```python
import torch

def _softmax(x, axis=-1):
    return torch.softmax(x, dim=axis)
def _gelu(x):
    return torch.nn.functional.gelu(x, approximate="tanh")
def _silu(x):
    return torch.nn.functional.silu(x)
def _sigmoid(x):
    return torch.sigmoid(x)
def _layernorm(x, axis=-1, eps=1e-5):
    m = x.mean(dim=axis, keepdim=True)
    v = x.var(dim=axis, keepdim=True, unbiased=False)
    return (x - m) / torch.sqrt(v + eps)
def _scatter_add(tgt, idx, src, axis=0):
    return tgt.clone().index_add_(axis, idx, src)
def _segment_sum(src, seg, n):
    out = torch.zeros((n,) + src.shape[1:], dtype=src.dtype)
    return out.index_add_(0, seg, src)
def _pad(x, pw):
    flat = tuple(v for pair in reversed(pw) for v in pair)
    return torch.nn.functional.pad(x, flat)

kernel_name = 'concat_heads__gqa_block_cached__gqa_block_cached__near_ridge'

def setup_inputs():

    _w = (lambda a: (lambda t: t.to(torch.bfloat16) if t.is_floating_point() else t)(torch.as_tensor(a)))
    def _A_setup():
        B, Sq, D = 16, 96, 640
        Hq, Hkv, Sk, Dh = 32, 32, 512, 128
        assert Hq % Hkv == 0, (Hq, Hkv)
        return {
            "x": _w((lambda *s: torch.randn(*s, dtype=torch.bfloat16) * 0.8)(B, Sq, D)),
            "k_cache": _w((lambda *s: torch.randn(*s, dtype=torch.bfloat16) * 0.8)(B, Hkv, Sk, Dh)),
            "v_cache": _w((lambda *s: torch.randn(*s, dtype=torch.bfloat16) * 0.05)(B, Hkv, Sk, Dh)),
            "wq": _w((lambda *s: torch.randn(*s, dtype=torch.bfloat16) * 0.8)(D, Hq * Dh) * (D ** -0.5)),
            "wo": _w((lambda *s: torch.randn(*s, dtype=torch.bfloat16) * 0.05)(Hq * Dh, D) * ((Hq * Dh) ** -0.5)),
        }
    _A_in = _A_setup()

    def _B_setup():
        B, Sq, D = 16, 96, 640
        Hq, Hkv, Sk, Dh = 32, 32, 512, 128
        assert Hq % Hkv == 0, (Hq, Hkv)
        return {
            "x": _w((lambda *s: torch.randn(*s, dtype=torch.bfloat16) * 0.8)(B, Sq, D)),
            "k_cache": _w((lambda *s: torch.randn(*s, dtype=torch.bfloat16) * 0.8)(B, Hkv, Sk, Dh)),
            "v_cache": _w((lambda *s: torch.randn(*s, dtype=torch.bfloat16) * 0.05)(B, Hkv, Sk, Dh)),
            "wq": _w((lambda *s: torch.randn(*s, dtype=torch.bfloat16) * 0.8)(D, Hq * Dh) * (D ** -0.5)),
            "wo": _w((lambda *s: torch.randn(*s, dtype=torch.bfloat16) * 0.05)(Hq * Dh, D) * ((Hq * Dh) ** -0.5)),
        }
    _B_in = _B_setup()

    return {
        "A_x": _A_in["x"],
        "A_k_cache": _A_in["k_cache"],
        "A_v_cache": _A_in["v_cache"],
        "A_wq": _A_in["wq"],
        "A_wo": _A_in["wo"],
        "B_x": _B_in["x"],
        "B_k_cache": _B_in["k_cache"],
        "B_v_cache": _B_in["v_cache"],
        "B_wq": _B_in["wq"],
        "B_wo": _B_in["wo"],
    }

def reference(A_x, A_k_cache, A_v_cache, A_wq, A_wo, B_x, B_k_cache, B_v_cache, B_wq, B_wo):
    def _A_ref(x, k_cache, v_cache, wq, wo):
        B, Sq, D = x.shape
        Hq, Dh = 32, 128
        Hkv = k_cache.shape[1]
        rep = Hq // Hkv
        q = (lambda x, *d: x.permute(*d))((x @ wq).reshape(B, Sq, Hq, Dh), 0, 2, 1, 3)
        k = (lambda x, n, axis: torch.repeat_interleave(x, n, dim=axis))(k_cache, rep, axis=1)
        v = (lambda x, n, axis: torch.repeat_interleave(x, n, dim=axis))(v_cache, rep, axis=1)
        scores = torch.einsum("bhqd,bhkd->bhqk", q, k) * (Dh ** -0.5)
        p = _softmax(scores, axis=-1)
        o = torch.einsum("bhqk,bhkd->bhqd", p, v)
        return (lambda x, *d: x.permute(*d))(o, 0, 2, 1, 3).reshape(B, Sq, Hq * Dh) @ wo

    def _B_ref(x, k_cache, v_cache, wq, wo):
        B, Sq, D = x.shape
        Hq, Dh = 32, 128
        Hkv = k_cache.shape[1]
        rep = Hq // Hkv
        q = (lambda x, *d: x.permute(*d))((x @ wq).reshape(B, Sq, Hq, Dh), 0, 2, 1, 3)
        k = (lambda x, n, axis: torch.repeat_interleave(x, n, dim=axis))(k_cache, rep, axis=1)
        v = (lambda x, n, axis: torch.repeat_interleave(x, n, dim=axis))(v_cache, rep, axis=1)
        scores = torch.einsum("bhqd,bhkd->bhqk", q, k) * (Dh ** -0.5)
        p = _softmax(scores, axis=-1)
        o = torch.einsum("bhqk,bhkd->bhqd", p, v)
        return (lambda x, *d: x.permute(*d))(o, 0, 2, 1, 3).reshape(B, Sq, Hq * Dh) @ wo

    a = _A_ref(A_x, A_k_cache, A_v_cache, A_wq, A_wo)
    b = _B_ref(B_x, B_k_cache, B_v_cache, B_wq, B_wo)
    return torch.concatenate([a, b], axis=-1)
```

```asm
; @launch grid=(256,1,1) block=(512,1,1) lds=163840
.amdgcn_target "amdgcn-amd-amdhsa--gfx950"
.text
.globl concat_heads__gqa_block_cached__gqa_block_cached__near_ridge_kernel
.p2align 8
.type concat_heads__gqa_block_cached__gqa_block_cached__near_ridge_kernel,@function
concat_heads__gqa_block_cached__gqa_block_cached__near_ridge_kernel:
    s_cmp_ge_u32 s2, 256
    s_cbranch_scc1 L_end
    s_load_dwordx16 s[36:51], s[0:1], 0
    s_load_dwordx8 s[52:59], s[0:1], 64
    s_load_dwordx2 s[60:61], s[0:1], 96
    v_lshrrev_b32 v1, 6, v0
    v_and_b32 v0, 63, v0
    v_readfirstlane_b32 s3, v1
    s_and_b32 s72, s2, 7
    s_lshr_b32 s78, s2, 3
    s_lshr_b32 s63, s72, 2
    s_and_b32 s72, s72, 3
    s_lshr_b32 s62, s78, 1
    s_and_b32 s78, s78, 1
    s_lshl_b32 s65, s72, 1
    s_add_u32 s65, s65, s78
    s_lshl_b32 s64, s65, 2
    s_mul_i32 s78, s78, 5
    s_lshr_b32 s89, s62, 1
    s_add_u32 s89, s89, s72
    s_add_u32 s89, s89, s78
    s_and_b32 s89, s89, 7
    s_lshl_b32 s89, s89, 14
    s_lshl_b32 s66, s63, 4
    s_add_u32 s66, s66, s62
    s_add_u32 s82, s62, s78
    s_cmp_ge_u32 s82, 10
    s_cselect_b32 s78, 10, 0
    s_sub_u32 s82, s82, s78
    s_cmp_ge_u32 s82, 10
    s_cselect_b32 s78, 10, 0
    s_sub_u32 s82, s82, s78
    s_lshr_b32 s83, s3, 2
    s_lshl_b32 s100, s83, 13
    s_lshl_b32 s101, s83, 11
    v_lshrrev_b32 v4, 4, v0
    v_and_b32 v5, 15, v0
    v_lshlrev_b32 v6, 2, v4
    v_xor_b32 v6, v6, v5
    v_lshlrev_b32 v6, 4, v6
    v_lshl_add_u32 v247, v4, 13, v6
    v_lshl_add_u32 v246, v4, 8, v6
    v_and_b32 v6, 7, v0
    v_xor_b32 v6, v6, v4
    s_lshl_b32 s72, s83, 2
    v_xor_b32 v6, s72, v6
    v_lshlrev_b32 v6, 4, v6
    v_lshrrev_b32 v7, 3, v0
    v_mul_u32_u24 v7, 1280, v7
    v_add_u32 v248, v7, v6
    s_mul_i32 s69, s62, 122880
    s_mul_i32 s72, s83, 10240
    s_add_u32 s69, s69, s72
    s_lshl_b32 s68, s64, 8
    s_lshl_b32 s72, s83, 18
    s_add_u32 s68, s68, s72
    s_mov_b32 s70, s82
    s_mov_b32 s71, 65536
    s_mov_b32 s34, 0
    s_mov_b32 s14, 1966080
    s_mov_b32 s15, 0x20000
    s_mov_b32 s18, 5242880
    s_mov_b32 s19, 0x20000
    s_and_b32 s79, s3, 3
    s_waitcnt lgkmcnt(0)
    s_cmp_eq_u32 s63, 0
    s_cselect_b64 s[12:13], s[36:37], s[46:47]
    s_cselect_b64 s[16:17], s[42:43], s[52:53]
    s_cselect_b64 s[4:5], s[38:39], s[48:49]
    s_cselect_b64 s[8:9], s[40:41], s[50:51]
    s_cselect_b64 s[20:21], s[44:45], s[54:55]
    s_and_b32 s13, s13, 0xffff
    s_and_b32 s17, s17, 0xffff
    s_cmp_lg_u32 s79, 3
    s_cbranch_scc1 L_rest
L_ld:
    s_add_u32 m0, s71, s100
    s_lshl_b32 s72, s70, 19
    s_add_u32 s72, s72, s68
    buffer_load_dwordx4 v247, s[16:19], s72 offen offset:0 lds
    s_add_u32 s72, s72, 31744
    buffer_load_dwordx4 v247, s[16:19], s72 offen offset:1024 lds
    s_add_u32 s72, s72, 31744
    buffer_load_dwordx4 v247, s[16:19], s72 offen offset:2048 lds
    s_add_u32 s72, s72, 31744
    buffer_load_dwordx4 v247, s[16:19], s72 offen offset:3072 lds
    s_add_u32 m0, m0, 4096
    s_add_u32 s72, s72, 35840
    buffer_load_dwordx4 v247, s[16:19], s72 offen offset:0 lds
    s_add_u32 s72, s72, 31744
    buffer_load_dwordx4 v247, s[16:19], s72 offen offset:1024 lds
    s_add_u32 s72, s72, 31744
    buffer_load_dwordx4 v247, s[16:19], s72 offen offset:2048 lds
    s_add_u32 s72, s72, 31744
    buffer_load_dwordx4 v247, s[16:19], s72 offen offset:3072 lds
    s_lshr_b32 s78, s101, 1
    s_add_u32 s78, s78, 16384
    s_add_u32 m0, s71, s78
    s_lshl_b32 s72, s70, 7
    s_add_u32 s72, s72, s69
    buffer_load_dwordx4 v248, s[12:15], s72 offen offset:0 lds
    s_add_u32 s72, s72, 18432
    buffer_load_dwordx4 v248, s[12:15], s72 offen offset:2048 lds
    s_add_u32 m0, m0, 4096
    s_add_u32 s72, s72, 22528
    buffer_load_dwordx4 v248, s[12:15], s72 offen offset:0 lds
    s_add_u32 s72, s72, 18432
    buffer_load_dwordx4 v248, s[12:15], s72 offen offset:2048 lds
    s_add_u32 m0, m0, 4096
    s_add_u32 s72, s72, 22528
    buffer_load_dwordx4 v248, s[12:15], s72 offen offset:0 lds
    s_add_u32 s72, s72, 18432
    buffer_load_dwordx4 v248, s[12:15], s72 offen offset:2048 lds
    s_add_u32 s70, s70, 1
    s_cmp_eq_u32 s70, 10
    s_cselect_b32 s70, 0, s70
    s_add_u32 s71, s71, 28672
    s_cmp_eq_u32 s71, 151552
    s_cselect_b32 s71, 65536, s71
    s_add_u32 m0, s71, s100
    s_lshl_b32 s72, s70, 19
    s_add_u32 s72, s72, s68
    buffer_load_dwordx4 v247, s[16:19], s72 offen offset:0 lds
    s_add_u32 s72, s72, 31744
    buffer_load_dwordx4 v247, s[16:19], s72 offen offset:1024 lds
    s_add_u32 s72, s72, 31744
    buffer_load_dwordx4 v247, s[16:19], s72 offen offset:2048 lds
    s_add_u32 s72, s72, 31744
    buffer_load_dwordx4 v247, s[16:19], s72 offen offset:3072 lds
    s_add_u32 m0, m0, 4096
    s_add_u32 s72, s72, 35840
    buffer_load_dwordx4 v247, s[16:19], s72 offen offset:0 lds
    s_add_u32 s72, s72, 31744
    buffer_load_dwordx4 v247, s[16:19], s72 offen offset:1024 lds
    s_add_u32 s72, s72, 31744
    buffer_load_dwordx4 v247, s[16:19], s72 offen offset:2048 lds
    s_add_u32 s72, s72, 31744
    buffer_load_dwordx4 v247, s[16:19], s72 offen offset:3072 lds
    s_lshr_b32 s78, s101, 1
    s_add_u32 s78, s78, 16384
    s_add_u32 m0, s71, s78
    s_lshl_b32 s72, s70, 7
    s_add_u32 s72, s72, s69
    buffer_load_dwordx4 v248, s[12:15], s72 offen offset:0 lds
    s_add_u32 s72, s72, 18432
    buffer_load_dwordx4 v248, s[12:15], s72 offen offset:2048 lds
    s_add_u32 m0, m0, 4096
    s_add_u32 s72, s72, 22528
    buffer_load_dwordx4 v248, s[12:15], s72 offen offset:0 lds
    s_add_u32 s72, s72, 18432
    buffer_load_dwordx4 v248, s[12:15], s72 offen offset:2048 lds
    s_add_u32 m0, m0, 4096
    s_add_u32 s72, s72, 22528
    buffer_load_dwordx4 v248, s[12:15], s72 offen offset:0 lds
    s_add_u32 s72, s72, 18432
    buffer_load_dwordx4 v248, s[12:15], s72 offen offset:2048 lds
    s_add_u32 s70, s70, 1
    s_cmp_eq_u32 s70, 10
    s_cselect_b32 s70, 0, s70
    s_add_u32 s71, s71, 28672
    s_cmp_eq_u32 s71, 151552
    s_cselect_b32 s71, 65536, s71
    s_mov_b32 s6, 67108864
    s_mov_b32 s7, 0x20000
    s_mov_b32 s10, 67108864
    s_mov_b32 s11, 0x20000
    s_mov_b32 s22, 5242880
    s_mov_b32 s23, 0x20000
    s_mov_b64 s[28:29], s[56:57]
    s_mov_b32 s30, 3932160
    s_mov_b32 s31, 0x20000
    s_mov_b64 s[24:25], s[60:61]
    s_mov_b32 s26, 293339136
    s_mov_b32 s27, 0x20000
    s_and_b32 s5, s5, 0xffff
    s_and_b32 s9, s9, 0xffff
    s_and_b32 s21, s21, 0xffff
    s_and_b32 s29, s29, 0xffff
    s_and_b32 s25, s25, 0xffff
    s_mov_b64 s[32:33], s[58:59]
    v_xor_b32 v6, v5, v4
    v_lshlrev_b32 v6, 4, v6
    v_lshl_add_u32 v6, v4, 8, v6
    v_xor_b32 v242, 0, v6
    v_xor_b32 v243, 64, v6
    v_xor_b32 v244, 128, v6
    v_xor_b32 v245, 192, v6
    v_lshlrev_b32 v240, 4, v0
    v_add_u32 v241, 139264, v240
    s_lshl_b32 s78, s62, 5
    s_add_u32 s72, s64, s78
    s_lshl_b32 s67, s72, 17
    s_add_u32 s67, s67, s100
    s_add_u32 s67, s67, s89
    s_mov_b32 s85, s100
    s_add_u32 s75, s101, 98304
    s_lshl_b32 s76, s82, 2
    s_mul_i32 s84, s83, 100
    s_add_u32 s84, s84, 9
    s_waitcnt vmcnt(14)
    s_barrier
    s_add_u32 m0, s71, s100
    s_lshl_b32 s72, s70, 19
    s_add_u32 s72, s72, s68
    buffer_load_dwordx4 v247, s[16:19], s72 offen offset:0 lds
    s_add_u32 s72, s72, 31744
    buffer_load_dwordx4 v247, s[16:19], s72 offen offset:1024 lds
    s_add_u32 s72, s72, 31744
    buffer_load_dwordx4 v247, s[16:19], s72 offen offset:2048 lds
    s_add_u32 s72, s72, 31744
    buffer_load_dwordx4 v247, s[16:19], s72 offen offset:3072 lds
    s_add_u32 m0, m0, 4096
    s_add_u32 s72, s72, 35840
    buffer_load_dwordx4 v247, s[16:19], s72 offen offset:0 lds
    s_add_u32 s72, s72, 31744
    buffer_load_dwordx4 v247, s[16:19], s72 offen offset:1024 lds
    s_add_u32 s72, s72, 31744
    buffer_load_dwordx4 v247, s[16:19], s72 offen offset:2048 lds
    s_add_u32 s72, s72, 31744
    buffer_load_dwordx4 v247, s[16:19], s72 offen offset:3072 lds
    s_lshr_b32 s78, s101, 1
    s_add_u32 s78, s78, 16384
    s_add_u32 m0, s71, s78
    s_lshl_b32 s72, s70, 7
    s_add_u32 s72, s72, s69
    buffer_load_dwordx4 v248, s[12:15], s72 offen offset:0 lds
    s_add_u32 s72, s72, 18432
    buffer_load_dwordx4 v248, s[12:15], s72 offen offset:2048 lds
    s_add_u32 m0, m0, 4096
    s_add_u32 s72, s72, 22528
    buffer_load_dwordx4 v248, s[12:15], s72 offen offset:0 lds
    s_add_u32 s72, s72, 18432
    buffer_load_dwordx4 v248, s[12:15], s72 offen offset:2048 lds
    s_add_u32 m0, m0, 4096
    s_add_u32 s72, s72, 22528
    buffer_load_dwordx4 v248, s[12:15], s72 offen offset:0 lds
    s_add_u32 s72, s72, 18432
    buffer_load_dwordx4 v248, s[12:15], s72 offen offset:2048 lds
    s_add_u32 s70, s70, 1
    s_cmp_eq_u32 s70, 10
    s_cselect_b32 s70, 0, s70
    s_add_u32 s71, s71, 28672
    s_cmp_eq_u32 s71, 151552
    s_cselect_b32 s71, 65536, s71
    s_mov_b32 m0, s85
    s_nop 0
    buffer_load_dwordx4 v242, s[4:7], s67 offen offset:0 nt lds
    buffer_load_dwordx4 v243, s[4:7], s67 offen offset:1024 nt lds
    buffer_load_dwordx4 v244, s[4:7], s67 offen offset:2048 nt lds
    buffer_load_dwordx4 v245, s[4:7], s67 offen offset:3072 nt lds
    s_add_u32 m0, s85, 4096
    s_add_u32 s72, s67, 4096
    buffer_load_dwordx4 v242, s[4:7], s72 offen offset:0 nt lds
    buffer_load_dwordx4 v243, s[4:7], s72 offen offset:1024 nt lds
    buffer_load_dwordx4 v244, s[4:7], s72 offen offset:2048 nt lds
    buffer_load_dwordx4 v245, s[4:7], s72 offen offset:3072 nt lds
    s_add_u32 m0, s85, 16384
    s_nop 0
    buffer_load_dwordx4 v246, s[8:11], s67 offen offset:0 nt lds
    buffer_load_dwordx4 v246, s[8:11], s67 offen offset:1024 nt lds
    buffer_load_dwordx4 v246, s[8:11], s67 offen offset:2048 nt lds
    buffer_load_dwordx4 v246, s[8:11], s67 offen offset:3072 nt lds
    s_add_u32 m0, s85, 20480
    s_add_u32 s72, s67, 4096
    buffer_load_dwordx4 v246, s[8:11], s72 offen offset:0 nt lds
    buffer_load_dwordx4 v246, s[8:11], s72 offen offset:1024 nt lds
    buffer_load_dwordx4 v246, s[8:11], s72 offen offset:2048 nt lds
    buffer_load_dwordx4 v246, s[8:11], s72 offen offset:3072 nt lds
    s_add_u32 s67, s67, 16384
    s_and_b32 s78, s67, 0x1c000
    s_cselect_b32 s78, 0, 0x20000
    s_sub_u32 s67, s67, s78
    s_add_u32 s85, s85, 32768
    s_cmp_ge_u32 s85, 98304
    s_cselect_b32 s85, s100, s85
    s_waitcnt vmcnt(30)
    s_barrier
    s_add_u32 m0, s71, s100
    s_lshl_b32 s72, s70, 19
    s_add_u32 s72, s72, s68
    buffer_load_dwordx4 v247, s[16:19], s72 offen offset:0 lds
    s_add_u32 s72, s72, 31744
    buffer_load_dwordx4 v247, s[16:19], s72 offen offset:1024 lds
    s_add_u32 s72, s72, 31744
    buffer_load_dwordx4 v247, s[16:19], s72 offen offset:2048 lds
    s_add_u32 s72, s72, 31744
    buffer_load_dwordx4 v247, s[16:19], s72 offen offset:3072 lds
    s_add_u32 m0, m0, 4096
    s_add_u32 s72, s72, 35840
    buffer_load_dwordx4 v247, s[16:19], s72 offen offset:0 lds
    s_add_u32 s72, s72, 31744
    buffer_load_dwordx4 v247, s[16:19], s72 offen offset:1024 lds
    s_add_u32 s72, s72, 31744
    buffer_load_dwordx4 v247, s[16:19], s72 offen offset:2048 lds
    s_add_u32 s72, s72, 31744
    buffer_load_dwordx4 v247, s[16:19], s72 offen offset:3072 lds
    s_lshr_b32 s78, s101, 1
    s_add_u32 s78, s78, 16384
    s_add_u32 m0, s71, s78
    s_lshl_b32 s72, s70, 7
    s_add_u32 s72, s72, s69
    buffer_load_dwordx4 v248, s[12:15], s72 offen offset:0 lds
    s_add_u32 s72, s72, 18432
    buffer_load_dwordx4 v248, s[12:15], s72 offen offset:2048 lds
    s_add_u32 m0, m0, 4096
    s_add_u32 s72, s72, 22528
    buffer_load_dwordx4 v248, s[12:15], s72 offen offset:0 lds
    s_add_u32 s72, s72, 18432
    buffer_load_dwordx4 v248, s[12:15], s72 offen offset:2048 lds
    s_add_u32 m0, m0, 4096
    s_add_u32 s72, s72, 22528
    buffer_load_dwordx4 v248, s[12:15], s72 offen offset:0 lds
    s_add_u32 s72, s72, 18432
    buffer_load_dwordx4 v248, s[12:15], s72 offen offset:2048 lds
    s_add_u32 s70, s70, 1
    s_cmp_eq_u32 s70, 10
    s_cselect_b32 s70, 0, s70
    s_add_u32 s71, s71, 28672
    s_cmp_eq_u32 s71, 151552
    s_cselect_b32 s71, 65536, s71
    s_waitcnt vmcnt(30)
    s_mov_b32 s35, 5
    s_barrier
L_ld_q:
    s_add_u32 m0, s71, s100
    s_lshl_b32 s72, s70, 19
    s_add_u32 s72, s72, s68
    buffer_load_dwordx4 v247, s[16:19], s72 offen offset:0 lds
    s_add_u32 s72, s72, 31744
    buffer_load_dwordx4 v247, s[16:19], s72 offen offset:1024 lds
    s_add_u32 s72, s72, 31744
    buffer_load_dwordx4 v247, s[16:19], s72 offen offset:2048 lds
    s_add_u32 s72, s72, 31744
    buffer_load_dwordx4 v247, s[16:19], s72 offen offset:3072 lds
    s_add_u32 m0, m0, 4096
    s_add_u32 s72, s72, 35840
    buffer_load_dwordx4 v247, s[16:19], s72 offen offset:0 lds
    s_add_u32 s72, s72, 31744
    buffer_load_dwordx4 v247, s[16:19], s72 offen offset:1024 lds
    s_add_u32 s72, s72, 31744
    buffer_load_dwordx4 v247, s[16:19], s72 offen offset:2048 lds
    s_add_u32 s72, s72, 31744
    buffer_load_dwordx4 v247, s[16:19], s72 offen offset:3072 lds
    s_lshr_b32 s78, s101, 1
    s_add_u32 s78, s78, 16384
    s_add_u32 m0, s71, s78
    s_lshl_b32 s72, s70, 7
    s_add_u32 s72, s72, s69
    buffer_load_dwordx4 v248, s[12:15], s72 offen offset:0 lds
    s_add_u32 s72, s72, 18432
    buffer_load_dwordx4 v248, s[12:15], s72 offen offset:2048 lds
    s_add_u32 m0, m0, 4096
    s_add_u32 s72, s72, 22528
    buffer_load_dwordx4 v248, s[12:15], s72 offen offset:0 lds
    s_add_u32 s72, s72, 18432
    buffer_load_dwordx4 v248, s[12:15], s72 offen offset:2048 lds
    s_add_u32 m0, m0, 4096
    s_add_u32 s72, s72, 22528
    buffer_load_dwordx4 v248, s[12:15], s72 offen offset:0 lds
    s_add_u32 s72, s72, 18432
    buffer_load_dwordx4 v248, s[12:15], s72 offen offset:2048 lds
    s_add_u32 s70, s70, 1
    s_cmp_eq_u32 s70, 10
    s_cselect_b32 s70, 0, s70
    s_add_u32 s71, s71, 28672
    s_cmp_eq_u32 s71, 151552
    s_cselect_b32 s71, 65536, s71
    s_waitcnt vmcnt(14)
    s_sub_u32 s35, s35, 1
    s_cmp_lg_u32 s35, 0
    s_barrier
    s_cbranch_scc1 L_ld_q
L_ld_7:
    s_add_u32 m0, s71, s100
    s_lshl_b32 s72, s70, 19
    s_add_u32 s72, s72, s68
    buffer_load_dwordx4 v247, s[16:19], s72 offen offset:0 lds
    s_add_u32 s72, s72, 31744
    buffer_load_dwordx4 v247, s[16:19], s72 offen offset:1024 lds
    s_add_u32 s72, s72, 31744
    buffer_load_dwordx4 v247, s[16:19], s72 offen offset:2048 lds
    s_add_u32 s72, s72, 31744
    buffer_load_dwordx4 v247, s[16:19], s72 offen offset:3072 lds
    s_add_u32 m0, m0, 4096
    s_add_u32 s72, s72, 35840
    buffer_load_dwordx4 v247, s[16:19], s72 offen offset:0 lds
    s_add_u32 s72, s72, 31744
    buffer_load_dwordx4 v247, s[16:19], s72 offen offset:1024 lds
    s_add_u32 s72, s72, 31744
    buffer_load_dwordx4 v247, s[16:19], s72 offen offset:2048 lds
    s_add_u32 s72, s72, 31744
    buffer_load_dwordx4 v247, s[16:19], s72 offen offset:3072 lds
    s_lshr_b32 s78, s101, 1
    s_add_u32 s78, s78, 16384
    s_add_u32 m0, s71, s78
    s_lshl_b32 s72, s70, 7
    s_add_u32 s72, s72, s69
    buffer_load_dwordx4 v248, s[12:15], s72 offen offset:0 lds
    s_add_u32 s72, s72, 18432
    buffer_load_dwordx4 v248, s[12:15], s72 offen offset:2048 lds
    s_add_u32 m0, m0, 4096
    s_add_u32 s72, s72, 22528
    buffer_load_dwordx4 v248, s[12:15], s72 offen offset:0 lds
    s_add_u32 s72, s72, 18432
    buffer_load_dwordx4 v248, s[12:15], s72 offen offset:2048 lds
    s_add_u32 m0, m0, 4096
    s_add_u32 s72, s72, 22528
    buffer_load_dwordx4 v248, s[12:15], s72 offen offset:0 lds
    s_add_u32 s72, s72, 18432
    buffer_load_dwordx4 v248, s[12:15], s72 offen offset:2048 lds
    s_add_u32 s70, s70, 1
    s_cmp_eq_u32 s70, 10
    s_cselect_b32 s70, 0, s70
    s_add_u32 s71, s71, 28672
    s_cmp_eq_u32 s71, 151552
    s_cselect_b32 s71, 65536, s71
    s_mov_b32 m0, s85
    s_nop 0
    buffer_load_dwordx4 v242, s[4:7], s67 offen offset:0 nt lds
    buffer_load_dwordx4 v243, s[4:7], s67 offen offset:1024 nt lds
    buffer_load_dwordx4 v244, s[4:7], s67 offen offset:2048 nt lds
    buffer_load_dwordx4 v245, s[4:7], s67 offen offset:3072 nt lds
    s_add_u32 m0, s85, 4096
    s_add_u32 s72, s67, 4096
    buffer_load_dwordx4 v242, s[4:7], s72 offen offset:0 nt lds
    buffer_load_dwordx4 v243, s[4:7], s72 offen offset:1024 nt lds
    buffer_load_dwordx4 v244, s[4:7], s72 offen offset:2048 nt lds
    buffer_load_dwordx4 v245, s[4:7], s72 offen offset:3072 nt lds
    s_waitcnt vmcnt(22)
    s_barrier
    s_mul_i32 s72, s83, 196608
    s_sub_u32 s68, s68, s72
    s_add_u32 s68, s68, 256
    s_lshl_b32 s72, s76, 17
    s_add_u32 s72, s72, s68
    s_mov_b32 m0, s75
    s_add_u32 s76, s76, 1
    buffer_load_dwordx4 v247, s[16:19], s72 offen lds
    s_add_u32 s72, s72, 31744
    s_cmp_eq_u32 s76, 40
    buffer_load_dwordx4 v247, s[16:19], s72 offen offset:1024 lds
    s_cselect_b32 s76, 0, s76
    s_lshl_b32 s72, s76, 17
    s_add_u32 s72, s72, s68
    s_add_u32 m0, m0, 4096
    s_add_u32 s76, s76, 1
    buffer_load_dwordx4 v247, s[16:19], s72 offen lds
    s_add_u32 s72, s72, 31744
    s_cmp_eq_u32 s76, 40
    buffer_load_dwordx4 v247, s[16:19], s72 offen offset:1024 lds
    s_cselect_b32 s76, 0, s76
    s_lshl_b32 s72, s76, 17
    s_add_u32 s72, s72, s68
    s_add_u32 m0, m0, 4096
    s_add_u32 s76, s76, 1
    buffer_load_dwordx4 v247, s[16:19], s72 offen lds
    s_add_u32 s72, s72, 31744
    s_cmp_eq_u32 s76, 40
    buffer_load_dwordx4 v247, s[16:19], s72 offen offset:1024 lds
    s_cselect_b32 s76, 0, s76
    s_lshl_b32 s72, s76, 17
    s_add_u32 s72, s72, s68
    s_add_u32 m0, m0, 4096
    s_add_u32 s76, s76, 1
    buffer_load_dwordx4 v247, s[16:19], s72 offen lds
    s_add_u32 s72, s72, 31744
    s_cmp_eq_u32 s76, 40
    buffer_load_dwordx4 v247, s[16:19], s72 offen offset:1024 lds
    s_cselect_b32 s76, 0, s76
    s_lshl_b32 s72, s76, 17
    s_add_u32 s72, s72, s68
    s_add_u32 m0, m0, 4096
    s_add_u32 s76, s76, 1
    buffer_load_dwordx4 v247, s[16:19], s72 offen lds
    s_add_u32 s72, s72, 31744
    s_cmp_eq_u32 s76, 40
    buffer_load_dwordx4 v247, s[16:19], s72 offen offset:1024 lds
    s_cselect_b32 s76, 0, s76
    s_xor_b32 s75, s75, 20480
    s_add_u32 m0, s85, 16384
    s_nop 0
    buffer_load_dwordx4 v246, s[8:11], s67 offen offset:0 nt lds
    buffer_load_dwordx4 v246, s[8:11], s67 offen offset:1024 nt lds
    buffer_load_dwordx4 v246, s[8:11], s67 offen offset:2048 nt lds
    buffer_load_dwordx4 v246, s[8:11], s67 offen offset:3072 nt lds
    s_add_u32 m0, s85, 20480
    s_add_u32 s72, s67, 4096
    buffer_load_dwordx4 v246, s[8:11], s72 offen offset:0 nt lds
    buffer_load_dwordx4 v246, s[8:11], s72 offen offset:1024 nt lds
    buffer_load_dwordx4 v246, s[8:11], s72 offen offset:2048 nt lds
    buffer_load_dwordx4 v246, s[8:11], s72 offen offset:3072 nt lds
    s_add_u32 s67, s67, 16384
    s_and_b32 s78, s67, 0x1c000
    s_cselect_b32 s78, 0, 0x20000
    s_sub_u32 s67, s67, s78
    s_add_u32 s85, s85, 32768
    s_cmp_ge_u32 s85, 98304
    s_cselect_b32 s85, s100, s85
    s_waitcnt vmcnt(26)
    s_barrier
    s_waitcnt vmcnt(8)
    s_mov_b32 s77, 0
    s_barrier
L_ld_m:
    s_and_b32 s72, s77, 7
    s_cmp_eq_u32 s72, 7
    s_cselect_b32 s72, 256, 0
    s_add_u32 s68, s68, s72
    s_lshl_b32 s72, s76, 17
    s_add_u32 s72, s72, s68
    s_mov_b32 m0, s75
    s_add_u32 s76, s76, 1
    buffer_load_dwordx4 v247, s[16:19], s72 offen lds
    s_add_u32 s72, s72, 31744
    s_cmp_eq_u32 s76, 40
    buffer_load_dwordx4 v247, s[16:19], s72 offen offset:1024 lds
    s_cselect_b32 s76, 0, s76
    s_lshl_b32 s72, s76, 17
    s_add_u32 s72, s72, s68
    s_add_u32 m0, m0, 4096
    s_add_u32 s76, s76, 1
    buffer_load_dwordx4 v247, s[16:19], s72 offen lds
    s_add_u32 s72, s72, 31744
    s_cmp_eq_u32 s76, 40
    buffer_load_dwordx4 v247, s[16:19], s72 offen offset:1024 lds
    s_cselect_b32 s76, 0, s76
    s_lshl_b32 s72, s76, 17
    s_add_u32 s72, s72, s68
    s_add_u32 m0, m0, 4096
    s_add_u32 s76, s76, 1
    buffer_load_dwordx4 v247, s[16:19], s72 offen lds
    s_add_u32 s72, s72, 31744
    s_cmp_eq_u32 s76, 40
    buffer_load_dwordx4 v247, s[16:19], s72 offen offset:1024 lds
    s_cselect_b32 s76, 0, s76
    s_lshl_b32 s72, s76, 17
    s_add_u32 s72, s72, s68
    s_add_u32 m0, m0, 4096
    s_add_u32 s76, s76, 1
    buffer_load_dwordx4 v247, s[16:19], s72 offen lds
    s_add_u32 s72, s72, 31744
    s_cmp_eq_u32 s76, 40
    buffer_load_dwordx4 v247, s[16:19], s72 offen offset:1024 lds
    s_cselect_b32 s76, 0, s76
    s_lshl_b32 s72, s76, 17
    s_add_u32 s72, s72, s68
    s_add_u32 m0, m0, 4096
    s_add_u32 s76, s76, 1
    buffer_load_dwordx4 v247, s[16:19], s72 offen lds
    s_add_u32 s72, s72, 31744
    s_cmp_eq_u32 s76, 40
    buffer_load_dwordx4 v247, s[16:19], s72 offen offset:1024 lds
    s_cselect_b32 s76, 0, s76
    s_xor_b32 s75, s75, 20480
    s_and_b32 s72, s77, 7
    s_cmp_eq_u32 s72, 6
    s_cselect_b32 s72, 131072, 0
    s_add_u32 s67, s67, s72
    s_mov_b32 m0, s85
    s_nop 0
    buffer_load_dwordx4 v242, s[4:7], s67 offen offset:0 nt lds
    buffer_load_dwordx4 v243, s[4:7], s67 offen offset:1024 nt lds
    buffer_load_dwordx4 v244, s[4:7], s67 offen offset:2048 nt lds
    buffer_load_dwordx4 v245, s[4:7], s67 offen offset:3072 nt lds
    s_add_u32 m0, s85, 4096
    s_add_u32 s72, s67, 4096
    buffer_load_dwordx4 v242, s[4:7], s72 offen offset:0 nt lds
    buffer_load_dwordx4 v243, s[4:7], s72 offen offset:1024 nt lds
    buffer_load_dwordx4 v244, s[4:7], s72 offen offset:2048 nt lds
    buffer_load_dwordx4 v245, s[4:7], s72 offen offset:3072 nt lds
    s_add_u32 m0, s85, 16384
    s_nop 0
    buffer_load_dwordx4 v246, s[8:11], s67 offen offset:0 nt lds
    buffer_load_dwordx4 v246, s[8:11], s67 offen offset:1024 nt lds
    buffer_load_dwordx4 v246, s[8:11], s67 offen offset:2048 nt lds
    buffer_load_dwordx4 v246, s[8:11], s67 offen offset:3072 nt lds
    s_add_u32 m0, s85, 20480
    s_add_u32 s72, s67, 4096
    buffer_load_dwordx4 v246, s[8:11], s72 offen offset:0 nt lds
    buffer_load_dwordx4 v246, s[8:11], s72 offen offset:1024 nt lds
    buffer_load_dwordx4 v246, s[8:11], s72 offen offset:2048 nt lds
    buffer_load_dwordx4 v246, s[8:11], s72 offen offset:3072 nt lds
    s_add_u32 s67, s67, 16384
    s_and_b32 s78, s67, 0x1c000
    s_cselect_b32 s78, 0, 0x20000
    s_sub_u32 s67, s67, s78
    s_add_u32 s85, s85, 32768
    s_cmp_ge_u32 s85, 98304
    s_cselect_b32 s85, s100, s85
    s_cmp_eq_u32 s77, s84
    s_cbranch_scc1 L_park
L_ld_mb:
    s_waitcnt vmcnt(16)
    s_add_u32 s77, s77, 1
    s_cmp_lg_u32 s77, 23
    s_barrier
    s_cbranch_scc1 L_ld_m
L_ld_t:
    s_mov_b32 m0, s85
    s_nop 0
    buffer_load_dwordx4 v242, s[4:7], s67 offen offset:0 nt lds
    buffer_load_dwordx4 v243, s[4:7], s67 offen offset:1024 nt lds
    buffer_load_dwordx4 v244, s[4:7], s67 offen offset:2048 nt lds
    buffer_load_dwordx4 v245, s[4:7], s67 offen offset:3072 nt lds
    s_add_u32 m0, s85, 4096
    s_add_u32 s72, s67, 4096
    buffer_load_dwordx4 v242, s[4:7], s72 offen offset:0 nt lds
    buffer_load_dwordx4 v243, s[4:7], s72 offen offset:1024 nt lds
    buffer_load_dwordx4 v244, s[4:7], s72 offen offset:2048 nt lds
    buffer_load_dwordx4 v245, s[4:7], s72 offen offset:3072 nt lds
    s_add_u32 m0, s85, 16384
    s_nop 0
    buffer_load_dwordx4 v246, s[8:11], s67 offen offset:0 nt lds
    buffer_load_dwordx4 v246, s[8:11], s67 offen offset:1024 nt lds
    buffer_load_dwordx4 v246, s[8:11], s67 offen offset:2048 nt lds
    buffer_load_dwordx4 v246, s[8:11], s67 offen offset:3072 nt lds
    s_add_u32 m0, s85, 20480
    s_add_u32 s72, s67, 4096
    buffer_load_dwordx4 v246, s[8:11], s72 offen offset:0 nt lds
    buffer_load_dwordx4 v246, s[8:11], s72 offen offset:1024 nt lds
    buffer_load_dwordx4 v246, s[8:11], s72 offen offset:2048 nt lds
    buffer_load_dwordx4 v246, s[8:11], s72 offen offset:3072 nt lds
    s_add_u32 s67, s67, 16384
    s_and_b32 s78, s67, 0x1c000
    s_cselect_b32 s78, 0, 0x20000
    s_sub_u32 s67, s67, s78
    s_add_u32 s85, s85, 32768
    s_cmp_ge_u32 s85, 98304
    s_cselect_b32 s85, s100, s85
    s_waitcnt vmcnt(16)
    s_cmp_lg_u32 s83, 0
    s_barrier
    s_cbranch_scc1 L_a24
L_ld_w:
    s_mov_b32 m0, s85
    s_nop 0
    buffer_load_dwordx4 v242, s[4:7], s67 offen offset:0 nt lds
    buffer_load_dwordx4 v243, s[4:7], s67 offen offset:1024 nt lds
    buffer_load_dwordx4 v244, s[4:7], s67 offen offset:2048 nt lds
    buffer_load_dwordx4 v245, s[4:7], s67 offen offset:3072 nt lds
    s_add_u32 m0, s85, 4096
    s_add_u32 s72, s67, 4096
    buffer_load_dwordx4 v242, s[4:7], s72 offen offset:0 nt lds
    buffer_load_dwordx4 v243, s[4:7], s72 offen offset:1024 nt lds
    buffer_load_dwordx4 v244, s[4:7], s72 offen offset:2048 nt lds
    buffer_load_dwordx4 v245, s[4:7], s72 offen offset:3072 nt lds
    s_add_u32 m0, s85, 8192
    s_add_u32 s72, s67, 8192
    buffer_load_dwordx4 v242, s[4:7], s72 offen offset:0 nt lds
    buffer_load_dwordx4 v243, s[4:7], s72 offen offset:1024 nt lds
    buffer_load_dwordx4 v244, s[4:7], s72 offen offset:2048 nt lds
    buffer_load_dwordx4 v245, s[4:7], s72 offen offset:3072 nt lds
    s_add_u32 m0, s85, 12288
    s_add_u32 s72, s67, 12288
    buffer_load_dwordx4 v242, s[4:7], s72 offen offset:0 nt lds
    buffer_load_dwordx4 v243, s[4:7], s72 offen offset:1024 nt lds
    buffer_load_dwordx4 v244, s[4:7], s72 offen offset:2048 nt lds
    buffer_load_dwordx4 v245, s[4:7], s72 offen offset:3072 nt lds
    s_add_u32 m0, s85, 16384
    s_nop 0
    buffer_load_dwordx4 v246, s[8:11], s67 offen offset:0 nt lds
    buffer_load_dwordx4 v246, s[8:11], s67 offen offset:1024 nt lds
    buffer_load_dwordx4 v246, s[8:11], s67 offen offset:2048 nt lds
    buffer_load_dwordx4 v246, s[8:11], s67 offen offset:3072 nt lds
    s_add_u32 m0, s85, 20480
    s_add_u32 s72, s67, 4096
    buffer_load_dwordx4 v246, s[8:11], s72 offen offset:0 nt lds
    buffer_load_dwordx4 v246, s[8:11], s72 offen offset:1024 nt lds
    buffer_load_dwordx4 v246, s[8:11], s72 offen offset:2048 nt lds
    buffer_load_dwordx4 v246, s[8:11], s72 offen offset:3072 nt lds
    s_add_u32 m0, s85, 24576
    s_add_u32 s72, s67, 8192
    buffer_load_dwordx4 v246, s[8:11], s72 offen offset:0 nt lds
    buffer_load_dwordx4 v246, s[8:11], s72 offen offset:1024 nt lds
    buffer_load_dwordx4 v246, s[8:11], s72 offen offset:2048 nt lds
    buffer_load_dwordx4 v246, s[8:11], s72 offen offset:3072 nt lds
    s_add_u32 m0, s85, 28672
    s_add_u32 s72, s67, 12288
    buffer_load_dwordx4 v246, s[8:11], s72 offen offset:0 nt lds
    buffer_load_dwordx4 v246, s[8:11], s72 offen offset:1024 nt lds
    buffer_load_dwordx4 v246, s[8:11], s72 offen offset:2048 nt lds
    buffer_load_dwordx4 v246, s[8:11], s72 offen offset:3072 nt lds
    s_add_u32 s67, s67, 16384
    s_and_b32 s78, s67, 0x1c000
    s_cselect_b32 s78, 0, 0x20000
    s_sub_u32 s67, s67, s78
    s_add_u32 s85, s85, 32768
    s_cmp_ge_u32 s85, 98304
    s_cselect_b32 s85, s100, s85
    v_add_u32 v241, 98304, v240
    ds_write_b128 v241, v[0:3] offset:0
    ds_write_b128 v241, v[4:7] offset:1024
    ds_write_b128 v241, v[8:11] offset:2048
    ds_write_b128 v241, v[12:15] offset:3072
    ds_write_b128 v241, v[16:19] offset:4096
    ds_write_b128 v241, v[20:23] offset:5120
    ds_write_b128 v241, v[24:27] offset:6144
    ds_write_b128 v241, v[28:31] offset:7168
    ds_write_b128 v241, v[32:35] offset:8192
    ds_write_b128 v241, v[36:39] offset:9216
    ds_write_b128 v241, v[40:43] offset:10240
    ds_write_b128 v241, v[44:47] offset:11264
    ds_write_b128 v241, v[48:51] offset:12288
    ds_write_b128 v241, v[52:55] offset:13312
    ds_write_b128 v241, v[56:59] offset:14336
    ds_write_b128 v241, v[60:63] offset:15360
    ds_write_b128 v241, v[64:67] offset:16384
    ds_write_b128 v241, v[68:71] offset:17408
    ds_write_b128 v241, v[72:75] offset:18432
    ds_write_b128 v241, v[76:79] offset:19456
    ds_write_b128 v241, v[80:83] offset:20480
    ds_write_b128 v241, v[84:87] offset:21504
    ds_write_b128 v241, v[88:91] offset:22528
    ds_write_b128 v241, v[92:95] offset:23552
    s_waitcnt lgkmcnt(0)
    s_waitcnt vmcnt(32)
    s_barrier
    s_mov_b32 m0, s85
    s_nop 0
    buffer_load_dwordx4 v242, s[4:7], s67 offen offset:0 nt lds
    buffer_load_dwordx4 v243, s[4:7], s67 offen offset:1024 nt lds
    buffer_load_dwordx4 v244, s[4:7], s67 offen offset:2048 nt lds
    buffer_load_dwordx4 v245, s[4:7], s67 offen offset:3072 nt lds
    s_add_u32 m0, s85, 4096
    s_add_u32 s72, s67, 4096
    buffer_load_dwordx4 v242, s[4:7], s72 offen offset:0 nt lds
    buffer_load_dwordx4 v243, s[4:7], s72 offen offset:1024 nt lds
    buffer_load_dwordx4 v244, s[4:7], s72 offen offset:2048 nt lds
    buffer_load_dwordx4 v245, s[4:7], s72 offen offset:3072 nt lds
    s_add_u32 m0, s85, 8192
    s_add_u32 s72, s67, 8192
    buffer_load_dwordx4 v242, s[4:7], s72 offen offset:0 nt lds
    buffer_load_dwordx4 v243, s[4:7], s72 offen offset:1024 nt lds
    buffer_load_dwordx4 v244, s[4:7], s72 offen offset:2048 nt lds
    buffer_load_dwordx4 v245, s[4:7], s72 offen offset:3072 nt lds
    s_add_u32 m0, s85, 12288
    s_add_u32 s72, s67, 12288
    buffer_load_dwordx4 v242, s[4:7], s72 offen offset:0 nt lds
    buffer_load_dwordx4 v243, s[4:7], s72 offen offset:1024 nt lds
    buffer_load_dwordx4 v244, s[4:7], s72 offen offset:2048 nt lds
    buffer_load_dwordx4 v245, s[4:7], s72 offen offset:3072 nt lds
    s_add_u32 m0, s85, 16384
    s_nop 0
    buffer_load_dwordx4 v246, s[8:11], s67 offen offset:0 nt lds
    buffer_load_dwordx4 v246, s[8:11], s67 offen offset:1024 nt lds
    buffer_load_dwordx4 v246, s[8:11], s67 offen offset:2048 nt lds
    buffer_load_dwordx4 v246, s[8:11], s67 offen offset:3072 nt lds
    s_add_u32 m0, s85, 20480
    s_add_u32 s72, s67, 4096
    buffer_load_dwordx4 v246, s[8:11], s72 offen offset:0 nt lds
    buffer_load_dwordx4 v246, s[8:11], s72 offen offset:1024 nt lds
    buffer_load_dwordx4 v246, s[8:11], s72 offen offset:2048 nt lds
    buffer_load_dwordx4 v246, s[8:11], s72 offen offset:3072 nt lds
    s_add_u32 m0, s85, 24576
    s_add_u32 s72, s67, 8192
    buffer_load_dwordx4 v246, s[8:11], s72 offen offset:0 nt lds
    buffer_load_dwordx4 v246, s[8:11], s72 offen offset:1024 nt lds
    buffer_load_dwordx4 v246, s[8:11], s72 offen offset:2048 nt lds
    buffer_load_dwordx4 v246, s[8:11], s72 offen offset:3072 nt lds
    s_add_u32 m0, s85, 28672
    s_add_u32 s72, s67, 12288
    buffer_load_dwordx4 v246, s[8:11], s72 offen offset:0 nt lds
    buffer_load_dwordx4 v246, s[8:11], s72 offen offset:1024 nt lds
    buffer_load_dwordx4 v246, s[8:11], s72 offen offset:2048 nt lds
    buffer_load_dwordx4 v246, s[8:11], s72 offen offset:3072 nt lds
    s_add_u32 s67, s67, 16384
    s_and_b32 s78, s67, 0x1c000
    s_cselect_b32 s78, 0, 0x20000
    s_sub_u32 s67, s67, s78
    s_add_u32 s85, s85, 32768
    s_cmp_ge_u32 s85, 98304
    s_cselect_b32 s85, s100, s85
    s_waitcnt lgkmcnt(0)
    s_waitcnt vmcnt(32)
    s_barrier
    s_mov_b32 m0, s85
    s_nop 0
    buffer_load_dwordx4 v242, s[4:7], s67 offen offset:0 nt lds
    buffer_load_dwordx4 v243, s[4:7], s67 offen offset:1024 nt lds
    buffer_load_dwordx4 v244, s[4:7], s67 offen offset:2048 nt lds
    buffer_load_dwordx4 v245, s[4:7], s67 offen offset:3072 nt lds
    s_add_u32 m0, s85, 4096
    s_add_u32 s72, s67, 4096
    buffer_load_dwordx4 v242, s[4:7], s72 offen offset:0 nt lds
    buffer_load_dwordx4 v243, s[4:7], s72 offen offset:1024 nt lds
    buffer_load_dwordx4 v244, s[4:7], s72 offen offset:2048 nt lds
    buffer_load_dwordx4 v245, s[4:7], s72 offen offset:3072 nt lds
    s_add_u32 m0, s85, 8192
    s_add_u32 s72, s67, 8192
    buffer_load_dwordx4 v242, s[4:7], s72 offen offset:0 nt lds
    buffer_load_dwordx4 v243, s[4:7], s72 offen offset:1024 nt lds
    buffer_load_dwordx4 v244, s[4:7], s72 offen offset:2048 nt lds
    buffer_load_dwordx4 v245, s[4:7], s72 offen offset:3072 nt lds
    s_add_u32 m0, s85, 12288
    s_add_u32 s72, s67, 12288
    buffer_load_dwordx4 v242, s[4:7], s72 offen offset:0 nt lds
    buffer_load_dwordx4 v243, s[4:7], s72 offen offset:1024 nt lds
    buffer_load_dwordx4 v244, s[4:7], s72 offen offset:2048 nt lds
    buffer_load_dwordx4 v245, s[4:7], s72 offen offset:3072 nt lds
    s_add_u32 m0, s85, 16384
    s_nop 0
    buffer_load_dwordx4 v246, s[8:11], s67 offen offset:0 nt lds
    buffer_load_dwordx4 v246, s[8:11], s67 offen offset:1024 nt lds
    buffer_load_dwordx4 v246, s[8:11], s67 offen offset:2048 nt lds
    buffer_load_dwordx4 v246, s[8:11], s67 offen offset:3072 nt lds
    s_add_u32 m0, s85, 20480
    s_add_u32 s72, s67, 4096
    buffer_load_dwordx4 v246, s[8:11], s72 offen offset:0 nt lds
    buffer_load_dwordx4 v246, s[8:11], s72 offen offset:1024 nt lds
    buffer_load_dwordx4 v246, s[8:11], s72 offen offset:2048 nt lds
    buffer_load_dwordx4 v246, s[8:11], s72 offen offset:3072 nt lds
    s_add_u32 m0, s85, 24576
    s_add_u32 s72, s67, 8192
    buffer_load_dwordx4 v246, s[8:11], s72 offen offset:0 nt lds
    buffer_load_dwordx4 v246, s[8:11], s72 offen offset:1024 nt lds
    buffer_load_dwordx4 v246, s[8:11], s72 offen offset:2048 nt lds
    buffer_load_dwordx4 v246, s[8:11], s72 offen offset:3072 nt lds
    s_add_u32 m0, s85, 28672
    s_add_u32 s72, s67, 12288
    buffer_load_dwordx4 v246, s[8:11], s72 offen offset:0 nt lds
    buffer_load_dwordx4 v246, s[8:11], s72 offen offset:1024 nt lds
    buffer_load_dwordx4 v246, s[8:11], s72 offen offset:2048 nt lds
    buffer_load_dwordx4 v246, s[8:11], s72 offen offset:3072 nt lds
    s_add_u32 s67, s67, 16384
    s_and_b32 s78, s67, 0x1c000
    s_cselect_b32 s78, 0, 0x20000
    s_sub_u32 s67, s67, s78
    s_add_u32 s85, s85, 32768
    s_cmp_ge_u32 s85, 98304
    s_cselect_b32 s85, s100, s85
    s_waitcnt lgkmcnt(0)
    s_waitcnt vmcnt(32)
    s_barrier
    s_mov_b32 m0, s85
    s_nop 0
    buffer_load_dwordx4 v242, s[4:7], s67 offen offset:0 nt lds
    buffer_load_dwordx4 v243, s[4:7], s67 offen offset:1024 nt lds
    buffer_load_dwordx4 v244, s[4:7], s67 offen offset:2048 nt lds
    buffer_load_dwordx4 v245, s[4:7], s67 offen offset:3072 nt lds
    s_add_u32 m0, s85, 4096
    s_add_u32 s72, s67, 4096
    buffer_load_dwordx4 v242, s[4:7], s72 offen offset:0 nt lds
    buffer_load_dwordx4 v243, s[4:7], s72 offen offset:1024 nt lds
    buffer_load_dwordx4 v244, s[4:7], s72 offen offset:2048 nt lds
    buffer_load_dwordx4 v245, s[4:7], s72 offen offset:3072 nt lds
    s_add_u32 m0, s85, 8192
    s_add_u32 s72, s67, 8192
    buffer_load_dwordx4 v242, s[4:7], s72 offen offset:0 nt lds
    buffer_load_dwordx4 v243, s[4:7], s72 offen offset:1024 nt lds
    buffer_load_dwordx4 v244, s[4:7], s72 offen offset:2048 nt lds
    buffer_load_dwordx4 v245, s[4:7], s72 offen offset:3072 nt lds
    s_add_u32 m0, s85, 12288
    s_add_u32 s72, s67, 12288
    buffer_load_dwordx4 v242, s[4:7], s72 offen offset:0 nt lds
    buffer_load_dwordx4 v243, s[4:7], s72 offen offset:1024 nt lds
    buffer_load_dwordx4 v244, s[4:7], s72 offen offset:2048 nt lds
    buffer_load_dwordx4 v245, s[4:7], s72 offen offset:3072 nt lds
    s_add_u32 m0, s85, 16384
    s_nop 0
    buffer_load_dwordx4 v246, s[8:11], s67 offen offset:0 nt lds
    buffer_load_dwordx4 v246, s[8:11], s67 offen offset:1024 nt lds
    buffer_load_dwordx4 v246, s[8:11], s67 offen offset:2048 nt lds
    buffer_load_dwordx4 v246, s[8:11], s67 offen offset:3072 nt lds
    s_add_u32 m0, s85, 20480
    s_add_u32 s72, s67, 4096
    buffer_load_dwordx4 v246, s[8:11], s72 offen offset:0 nt lds
    buffer_load_dwordx4 v246, s[8:11], s72 offen offset:1024 nt lds
    buffer_load_dwordx4 v246, s[8:11], s72 offen offset:2048 nt lds
    buffer_load_dwordx4 v246, s[8:11], s72 offen offset:3072 nt lds
    s_add_u32 m0, s85, 24576
    s_add_u32 s72, s67, 8192
    buffer_load_dwordx4 v246, s[8:11], s72 offen offset:0 nt lds
    buffer_load_dwordx4 v246, s[8:11], s72 offen offset:1024 nt lds
    buffer_load_dwordx4 v246, s[8:11], s72 offen offset:2048 nt lds
    buffer_load_dwordx4 v246, s[8:11], s72 offen offset:3072 nt lds
    s_add_u32 m0, s85, 28672
    s_add_u32 s72, s67, 12288
    buffer_load_dwordx4 v246, s[8:11], s72 offen offset:0 nt lds
    buffer_load_dwordx4 v246, s[8:11], s72 offen offset:1024 nt lds
    buffer_load_dwordx4 v246, s[8:11], s72 offen offset:2048 nt lds
    buffer_load_dwordx4 v246, s[8:11], s72 offen offset:3072 nt lds
    s_add_u32 s67, s67, 16384
    s_and_b32 s78, s67, 0x1c000
    s_cselect_b32 s78, 0, 0x20000
    s_sub_u32 s67, s67, s78
    s_add_u32 s85, s85, 32768
    s_cmp_ge_u32 s85, 98304
    s_cselect_b32 s85, s100, s85
    v_add_u32 v241, 98304, v240
    ds_write_b128 v241, v[96:99] offset:0
    ds_write_b128 v241, v[100:103] offset:1024
    ds_write_b128 v241, v[104:107] offset:2048
    ds_write_b128 v241, v[108:111] offset:3072
    ds_write_b128 v241, v[112:115] offset:4096
    ds_write_b128 v241, v[116:119] offset:5120
    ds_write_b128 v241, v[120:123] offset:6144
    ds_write_b128 v241, v[124:127] offset:7168
    ds_write_b128 v241, v[128:131] offset:8192
    ds_write_b128 v241, v[132:135] offset:9216
    ds_write_b128 v241, v[136:139] offset:10240
    ds_write_b128 v241, v[140:143] offset:11264
    ds_write_b128 v241, v[144:147] offset:12288
    ds_write_b128 v241, v[148:151] offset:13312
    ds_write_b128 v241, v[152:155] offset:14336
    ds_write_b128 v241, v[156:159] offset:15360
    ds_write_b128 v241, v[160:163] offset:16384
    ds_write_b128 v241, v[164:167] offset:17408
    ds_write_b128 v241, v[168:171] offset:18432
    ds_write_b128 v241, v[172:175] offset:19456
    ds_write_b128 v241, v[176:179] offset:20480
    ds_write_b128 v241, v[180:183] offset:21504
    ds_write_b128 v241, v[184:187] offset:22528
    ds_write_b128 v241, v[188:191] offset:23552
    s_waitcnt lgkmcnt(0)
    s_waitcnt vmcnt(32)
    s_barrier
    s_mov_b32 m0, s85
    s_nop 0
    buffer_load_dwordx4 v242, s[4:7], s67 offen offset:0 nt lds
    buffer_load_dwordx4 v243, s[4:7], s67 offen offset:1024 nt lds
    buffer_load_dwordx4 v244, s[4:7], s67 offen offset:2048 nt lds
    buffer_load_dwordx4 v245, s[4:7], s67 offen offset:3072 nt lds
    s_add_u32 m0, s85, 4096
    s_add_u32 s72, s67, 4096
    buffer_load_dwordx4 v242, s[4:7], s72 offen offset:0 nt lds
    buffer_load_dwordx4 v243, s[4:7], s72 offen offset:1024 nt lds
    buffer_load_dwordx4 v244, s[4:7], s72 offen offset:2048 nt lds
    buffer_load_dwordx4 v245, s[4:7], s72 offen offset:3072 nt lds
    s_add_u32 m0, s85, 8192
    s_add_u32 s72, s67, 8192
    buffer_load_dwordx4 v242, s[4:7], s72 offen offset:0 nt lds
    buffer_load_dwordx4 v243, s[4:7], s72 offen offset:1024 nt lds
    buffer_load_dwordx4 v244, s[4:7], s72 offen offset:2048 nt lds
    buffer_load_dwordx4 v245, s[4:7], s72 offen offset:3072 nt lds
    s_add_u32 m0, s85, 12288
    s_add_u32 s72, s67, 12288
    buffer_load_dwordx4 v242, s[4:7], s72 offen offset:0 nt lds
    buffer_load_dwordx4 v243, s[4:7], s72 offen offset:1024 nt lds
    buffer_load_dwordx4 v244, s[4:7], s72 offen offset:2048 nt lds
    buffer_load_dwordx4 v245, s[4:7], s72 offen offset:3072 nt lds
    s_add_u32 m0, s85, 16384
    s_nop 0
    buffer_load_dwordx4 v246, s[8:11], s67 offen offset:0 nt lds
    buffer_load_dwordx4 v246, s[8:11], s67 offen offset:1024 nt lds
    buffer_load_dwordx4 v246, s[8:11], s67 offen offset:2048 nt lds
    buffer_load_dwordx4 v246, s[8:11], s67 offen offset:3072 nt lds
    s_add_u32 m0, s85, 20480
    s_add_u32 s72, s67, 4096
    buffer_load_dwordx4 v246, s[8:11], s72 offen offset:0 nt lds
    buffer_load_dwordx4 v246, s[8:11], s72 offen offset:1024 nt lds
    buffer_load_dwordx4 v246, s[8:11], s72 offen offset:2048 nt lds
    buffer_load_dwordx4 v246, s[8:11], s72 offen offset:3072 nt lds
    s_add_u32 m0, s85, 24576
    s_add_u32 s72, s67, 8192
    buffer_load_dwordx4 v246, s[8:11], s72 offen offset:0 nt lds
    buffer_load_dwordx4 v246, s[8:11], s72 offen offset:1024 nt lds
    buffer_load_dwordx4 v246, s[8:11], s72 offen offset:2048 nt lds
    buffer_load_dwordx4 v246, s[8:11], s72 offen offset:3072 nt lds
    s_add_u32 m0, s85, 28672
    s_add_u32 s72, s67, 12288
    buffer_load_dwordx4 v246, s[8:11], s72 offen offset:0 nt lds
    buffer_load_dwordx4 v246, s[8:11], s72 offen offset:1024 nt lds
    buffer_load_dwordx4 v246, s[8:11], s72 offen offset:2048 nt lds
    buffer_load_dwordx4 v246, s[8:11], s72 offen offset:3072 nt lds
    s_add_u32 s67, s67, 16384
    s_and_b32 s78, s67, 0x1c000
    s_cselect_b32 s78, 0, 0x20000
    s_sub_u32 s67, s67, s78
    s_add_u32 s85, s85, 32768
    s_cmp_ge_u32 s85, 98304
    s_cselect_b32 s85, s100, s85
    s_waitcnt lgkmcnt(0)
    s_waitcnt vmcnt(32)
    s_barrier
    s_mov_b32 m0, s85
    s_nop 0
    buffer_load_dwordx4 v242, s[4:7], s67 offen offset:0 nt lds
    buffer_load_dwordx4 v243, s[4:7], s67 offen offset:1024 nt lds
    buffer_load_dwordx4 v244, s[4:7], s67 offen offset:2048 nt lds
    buffer_load_dwordx4 v245, s[4:7], s67 offen offset:3072 nt lds
    s_add_u32 m0, s85, 4096
    s_add_u32 s72, s67, 4096
    buffer_load_dwordx4 v242, s[4:7], s72 offen offset:0 nt lds
    buffer_load_dwordx4 v243, s[4:7], s72 offen offset:1024 nt lds
    buffer_load_dwordx4 v244, s[4:7], s72 offen offset:2048 nt lds
    buffer_load_dwordx4 v245, s[4:7], s72 offen offset:3072 nt lds
    s_add_u32 m0, s85, 8192
    s_add_u32 s72, s67, 8192
    buffer_load_dwordx4 v242, s[4:7], s72 offen offset:0 nt lds
    buffer_load_dwordx4 v243, s[4:7], s72 offen offset:1024 nt lds
    buffer_load_dwordx4 v244, s[4:7], s72 offen offset:2048 nt lds
    buffer_load_dwordx4 v245, s[4:7], s72 offen offset:3072 nt lds
    s_add_u32 m0, s85, 12288
    s_add_u32 s72, s67, 12288
    buffer_load_dwordx4 v242, s[4:7], s72 offen offset:0 nt lds
    buffer_load_dwordx4 v243, s[4:7], s72 offen offset:1024 nt lds
    buffer_load_dwordx4 v244, s[4:7], s72 offen offset:2048 nt lds
    buffer_load_dwordx4 v245, s[4:7], s72 offen offset:3072 nt lds
    s_add_u32 m0, s85, 16384
    s_nop 0
    buffer_load_dwordx4 v246, s[8:11], s67 offen offset:0 nt lds
    buffer_load_dwordx4 v246, s[8:11], s67 offen offset:1024 nt lds
    buffer_load_dwordx4 v246, s[8:11], s67 offen offset:2048 nt lds
    buffer_load_dwordx4 v246, s[8:11], s67 offen offset:3072 nt lds
    s_add_u32 m0, s85, 20480
    s_add_u32 s72, s67, 4096
    buffer_load_dwordx4 v246, s[8:11], s72 offen offset:0 nt lds
    buffer_load_dwordx4 v246, s[8:11], s72 offen offset:1024 nt lds
    buffer_load_dwordx4 v246, s[8:11], s72 offen offset:2048 nt lds
    buffer_load_dwordx4 v246, s[8:11], s72 offen offset:3072 nt lds
    s_add_u32 m0, s85, 24576
    s_add_u32 s72, s67, 8192
    buffer_load_dwordx4 v246, s[8:11], s72 offen offset:0 nt lds
    buffer_load_dwordx4 v246, s[8:11], s72 offen offset:1024 nt lds
    buffer_load_dwordx4 v246, s[8:11], s72 offen offset:2048 nt lds
    buffer_load_dwordx4 v246, s[8:11], s72 offen offset:3072 nt lds
    s_add_u32 m0, s85, 28672
    s_add_u32 s72, s67, 12288
    buffer_load_dwordx4 v246, s[8:11], s72 offen offset:0 nt lds
    buffer_load_dwordx4 v246, s[8:11], s72 offen offset:1024 nt lds
    buffer_load_dwordx4 v246, s[8:11], s72 offen offset:2048 nt lds
    buffer_load_dwordx4 v246, s[8:11], s72 offen offset:3072 nt lds
    s_add_u32 s67, s67, 16384
    s_and_b32 s78, s67, 0x1c000
    s_cselect_b32 s78, 0, 0x20000
    s_sub_u32 s67, s67, s78
    s_add_u32 s85, s85, 32768
    s_cmp_ge_u32 s85, 98304
    s_cselect_b32 s85, s100, s85
    s_waitcnt lgkmcnt(0)
    s_waitcnt vmcnt(32)
    s_barrier
    v_lshrrev_b32 v242, 5, v240
    v_mul_u32_u24 v242, 1280, v242
    v_and_b32 v243, 16, v240
    v_lshl_add_u32 v242, v243, 3, v242
    s_mul_i32 s72, s64, 163840
    s_mul_i32 s78, s62, 40960
    s_add_u32 s72, s72, s78
    buffer_load_dword v255, v242, s[20:23], s72 offen offset:512
    buffer_load_dword v255, v242, s[20:23], s72 offen offset:768
    buffer_load_dword v255, v242, s[20:23], s72 offen offset:1024
    v_add_u32 v241, 65536, v240
    ds_write_b128 v241, v[0:3] offset:0
    ds_write_b128 v241, v[4:7] offset:1024
    ds_write_b128 v241, v[8:11] offset:2048
    ds_write_b128 v241, v[12:15] offset:3072
    ds_write_b128 v241, v[16:19] offset:4096
    ds_write_b128 v241, v[20:23] offset:5120
    ds_write_b128 v241, v[24:27] offset:6144
    ds_write_b128 v241, v[28:31] offset:7168
    ds_write_b128 v241, v[32:35] offset:8192
    ds_write_b128 v241, v[36:39] offset:9216
    ds_write_b128 v241, v[40:43] offset:10240
    ds_write_b128 v241, v[44:47] offset:11264
    ds_write_b128 v241, v[48:51] offset:12288
    ds_write_b128 v241, v[52:55] offset:13312
    ds_write_b128 v241, v[56:59] offset:14336
    ds_write_b128 v241, v[60:63] offset:15360
    ds_write_b128 v241, v[64:67] offset:16384
    ds_write_b128 v241, v[68:71] offset:17408
    ds_write_b128 v241, v[72:75] offset:18432
    ds_write_b128 v241, v[76:79] offset:19456
    ds_write_b128 v241, v[80:83] offset:20480
    ds_write_b128 v241, v[84:87] offset:21504
    ds_write_b128 v241, v[88:91] offset:22528
    ds_write_b128 v241, v[92:95] offset:23552
    s_waitcnt lgkmcnt(0)
    s_waitcnt vmcnt(3)
    s_barrier
    s_waitcnt lgkmcnt(0)
    s_barrier
    s_barrier
    s_branch L_tb
L_park:
    s_cmp_eq_u32 s77, 17
    s_cbranch_scc1 L_park1
L_park0:
    ds_read_b128 v[0:3], v241 offset:0
    ds_read_b128 v[4:7], v241 offset:1024
    ds_read_b128 v[8:11], v241 offset:2048
    ds_read_b128 v[12:15], v241 offset:3072
    ds_read_b128 v[16:19], v241 offset:4096
    ds_read_b128 v[20:23], v241 offset:5120
    ds_read_b128 v[24:27], v241 offset:6144
    ds_read_b128 v[28:31], v241 offset:7168
    ds_read_b128 v[32:35], v241 offset:8192
    ds_read_b128 v[36:39], v241 offset:9216
    ds_read_b128 v[40:43], v241 offset:10240
    ds_read_b128 v[44:47], v241 offset:11264
    ds_read_b128 v[48:51], v241 offset:12288
    ds_read_b128 v[52:55], v241 offset:13312
    ds_read_b128 v[56:59], v241 offset:14336
    ds_read_b128 v[60:63], v241 offset:15360
    ds_read_b128 v[64:67], v241 offset:16384
    ds_read_b128 v[68:71], v241 offset:17408
    ds_read_b128 v[72:75], v241 offset:18432
    ds_read_b128 v[76:79], v241 offset:19456
    ds_read_b128 v[80:83], v241 offset:20480
    ds_read_b128 v[84:87], v241 offset:21504
    ds_read_b128 v[88:91], v241 offset:22528
    ds_read_b128 v[92:95], v241 offset:23552
    s_add_u32 s84, s84, 8
    s_waitcnt lgkmcnt(0)
    s_branch L_ld_mb
L_park1:
    ds_read_b128 v[96:99], v241 offset:0
    ds_read_b128 v[100:103], v241 offset:1024
    ds_read_b128 v[104:107], v241 offset:2048
    ds_read_b128 v[108:111], v241 offset:3072
    ds_read_b128 v[112:115], v241 offset:4096
    ds_read_b128 v[116:119], v241 offset:5120
    ds_read_b128 v[120:123], v241 offset:6144
    ds_read_b128 v[124:127], v241 offset:7168
    ds_read_b128 v[128:131], v241 offset:8192
    ds_read_b128 v[132:135], v241 offset:9216
    ds_read_b128 v[136:139], v241 offset:10240
    ds_read_b128 v[140:143], v241 offset:11264
    ds_read_b128 v[144:147], v241 offset:12288
    ds_read_b128 v[148:151], v241 offset:13312
    ds_read_b128 v[152:155], v241 offset:14336
    ds_read_b128 v[156:159], v241 offset:15360
    ds_read_b128 v[160:163], v241 offset:16384
    ds_read_b128 v[164:167], v241 offset:17408
    ds_read_b128 v[168:171], v241 offset:18432
    ds_read_b128 v[172:175], v241 offset:19456
    ds_read_b128 v[176:179], v241 offset:20480
    ds_read_b128 v[180:183], v241 offset:21504
    ds_read_b128 v[184:187], v241 offset:22528
    ds_read_b128 v[188:191], v241 offset:23552
    s_add_u32 s84, s84, 8
    s_waitcnt lgkmcnt(0)
    s_branch L_ld_mb
L_rest:
    s_mov_b32 s6, 67108864
    s_mov_b32 s7, 0x20000
    s_mov_b32 s10, 67108864
    s_mov_b32 s11, 0x20000
    s_mov_b32 s22, 5242880
    s_mov_b32 s23, 0x20000
    s_mov_b64 s[28:29], s[56:57]
    s_mov_b32 s30, 3932160
    s_mov_b32 s31, 0x20000
    s_mov_b64 s[24:25], s[60:61]
    s_mov_b32 s26, 293339136
    s_mov_b32 s27, 0x20000
    s_and_b32 s5, s5, 0xffff
    s_and_b32 s9, s9, 0xffff
    s_and_b32 s21, s21, 0xffff
    s_and_b32 s29, s29, 0xffff
    s_and_b32 s25, s25, 0xffff
    s_mov_b64 s[32:33], s[58:59]
    v_lshrrev_b32 v1, 5, v0
    v_bfe_u32 v3, v0, 2, 2
    v_lshl_add_u32 v2, v1, 3, v3
    v_lshlrev_b32 v2, 8, v2
    v_bfe_u32 v4, v0, 4, 1
    v_lshl_add_u32 v2, v4, 5, v2
    v_and_b32 v4, 1, v0
    v_lshl_add_u32 v2, v4, 4, v2
    v_bfe_u32 v4, v0, 1, 1
    v_lshl_add_u32 v2, v4, 3, v2
    v_and_b32 v5, 31, v0
    v_bfe_u32 v6, v0, 1, 3
    v_xor_b32 v6, v6, v1
    v_lshlrev_b32 v6, 4, v6
    v_lshl_add_u32 v6, v5, 7, v6
    s_lshl_b32 s72, s79, 12
    s_add_u32 s72, s72, 81920
    v_add_u32 v6, s72, v6
    s_lshl_b32 s72, s79, 10
    s_add_u32 s72, s72, 139264
    v_lshlrev_b32 v7, 4, v0
    v_add_u32 v7, s72, v7
    s_mov_b32 s86, 0x3e0293ee
    s_mov_b32 s87, 0x3e0293ee
    s_cmp_ge_u32 s3, 4
    s_cbranch_scc1 L_qp
L_att:
    s_setprio 1
    v_xor_b32 v5, 0, v3
    v_lshl_add_u32 v224, v5, 6, v2
    v_add_u32 v224, 65536, v224
    v_xor_b32 v5, 1, v3
    v_lshl_add_u32 v225, v5, 6, v2
    v_add_u32 v225, 65536, v225
    v_xor_b32 v5, 2, v3
    v_lshl_add_u32 v226, v5, 6, v2
    v_add_u32 v226, 65536, v226
    v_xor_b32 v5, 3, v3
    v_lshl_add_u32 v227, v5, 6, v2
    v_add_u32 v227, 65536, v227
    v_xor_b32 v228, 0, v6
    v_xor_b32 v229, 32, v6
    v_xor_b32 v230, 64, v6
    v_xor_b32 v231, 96, v6
    v_mov_b32 v236, v7
    v_and_b32 v5, 0x13, v0
    v_bfe_u32 v6, v0, 2, 1
    v_lshl_or_b32 v5, v6, 3, v5
    v_bfe_u32 v6, v0, 3, 1
    v_lshl_or_b32 v5, v6, 2, v5
    v_and_b32 v6, 15, v5
    v_xor_b32 v6, v6, v1
    v_lshlrev_b32 v6, 4, v6
    v_lshl_add_u32 v6, v5, 8, v6
    v_xor_b32 v216, 0, v6
    v_xor_b32 v217, 32, v6
    v_xor_b32 v218, 64, v6
    v_xor_b32 v219, 96, v6
    v_xor_b32 v220, 128, v6
    v_xor_b32 v221, 160, v6
    v_xor_b32 v222, 192, v6
    v_xor_b32 v223, 224, v6
    s_mov_b32 s88, 0x42000000
    s_mov_b32 s81, 65536
    s_barrier
L_att_q0:
    ds_read_b128 v[96:99], v228
    ds_read_b64_tr_b16 v[128:129], v224 offset:0
    ds_read_b64_tr_b16 v[130:131], v224 offset:1024
    ds_read_b64_tr_b16 v[132:133], v225 offset:0
    ds_read_b64_tr_b16 v[134:135], v225 offset:1024
    ds_read_b64_tr_b16 v[136:137], v226 offset:0
    ds_read_b64_tr_b16 v[138:139], v226 offset:1024
    ds_read_b64_tr_b16 v[140:141], v227 offset:0
    ds_read_b64_tr_b16 v[142:143], v227 offset:1024
    ds_read_b128 v[100:103], v229
    ds_read_b64_tr_b16 v[144:145], v224 offset:4096
    ds_read_b64_tr_b16 v[146:147], v224 offset:5120
    ds_read_b64_tr_b16 v[148:149], v225 offset:4096
    ds_read_b64_tr_b16 v[150:151], v225 offset:5120
    ds_read_b64_tr_b16 v[152:153], v226 offset:4096
    ds_read_b64_tr_b16 v[154:155], v226 offset:5120
    ds_read_b64_tr_b16 v[156:157], v227 offset:4096
    ds_read_b64_tr_b16 v[158:159], v227 offset:5120
    s_waitcnt lgkmcnt(9)
    v_mfma_f32_32x32x16_bf16 v[112:127], v[128:131], v[96:99], 0
    ds_read_b128 v[104:107], v230
    ds_read_b64_tr_b16 v[160:161], v224 offset:8192
    ds_read_b64_tr_b16 v[162:163], v224 offset:9216
    ds_read_b64_tr_b16 v[164:165], v225 offset:8192
    ds_read_b64_tr_b16 v[166:167], v225 offset:9216
    ds_read_b64_tr_b16 v[168:169], v226 offset:8192
    v_mfma_f32_32x32x16_bf16 v[192:207], v[132:135], v[96:99], 0
    ds_read_b64_tr_b16 v[170:171], v226 offset:9216
    ds_read_b64_tr_b16 v[172:173], v227 offset:8192
    ds_read_b64_tr_b16 v[174:175], v227 offset:9216
    ds_read_b128 v[108:111], v231
    ds_read_b64_tr_b16 v[176:177], v224 offset:12288
    ds_read_b64_tr_b16 v[178:179], v224 offset:13312
    v_mfma_f32_32x32x16_bf16 v[64:79], v[136:139], v[96:99], 0
    ds_read_b64_tr_b16 v[180:181], v225 offset:12288
    ds_read_b64_tr_b16 v[182:183], v225 offset:13312
    ds_read_b64_tr_b16 v[184:185], v226 offset:12288
    ds_read_b64_tr_b16 v[186:187], v226 offset:13312
    ds_read_b64_tr_b16 v[188:189], v227 offset:12288
    ds_read_b64_tr_b16 v[190:191], v227 offset:13312
    v_mfma_f32_32x32x16_bf16 v[80:95], v[140:143], v[96:99], 0
    s_waitcnt lgkmcnt(14)
    v_mfma_f32_32x32x16_bf16 v[112:127], v[144:147], v[100:103], v[112:127]
    s_add_u32 s72, s81, 28672
    s_cmp_eq_u32 s72, 151552
    s_cselect_b32 s72, 65536, s72
    s_sub_u32 s80, s72, s81
    s_mov_b32 s81, s72
    v_mfma_f32_32x32x16_bf16 v[192:207], v[148:151], v[100:103], v[192:207]
    v_add_u32 v228, s80, v228
    v_add_u32 v229, s80, v229
    v_add_u32 v230, s80, v230
    v_add_u32 v231, s80, v231
    v_mfma_f32_32x32x16_bf16 v[64:79], v[152:155], v[100:103], v[64:79]
    v_add_u32 v224, s80, v224
    v_add_u32 v225, s80, v225
    v_add_u32 v226, s80, v226
    v_add_u32 v227, s80, v227
    v_mfma_f32_32x32x16_bf16 v[80:95], v[156:159], v[100:103], v[80:95]
    s_mov_b32 s35, 9
    s_waitcnt lgkmcnt(0)
    s_barrier
L_att_q:
    v_mfma_f32_32x32x16_bf16 v[112:127], v[160:163], v[104:107], v[112:127]
    ds_read_b128 v[96:99], v228
    ds_read_b64_tr_b16 v[128:129], v224 offset:0
    ds_read_b64_tr_b16 v[130:131], v224 offset:1024
    v_mfma_f32_32x32x16_bf16 v[192:207], v[164:167], v[104:107], v[192:207]
    ds_read_b64_tr_b16 v[132:133], v225 offset:0
    ds_read_b64_tr_b16 v[134:135], v225 offset:1024
    ds_read_b64_tr_b16 v[136:137], v226 offset:0
    v_mfma_f32_32x32x16_bf16 v[64:79], v[168:171], v[104:107], v[64:79]
    ds_read_b64_tr_b16 v[138:139], v226 offset:1024
    ds_read_b64_tr_b16 v[140:141], v227 offset:0
    ds_read_b64_tr_b16 v[142:143], v227 offset:1024
    v_mfma_f32_32x32x16_bf16 v[80:95], v[172:175], v[104:107], v[80:95]
    ds_read_b128 v[100:103], v229
    ds_read_b64_tr_b16 v[144:145], v224 offset:4096
    ds_read_b64_tr_b16 v[146:147], v224 offset:5120
    v_mfma_f32_32x32x16_bf16 v[112:127], v[176:179], v[108:111], v[112:127]
    ds_read_b64_tr_b16 v[148:149], v225 offset:4096
    ds_read_b64_tr_b16 v[150:151], v225 offset:5120
    ds_read_b64_tr_b16 v[152:153], v226 offset:4096
    v_mfma_f32_32x32x16_bf16 v[192:207], v[180:183], v[108:111], v[192:207]
    ds_read_b64_tr_b16 v[154:155], v226 offset:5120
    ds_read_b64_tr_b16 v[156:157], v227 offset:4096
    ds_read_b64_tr_b16 v[158:159], v227 offset:5120
    v_mfma_f32_32x32x16_bf16 v[64:79], v[184:187], v[108:111], v[64:79]
    ds_read_b128 v[104:107], v230
    ds_read_b64_tr_b16 v[160:161], v224 offset:8192
    ds_read_b64_tr_b16 v[162:163], v224 offset:9216
    v_mfma_f32_32x32x16_bf16 v[80:95], v[188:191], v[108:111], v[80:95]
    ds_read_b64_tr_b16 v[164:165], v225 offset:8192
    ds_read_b64_tr_b16 v[166:167], v225 offset:9216
    ds_read_b64_tr_b16 v[168:169], v226 offset:8192
    s_waitcnt lgkmcnt(14)
    v_mfma_f32_32x32x16_bf16 v[112:127], v[128:131], v[96:99], v[112:127]
    ds_read_b64_tr_b16 v[170:171], v226 offset:9216
    ds_read_b64_tr_b16 v[172:173], v227 offset:8192
    ds_read_b64_tr_b16 v[174:175], v227 offset:9216
    v_mfma_f32_32x32x16_bf16 v[192:207], v[132:135], v[96:99], v[192:207]
    ds_read_b128 v[108:111], v231
    ds_read_b64_tr_b16 v[176:177], v224 offset:12288
    ds_read_b64_tr_b16 v[178:179], v224 offset:13312
    v_mfma_f32_32x32x16_bf16 v[64:79], v[136:139], v[96:99], v[64:79]
    ds_read_b64_tr_b16 v[180:181], v225 offset:12288
    ds_read_b64_tr_b16 v[182:183], v225 offset:13312
    ds_read_b64_tr_b16 v[184:185], v226 offset:12288
    v_mfma_f32_32x32x16_bf16 v[80:95], v[140:143], v[96:99], v[80:95]
    ds_read_b64_tr_b16 v[186:187], v226 offset:13312
    ds_read_b64_tr_b16 v[188:189], v227 offset:12288
    ds_read_b64_tr_b16 v[190:191], v227 offset:13312
    s_waitcnt lgkmcnt(14)
    v_mfma_f32_32x32x16_bf16 v[112:127], v[144:147], v[100:103], v[112:127]
    s_add_u32 s72, s81, 28672
    s_cmp_eq_u32 s72, 151552
    s_cselect_b32 s72, 65536, s72
    s_sub_u32 s80, s72, s81
    s_mov_b32 s81, s72
    v_mfma_f32_32x32x16_bf16 v[192:207], v[148:151], v[100:103], v[192:207]
    v_add_u32 v228, s80, v228
    v_add_u32 v229, s80, v229
    v_add_u32 v230, s80, v230
    v_add_u32 v231, s80, v231
    v_mfma_f32_32x32x16_bf16 v[64:79], v[152:155], v[100:103], v[64:79]
    v_add_u32 v224, s80, v224
    v_add_u32 v225, s80, v225
    v_add_u32 v226, s80, v226
    v_add_u32 v227, s80, v227
    v_mfma_f32_32x32x16_bf16 v[80:95], v[156:159], v[100:103], v[80:95]
    s_waitcnt lgkmcnt(0)
    s_sub_u32 s35, s35, 1
    s_cmp_lg_u32 s35, 0
    s_barrier
    s_cbranch_scc1 L_att_q
L_att_a0:
    v_mfma_f32_32x32x16_bf16 v[64:79], v[168:171], v[104:107], v[64:79]
    s_mov_b32 s81, 0
    v_mfma_f32_32x32x16_bf16 v[64:79], v[184:187], v[108:111], v[64:79]
    ds_read_b128 v[144:147], v220 offset:0
    ds_read_b128 v[148:151], v221 offset:0
    v_mfma_f32_32x32x16_bf16 v[80:95], v[172:175], v[104:107], v[80:95]
    ds_read_b128 v[152:155], v222 offset:0
    ds_read_b128 v[156:159], v223 offset:0
    v_mfma_f32_32x32x16_bf16 v[80:95], v[188:191], v[108:111], v[80:95]
    ds_read_b128 v[128:131], v216 offset:0
    ds_read_b128 v[132:135], v217 offset:0
    ds_read_b128 v[136:139], v218 offset:0
    ds_read_b128 v[140:143], v219 offset:0
    v_mov_b32 v232, 0
    v_mov_b32 v233, 0
    v_mfma_f32_32x32x16_bf16 v[112:127], v[160:163], v[104:107], v[112:127]
    v_mul_f32 v64, s86, v64
    v_mul_f32 v65, s86, v65
    v_mul_f32 v66, s86, v66
    v_mul_f32 v67, s86, v67
    v_mul_f32 v68, s86, v68
    v_mul_f32 v69, s86, v69
    v_mfma_f32_32x32x16_bf16 v[112:127], v[176:179], v[108:111], v[112:127]
    v_mul_f32 v70, s86, v70
    v_mul_f32 v71, s86, v71
    v_cvt_pk_bf16_f32 v64, v64, v65
    v_cvt_pk_bf16_f32 v65, v66, v67
    v_cvt_pk_bf16_f32 v66, v68, v69
    v_cvt_pk_bf16_f32 v67, v70, v71
    v_mfma_f32_32x32x16_bf16 v[192:207], v[164:167], v[104:107], v[192:207]
    v_mul_f32 v72, s86, v72
    v_mul_f32 v73, s86, v73
    v_mul_f32 v74, s86, v74
    v_mul_f32 v75, s86, v75
    v_mul_f32 v76, s86, v76
    v_mul_f32 v77, s86, v77
    v_mfma_f32_32x32x16_bf16 v[192:207], v[180:183], v[108:111], v[192:207]
    v_mul_f32 v78, s86, v78
    v_mul_f32 v79, s86, v79
    v_cvt_pk_bf16_f32 v68, v72, v73
    v_cvt_pk_bf16_f32 v69, v74, v75
    v_cvt_pk_bf16_f32 v70, v76, v77
    v_cvt_pk_bf16_f32 v71, v78, v79
    v_subrev_u32 v224, 94208, v224
    v_subrev_u32 v225, 94208, v225
    v_subrev_u32 v226, 94208, v226
    v_subrev_u32 v227, 94208, v227
    s_waitcnt lgkmcnt(0)
    v_mfma_f32_32x32x16_bf16 v[96:111], v[144:147], v[64:67], 0
    ds_read_b128 v[144:147], v220 offset:8192
    ds_read_b64_tr_b16 v[160:161], v224 offset:16384
    ds_read_b64_tr_b16 v[162:163], v224 offset:17408
    v_mul_f32 v80, s86, v80
    v_mul_f32 v81, s86, v81
    v_mul_f32 v82, s86, v82
    v_mul_f32 v83, s86, v83
    v_mul_f32 v84, s86, v84
    v_mul_f32 v85, s86, v85
    v_mfma_f32_32x32x16_bf16 v[96:111], v[148:151], v[68:71], v[96:111]
    ds_read_b128 v[148:151], v221 offset:8192
    ds_read_b64_tr_b16 v[164:165], v225 offset:16384
    ds_read_b64_tr_b16 v[166:167], v225 offset:17408
    v_mul_f32 v86, s86, v86
    v_mul_f32 v87, s86, v87
    v_cvt_pk_bf16_f32 v80, v80, v81
    v_cvt_pk_bf16_f32 v81, v82, v83
    v_cvt_pk_bf16_f32 v82, v84, v85
    v_cvt_pk_bf16_f32 v83, v86, v87
    s_nop 1
    v_mfma_f32_32x32x16_bf16 v[96:111], v[152:155], v[80:83], v[96:111]
    ds_read_b128 v[152:155], v222 offset:8192
    ds_read_b64_tr_b16 v[168:169], v226 offset:16384
    ds_read_b64_tr_b16 v[170:171], v226 offset:17408
    v_mul_f32 v88, s86, v88
    v_mul_f32 v89, s86, v89
    v_mul_f32 v90, s86, v90
    v_mul_f32 v91, s86, v91
    v_mul_f32 v92, s86, v92
    v_mul_f32 v93, s86, v93
    v_mul_f32 v94, s86, v94
    v_mul_f32 v95, s86, v95
    v_cvt_pk_bf16_f32 v84, v88, v89
    v_cvt_pk_bf16_f32 v85, v90, v91
    v_cvt_pk_bf16_f32 v86, v92, v93
    v_cvt_pk_bf16_f32 v87, v94, v95
    s_nop 1
    v_mfma_f32_32x32x16_bf16 v[96:111], v[156:159], v[84:87], v[96:111]
    ds_read_b128 v[156:159], v223 offset:8192
    ds_read_b64_tr_b16 v[172:173], v227 offset:16384
    ds_read_b64_tr_b16 v[174:175], v227 offset:17408
    v_mul_f32 v112, s86, v112
    v_mul_f32 v113, s86, v113
    v_mul_f32 v114, s86, v114
    v_mul_f32 v115, s86, v115
    v_mul_f32 v116, s86, v116
    v_mul_f32 v117, s86, v117
    v_mul_f32 v118, s86, v118
    v_mul_f32 v119, s86, v119
    v_cvt_pk_bf16_f32 v72, v112, v113
    v_cvt_pk_bf16_f32 v73, v114, v115
    v_cvt_pk_bf16_f32 v74, v116, v117
    v_cvt_pk_bf16_f32 v75, v118, v119
    s_nop 1
    v_mfma_f32_32x32x16_bf16 v[96:111], v[128:131], v[72:75], v[96:111]
    ds_read_b128 v[128:131], v216 offset:8192
    ds_read_b64_tr_b16 v[176:177], v224 offset:20480
    ds_read_b64_tr_b16 v[178:179], v224 offset:21504
    v_mul_f32 v120, s86, v120
    v_mul_f32 v121, s86, v121
    v_mul_f32 v122, s86, v122
    v_mul_f32 v123, s86, v123
    v_mul_f32 v124, s86, v124
    v_mul_f32 v125, s86, v125
    v_mul_f32 v126, s86, v126
    v_mul_f32 v127, s86, v127
    v_cvt_pk_bf16_f32 v76, v120, v121
    v_cvt_pk_bf16_f32 v77, v122, v123
    v_cvt_pk_bf16_f32 v78, v124, v125
    v_cvt_pk_bf16_f32 v79, v126, v127
    s_nop 1
    v_mfma_f32_32x32x16_bf16 v[96:111], v[132:135], v[76:79], v[96:111]
    ds_read_b128 v[132:135], v217 offset:8192
    ds_read_b64_tr_b16 v[180:181], v225 offset:20480
    ds_read_b64_tr_b16 v[182:183], v225 offset:21504
    v_mul_f32 v192, s86, v192
    v_mul_f32 v193, s86, v193
    v_mul_f32 v194, s86, v194
    v_mul_f32 v195, s86, v195
    v_mul_f32 v196, s86, v196
    v_mul_f32 v197, s86, v197
    v_mul_f32 v198, s86, v198
    v_mul_f32 v199, s86, v199
    v_cvt_pk_bf16_f32 v88, v192, v193
    v_cvt_pk_bf16_f32 v89, v194, v195
    v_cvt_pk_bf16_f32 v90, v196, v197
    v_cvt_pk_bf16_f32 v91, v198, v199
    s_nop 1
    v_mfma_f32_32x32x16_bf16 v[96:111], v[136:139], v[88:91], v[96:111]
    ds_read_b128 v[136:139], v218 offset:8192
    ds_read_b64_tr_b16 v[184:185], v226 offset:20480
    ds_read_b64_tr_b16 v[186:187], v226 offset:21504
    v_mul_f32 v200, s86, v200
    v_mul_f32 v201, s86, v201
    v_mul_f32 v202, s86, v202
    v_mul_f32 v203, s86, v203
    v_mul_f32 v204, s86, v204
    v_mul_f32 v205, s86, v205
    v_mul_f32 v206, s86, v206
    v_mul_f32 v207, s86, v207
    v_cvt_pk_bf16_f32 v92, v200, v201
    v_cvt_pk_bf16_f32 v93, v202, v203
    v_cvt_pk_bf16_f32 v94, v204, v205
    v_cvt_pk_bf16_f32 v95, v206, v207
    s_nop 1
    v_mfma_f32_32x32x16_bf16 v[96:111], v[140:143], v[92:95], v[96:111]
    ds_read_b128 v[140:143], v219 offset:8192
    ds_read_b64_tr_b16 v[188:189], v227 offset:20480
    ds_read_b64_tr_b16 v[190:191], v227 offset:21504
    s_nop 8
    v_max3_f32 v234, v96, v97, v98
    v_max3_f32 v234, v234, v99, v100
    v_max3_f32 v234, v234, v101, v102
    v_max3_f32 v234, v234, v103, v104
    v_max3_f32 v234, v234, v105, v106
    v_max3_f32 v234, v234, v107, v108
    v_max3_f32 v234, v234, v109, v110
    v_max_f32 v234, v234, v111
    v_mov_b32 v235, v234
    s_nop 1
    v_permlane32_swap_b32 v234, v235
    v_max_f32 v234, v234, v235
    v_mul_f32 v192, -1.0, v234
    v_mul_f32 v193, -1.0, v234
    v_mul_f32 v194, -1.0, v234
    v_mul_f32 v195, -1.0, v234
    v_mul_f32 v196, -1.0, v234
    v_mul_f32 v197, -1.0, v234
    v_mul_f32 v198, -1.0, v234
    v_mul_f32 v199, -1.0, v234
    v_mul_f32 v200, -1.0, v234
    v_mul_f32 v201, -1.0, v234
    v_mul_f32 v202, -1.0, v234
    v_mul_f32 v203, -1.0, v234
    v_mul_f32 v204, -1.0, v234
    v_mul_f32 v205, -1.0, v234
    v_mul_f32 v206, -1.0, v234
    v_mul_f32 v207, -1.0, v234
    v_sub_f32 v96, v96, v234
    v_sub_f32 v97, v97, v234
    v_sub_f32 v98, v98, v234
    v_sub_f32 v99, v99, v234
    s_waitcnt lgkmcnt(2)
    v_mfma_f32_32x32x16_bf16 v[112:127], v[128:131], v[72:75], v[192:207]
    v_sub_f32 v100, v100, v234
    v_sub_f32 v101, v101, v234
    v_exp_f32 v96, v96
    v_exp_f32 v97, v97
    v_exp_f32 v98, v98
    v_mfma_f32_32x32x16_bf16 v[112:127], v[132:135], v[76:79], v[112:127]
    v_sub_f32 v102, v102, v234
    v_sub_f32 v103, v103, v234
    v_exp_f32 v99, v99
    v_cvt_pk_bf16_f32 v208, v96, v97
    v_exp_f32 v100, v100
    v_mfma_f32_32x32x16_bf16 v[112:127], v[136:139], v[88:91], v[112:127]
    v_sub_f32 v104, v104, v234
    v_sub_f32 v105, v105, v234
    v_exp_f32 v101, v101
    v_cvt_pk_bf16_f32 v209, v98, v99
    v_exp_f32 v102, v102
    v_mfma_f32_32x32x16_bf16 v[112:127], v[140:143], v[92:95], v[112:127]
    v_sub_f32 v106, v106, v234
    v_sub_f32 v107, v107, v234
    v_exp_f32 v103, v103
    v_cvt_pk_bf16_f32 v210, v100, v101
    v_exp_f32 v104, v104
    v_mfma_f32_32x32x16_bf16 v[112:127], v[144:147], v[64:67], v[112:127]
    v_sub_f32 v108, v108, v234
    v_sub_f32 v109, v109, v234
    v_exp_f32 v105, v105
    v_cvt_pk_bf16_f32 v211, v102, v103
    v_exp_f32 v106, v106
    v_mfma_f32_32x32x16_bf16 v[112:127], v[148:151], v[68:71], v[112:127]
    v_sub_f32 v110, v110, v234
    v_sub_f32 v111, v111, v234
    v_exp_f32 v107, v107
    v_cvt_pk_bf16_f32 v212, v104, v105
    v_exp_f32 v108, v108
    v_mfma_f32_32x32x16_bf16 v[112:127], v[152:155], v[80:83], v[112:127]
    v_exp_f32 v109, v109
    v_cvt_pk_bf16_f32 v213, v106, v107
    v_exp_f32 v110, v110
    v_mfma_f32_32x32x16_bf16 v[112:127], v[156:159], v[84:87], v[112:127]
    v_exp_f32 v111, v111
    v_cvt_pk_bf16_f32 v214, v108, v109
    v_cvt_pk_bf16_f32 v215, v110, v111
    s_waitcnt lgkmcnt(0)
    v_mfma_f32_32x32x16_bf16 v[0:15], v[160:163], v[208:211], 0
    ds_read_b64_tr_b16 v[128:129], v224 offset:24576
    ds_read_b64_tr_b16 v[130:131], v224 offset:25600
    ds_read_b64_tr_b16 v[132:133], v225 offset:24576
    ds_read_b64_tr_b16 v[134:135], v225 offset:25600
    v_add_f32 v232, v232, v96
    v_add_f32 v233, v233, v97
    v_mfma_f32_32x32x16_bf16 v[16:31], v[164:167], v[208:211], 0
    ds_read_b64_tr_b16 v[136:137], v226 offset:24576
    ds_read_b64_tr_b16 v[138:139], v226 offset:25600
    ds_read_b64_tr_b16 v[140:141], v227 offset:24576
    ds_read_b64_tr_b16 v[142:143], v227 offset:25600
    v_add_f32 v232, v232, v98
    v_add_f32 v233, v233, v99
    v_mfma_f32_32x32x16_bf16 v[32:47], v[168:171], v[208:211], 0
    ds_read_b64_tr_b16 v[144:145], v224 offset:28672
    ds_read_b64_tr_b16 v[146:147], v224 offset:29696
    ds_read_b64_tr_b16 v[148:149], v225 offset:28672
    ds_read_b64_tr_b16 v[150:151], v225 offset:29696
    v_add_f32 v232, v232, v100
    v_max3_f32 v234, v112, v113, v114
    v_mfma_f32_32x32x16_bf16 v[48:63], v[172:175], v[208:211], 0
    ds_read_b64_tr_b16 v[152:153], v226 offset:28672
    ds_read_b64_tr_b16 v[154:155], v226 offset:29696
    ds_read_b64_tr_b16 v[156:157], v227 offset:28672
    ds_read_b64_tr_b16 v[158:159], v227 offset:29696
    v_add_f32 v233, v233, v101
    v_max3_f32 v234, v234, v115, v116
    v_mfma_f32_32x32x16_bf16 v[0:15], v[176:179], v[212:215], v[0:15]
    v_add_f32 v232, v232, v102
    v_add_f32 v233, v233, v103
    v_max3_f32 v234, v234, v117, v118
    v_max3_f32 v234, v234, v119, v120
    v_max3_f32 v234, v234, v121, v122
    s_add_u32 s72, s81, 32768
    s_cmp_eq_u32 s72, 98304
    s_cselect_b32 s72, 0, s72
    s_sub_u32 s80, s72, s81
    s_mov_b32 s81, s72
    v_mfma_f32_32x32x16_bf16 v[16:31], v[180:183], v[212:215], v[16:31]
    v_add_f32 v232, v232, v104
    v_add_f32 v233, v233, v105
    v_add_f32 v232, v232, v106
    v_max3_f32 v234, v234, v123, v124
    v_max3_f32 v234, v234, v125, v126
    v_max_f32 v234, v234, v127
    v_add_u32 v216, s80, v216
    v_add_u32 v217, s80, v217
    v_add_u32 v218, s80, v218
    v_add_u32 v219, s80, v219
    v_add_u32 v220, s80, v220
    v_add_u32 v221, s80, v221
    v_add_u32 v222, s80, v222
    v_add_u32 v223, s80, v223
    v_mfma_f32_32x32x16_bf16 v[32:47], v[184:187], v[212:215], v[32:47]
    v_cmp_lt_f32 vcc, s88, v234
    v_add_f32 v233, v233, v107
    v_add_u32 v224, s80, v224
    v_add_u32 v225, s80, v225
    v_add_u32 v226, s80, v226
    v_add_u32 v227, s80, v227
    v_mfma_f32_32x32x16_bf16 v[48:63], v[188:191], v[212:215], v[48:63]
    v_add_f32 v232, v232, v108
    v_add_f32 v233, v233, v109
    v_add_f32 v232, v232, v110
    v_add_f32 v233, v233, v111
    s_mov_b32 s35, 4
    s_cbranch_vccnz L_slow_a0
L_back_a0:
    s_waitcnt lgkmcnt(0)
    s_barrier
L_att_ao:
    ds_read_b128 v[160:163], v216 offset:0
    ds_read_b128 v[164:167], v217 offset:0
    ds_read_b128 v[168:171], v218 offset:0
    ds_read_b128 v[172:175], v219 offset:0
    ds_read_b128 v[176:179], v220 offset:0
    ds_read_b128 v[180:183], v221 offset:0
    ds_read_b128 v[184:187], v222 offset:0
    ds_read_b128 v[188:191], v223 offset:0
    v_exp_f32 v112, v112
    v_exp_f32 v113, v113
    v_exp_f32 v114, v114
    v_exp_f32 v115, v115
    v_cvt_pk_bf16_f32 v208, v112, v113
    v_add_f32 v232, v232, v112
    v_add_f32 v233, v233, v113
    v_exp_f32 v116, v116
    v_exp_f32 v117, v117
    v_cvt_pk_bf16_f32 v209, v114, v115
    v_add_f32 v232, v232, v114
    v_add_f32 v233, v233, v115
    s_waitcnt lgkmcnt(4)
    v_mfma_f32_32x32x16_bf16 v[96:111], v[160:163], v[72:75], v[192:207]
    v_exp_f32 v118, v118
    v_exp_f32 v119, v119
    v_cvt_pk_bf16_f32 v210, v116, v117
    v_mfma_f32_32x32x16_bf16 v[96:111], v[164:167], v[76:79], v[96:111]
    v_add_f32 v232, v232, v116
    v_add_f32 v233, v233, v117
    v_exp_f32 v120, v120
    v_exp_f32 v121, v121
    v_mfma_f32_32x32x16_bf16 v[96:111], v[168:171], v[88:91], v[96:111]
    v_cvt_pk_bf16_f32 v211, v118, v119
    v_add_f32 v232, v232, v118
    v_add_f32 v233, v233, v119
    v_mfma_f32_32x32x16_bf16 v[96:111], v[172:175], v[92:95], v[96:111]
    v_exp_f32 v122, v122
    v_exp_f32 v123, v123
    v_cvt_pk_bf16_f32 v212, v120, v121
    v_add_f32 v232, v232, v120
    s_waitcnt lgkmcnt(0)
    v_mfma_f32_32x32x16_bf16 v[96:111], v[176:179], v[64:67], v[96:111]
    v_add_f32 v233, v233, v121
    v_exp_f32 v124, v124
    v_exp_f32 v125, v125
    v_mfma_f32_32x32x16_bf16 v[96:111], v[180:183], v[68:71], v[96:111]
    v_cvt_pk_bf16_f32 v213, v122, v123
    v_add_f32 v232, v232, v122
    v_add_f32 v233, v233, v123
    v_exp_f32 v126, v126
    v_mfma_f32_32x32x16_bf16 v[96:111], v[184:187], v[80:83], v[96:111]
    v_exp_f32 v127, v127
    v_cvt_pk_bf16_f32 v214, v124, v125
    v_add_f32 v232, v232, v124
    v_mfma_f32_32x32x16_bf16 v[96:111], v[188:191], v[84:87], v[96:111]
    v_add_f32 v233, v233, v125
    v_cvt_pk_bf16_f32 v215, v126, v127
    v_add_f32 v232, v232, v126
    v_add_f32 v233, v233, v127
    v_mfma_f32_32x32x16_bf16 v[0:15], v[128:131], v[208:211], v[0:15]
    ds_read_b128 v[160:163], v216 offset:8192
    ds_read_b128 v[164:167], v217 offset:8192
    ds_read_b64_tr_b16 v[128:129], v224 offset:16384
    ds_read_b64_tr_b16 v[130:131], v224 offset:17408
    s_add_u32 s72, s81, 32768
    s_cmp_eq_u32 s72, 98304
    s_cselect_b32 s72, 0, s72
    v_mfma_f32_32x32x16_bf16 v[16:31], v[132:135], v[208:211], v[16:31]
    ds_read_b128 v[168:171], v218 offset:8192
    ds_read_b128 v[172:175], v219 offset:8192
    ds_read_b64_tr_b16 v[132:133], v225 offset:16384
    ds_read_b64_tr_b16 v[134:135], v225 offset:17408
    v_max3_f32 v234, v96, v97, v98
    v_max3_f32 v234, v234, v99, v100
    v_mfma_f32_32x32x16_bf16 v[32:47], v[136:139], v[208:211], v[32:47]
    ds_read_b128 v[176:179], v220 offset:8192
    ds_read_b128 v[180:183], v221 offset:8192
    ds_read_b64_tr_b16 v[136:137], v226 offset:16384
    ds_read_b64_tr_b16 v[138:139], v226 offset:17408
    v_max3_f32 v234, v234, v101, v102
    v_max3_f32 v234, v234, v103, v104
    v_mfma_f32_32x32x16_bf16 v[48:63], v[140:143], v[208:211], v[48:63]
    ds_read_b128 v[184:187], v222 offset:8192
    ds_read_b128 v[188:191], v223 offset:8192
    ds_read_b64_tr_b16 v[140:141], v227 offset:16384
    ds_read_b64_tr_b16 v[142:143], v227 offset:17408
    v_max3_f32 v234, v234, v105, v106
    v_max3_f32 v234, v234, v107, v108
    v_mfma_f32_32x32x16_bf16 v[0:15], v[144:147], v[212:215], v[0:15]
    ds_read_b64_tr_b16 v[144:145], v224 offset:20480
    ds_read_b64_tr_b16 v[146:147], v224 offset:21504
    v_max3_f32 v234, v234, v109, v110
    v_max_f32 v234, v234, v111
    s_sub_u32 s80, s72, s81
    s_mov_b32 s81, s72
    v_mfma_f32_32x32x16_bf16 v[16:31], v[148:151], v[212:215], v[16:31]
    ds_read_b64_tr_b16 v[148:149], v225 offset:20480
    ds_read_b64_tr_b16 v[150:151], v225 offset:21504
    v_cmp_lt_f32 vcc, s88, v234
    v_add_u32 v216, s80, v216
    v_add_u32 v217, s80, v217
    v_mfma_f32_32x32x16_bf16 v[32:47], v[152:155], v[212:215], v[32:47]
    ds_read_b64_tr_b16 v[152:153], v226 offset:20480
    ds_read_b64_tr_b16 v[154:155], v226 offset:21504
    v_add_u32 v218, s80, v218
    v_add_u32 v219, s80, v219
    v_add_u32 v220, s80, v220
    v_add_u32 v221, s80, v221
    v_mfma_f32_32x32x16_bf16 v[48:63], v[156:159], v[212:215], v[48:63]
    ds_read_b64_tr_b16 v[156:157], v227 offset:20480
    ds_read_b64_tr_b16 v[158:159], v227 offset:21504
    v_add_u32 v222, s80, v222
    v_add_u32 v223, s80, v223
    s_cbranch_vccnz L_slow_ao1
L_back_ao1:
    s_waitcnt lgkmcnt(10)
    v_mfma_f32_32x32x16_bf16 v[112:127], v[160:163], v[72:75], v[192:207]
    v_exp_f32 v96, v96
    v_exp_f32 v97, v97
    v_exp_f32 v98, v98
    v_mfma_f32_32x32x16_bf16 v[112:127], v[164:167], v[76:79], v[112:127]
    v_exp_f32 v99, v99
    v_cvt_pk_bf16_f32 v208, v96, v97
    v_exp_f32 v100, v100
    v_mfma_f32_32x32x16_bf16 v[112:127], v[168:171], v[88:91], v[112:127]
    v_exp_f32 v101, v101
    v_cvt_pk_bf16_f32 v209, v98, v99
    v_exp_f32 v102, v102
    v_mfma_f32_32x32x16_bf16 v[112:127], v[172:175], v[92:95], v[112:127]
    v_exp_f32 v103, v103
    v_cvt_pk_bf16_f32 v210, v100, v101
    v_exp_f32 v104, v104
    v_mfma_f32_32x32x16_bf16 v[112:127], v[176:179], v[64:67], v[112:127]
    v_exp_f32 v105, v105
    v_cvt_pk_bf16_f32 v211, v102, v103
    v_exp_f32 v106, v106
    v_mfma_f32_32x32x16_bf16 v[112:127], v[180:183], v[68:71], v[112:127]
    v_exp_f32 v107, v107
    v_cvt_pk_bf16_f32 v212, v104, v105
    v_exp_f32 v108, v108
    v_mfma_f32_32x32x16_bf16 v[112:127], v[184:187], v[80:83], v[112:127]
    v_exp_f32 v109, v109
    v_cvt_pk_bf16_f32 v213, v106, v107
    v_exp_f32 v110, v110
    v_mfma_f32_32x32x16_bf16 v[112:127], v[188:191], v[84:87], v[112:127]
    v_exp_f32 v111, v111
    v_cvt_pk_bf16_f32 v214, v108, v109
    v_cvt_pk_bf16_f32 v215, v110, v111
    s_waitcnt lgkmcnt(0)
    v_mfma_f32_32x32x16_bf16 v[0:15], v[128:131], v[208:211], v[0:15]
    ds_read_b64_tr_b16 v[160:161], v224 offset:24576
    ds_read_b64_tr_b16 v[162:163], v224 offset:25600
    ds_read_b64_tr_b16 v[164:165], v225 offset:24576
    ds_read_b64_tr_b16 v[166:167], v225 offset:25600
    v_add_f32 v232, v232, v96
    v_add_f32 v233, v233, v97
    v_mfma_f32_32x32x16_bf16 v[16:31], v[132:135], v[208:211], v[16:31]
    ds_read_b64_tr_b16 v[168:169], v226 offset:24576
    ds_read_b64_tr_b16 v[170:171], v226 offset:25600
    ds_read_b64_tr_b16 v[172:173], v227 offset:24576
    ds_read_b64_tr_b16 v[174:175], v227 offset:25600
    v_add_f32 v232, v232, v98
    v_add_f32 v233, v233, v99
    v_mfma_f32_32x32x16_bf16 v[32:47], v[136:139], v[208:211], v[32:47]
    ds_read_b64_tr_b16 v[176:177], v224 offset:28672
    ds_read_b64_tr_b16 v[178:179], v224 offset:29696
    ds_read_b64_tr_b16 v[180:181], v225 offset:28672
    ds_read_b64_tr_b16 v[182:183], v225 offset:29696
    v_add_f32 v232, v232, v100
    v_max3_f32 v234, v112, v113, v114
    v_mfma_f32_32x32x16_bf16 v[48:63], v[140:143], v[208:211], v[48:63]
    ds_read_b64_tr_b16 v[184:185], v226 offset:28672
    ds_read_b64_tr_b16 v[186:187], v226 offset:29696
    ds_read_b64_tr_b16 v[188:189], v227 offset:28672
    ds_read_b64_tr_b16 v[190:191], v227 offset:29696
    v_add_f32 v233, v233, v101
    v_max3_f32 v234, v234, v115, v116
    v_mfma_f32_32x32x16_bf16 v[0:15], v[144:147], v[212:215], v[0:15]
    v_add_f32 v232, v232, v102
    v_add_f32 v233, v233, v103
    v_max3_f32 v234, v234, v117, v118
    v_max3_f32 v234, v234, v119, v120
    v_max3_f32 v234, v234, v121, v122
    v_mfma_f32_32x32x16_bf16 v[16:31], v[148:151], v[212:215], v[16:31]
    v_add_f32 v232, v232, v104
    v_add_f32 v233, v233, v105
    v_add_f32 v232, v232, v106
    v_max3_f32 v234, v234, v123, v124
    v_max3_f32 v234, v234, v125, v126
    v_max_f32 v234, v234, v127
    v_mfma_f32_32x32x16_bf16 v[32:47], v[152:155], v[212:215], v[32:47]
    v_cmp_lt_f32 vcc, s88, v234
    v_add_f32 v233, v233, v107
    v_add_u32 v224, s80, v224
    v_add_u32 v225, s80, v225
    v_add_u32 v226, s80, v226
    v_add_u32 v227, s80, v227
    v_mfma_f32_32x32x16_bf16 v[48:63], v[156:159], v[212:215], v[48:63]
    v_add_f32 v232, v232, v108
    v_add_f32 v233, v233, v109
    v_add_f32 v232, v232, v110
    v_add_f32 v233, v233, v111
    s_cbranch_vccnz L_slow_ao2
L_back_ao2:
    s_waitcnt lgkmcnt(0)
    s_sub_u32 s35, s35, 1
    s_cmp_eq_u32 s35, 0
    s_barrier
    s_cbranch_scc1 L_att_drain
L_att_ae:
    ds_read_b128 v[128:131], v216 offset:0
    ds_read_b128 v[132:135], v217 offset:0
    ds_read_b128 v[136:139], v218 offset:0
    ds_read_b128 v[140:143], v219 offset:0
    ds_read_b128 v[144:147], v220 offset:0
    ds_read_b128 v[148:151], v221 offset:0
    ds_read_b128 v[152:155], v222 offset:0
    ds_read_b128 v[156:159], v223 offset:0
    v_exp_f32 v112, v112
    v_exp_f32 v113, v113
    v_exp_f32 v114, v114
    v_exp_f32 v115, v115
    v_cvt_pk_bf16_f32 v208, v112, v113
    v_add_f32 v232, v232, v112
    v_add_f32 v233, v233, v113
    v_exp_f32 v116, v116
    v_exp_f32 v117, v117
    v_cvt_pk_bf16_f32 v209, v114, v115
    v_add_f32 v232, v232, v114
    v_add_f32 v233, v233, v115
    s_waitcnt lgkmcnt(4)
    v_mfma_f32_32x32x16_bf16 v[96:111], v[128:131], v[72:75], v[192:207]
    v_exp_f32 v118, v118
    v_exp_f32 v119, v119
    v_cvt_pk_bf16_f32 v210, v116, v117
    v_mfma_f32_32x32x16_bf16 v[96:111], v[132:135], v[76:79], v[96:111]
    v_add_f32 v232, v232, v116
    v_add_f32 v233, v233, v117
    v_exp_f32 v120, v120
    v_exp_f32 v121, v121
    v_mfma_f32_32x32x16_bf16 v[96:111], v[136:139], v[88:91], v[96:111]
    v_cvt_pk_bf16_f32 v211, v118, v119
    v_add_f32 v232, v232, v118
    v_add_f32 v233, v233, v119
    v_mfma_f32_32x32x16_bf16 v[96:111], v[140:143], v[92:95], v[96:111]
    v_exp_f32 v122, v122
    v_exp_f32 v123, v123
    v_cvt_pk_bf16_f32 v212, v120, v121
    v_add_f32 v232, v232, v120
    s_waitcnt lgkmcnt(0)
    v_mfma_f32_32x32x16_bf16 v[96:111], v[144:147], v[64:67], v[96:111]
    v_add_f32 v233, v233, v121
    v_exp_f32 v124, v124
    v_exp_f32 v125, v125
    v_mfma_f32_32x32x16_bf16 v[96:111], v[148:151], v[68:71], v[96:111]
    v_cvt_pk_bf16_f32 v213, v122, v123
    v_add_f32 v232, v232, v122
    v_add_f32 v233, v233, v123
    v_exp_f32 v126, v126
    v_mfma_f32_32x32x16_bf16 v[96:111], v[152:155], v[80:83], v[96:111]
    v_exp_f32 v127, v127
    v_cvt_pk_bf16_f32 v214, v124, v125
    v_add_f32 v232, v232, v124
    v_mfma_f32_32x32x16_bf16 v[96:111], v[156:159], v[84:87], v[96:111]
    v_add_f32 v233, v233, v125
    v_cvt_pk_bf16_f32 v215, v126, v127
    v_add_f32 v232, v232, v126
    v_add_f32 v233, v233, v127
    v_mfma_f32_32x32x16_bf16 v[0:15], v[160:163], v[208:211], v[0:15]
    ds_read_b128 v[128:131], v216 offset:8192
    ds_read_b128 v[132:135], v217 offset:8192
    ds_read_b64_tr_b16 v[160:161], v224 offset:16384
    ds_read_b64_tr_b16 v[162:163], v224 offset:17408
    s_add_u32 s72, s81, 32768
    s_cmp_eq_u32 s72, 98304
    s_cselect_b32 s72, 0, s72
    v_mfma_f32_32x32x16_bf16 v[16:31], v[164:167], v[208:211], v[16:31]
    ds_read_b128 v[136:139], v218 offset:8192
    ds_read_b128 v[140:143], v219 offset:8192
    ds_read_b64_tr_b16 v[164:165], v225 offset:16384
    ds_read_b64_tr_b16 v[166:167], v225 offset:17408
    v_max3_f32 v234, v96, v97, v98
    v_max3_f32 v234, v234, v99, v100
    v_mfma_f32_32x32x16_bf16 v[32:47], v[168:171], v[208:211], v[32:47]
    ds_read_b128 v[144:147], v220 offset:8192
    ds_read_b128 v[148:151], v221 offset:8192
    ds_read_b64_tr_b16 v[168:169], v226 offset:16384
    ds_read_b64_tr_b16 v[170:171], v226 offset:17408
    v_max3_f32 v234, v234, v101, v102
    v_max3_f32 v234, v234, v103, v104
    v_mfma_f32_32x32x16_bf16 v[48:63], v[172:175], v[208:211], v[48:63]
    ds_read_b128 v[152:155], v222 offset:8192
    ds_read_b128 v[156:159], v223 offset:8192
    ds_read_b64_tr_b16 v[172:173], v227 offset:16384
    ds_read_b64_tr_b16 v[174:175], v227 offset:17408
    v_max3_f32 v234, v234, v105, v106
    v_max3_f32 v234, v234, v107, v108
    v_mfma_f32_32x32x16_bf16 v[0:15], v[176:179], v[212:215], v[0:15]
    ds_read_b64_tr_b16 v[176:177], v224 offset:20480
    ds_read_b64_tr_b16 v[178:179], v224 offset:21504
    v_max3_f32 v234, v234, v109, v110
    v_max_f32 v234, v234, v111
    s_sub_u32 s80, s72, s81
    s_mov_b32 s81, s72
    v_mfma_f32_32x32x16_bf16 v[16:31], v[180:183], v[212:215], v[16:31]
    ds_read_b64_tr_b16 v[180:181], v225 offset:20480
    ds_read_b64_tr_b16 v[182:183], v225 offset:21504
    v_cmp_lt_f32 vcc, s88, v234
    v_add_u32 v216, s80, v216
    v_add_u32 v217, s80, v217
    v_mfma_f32_32x32x16_bf16 v[32:47], v[184:187], v[212:215], v[32:47]
    ds_read_b64_tr_b16 v[184:185], v226 offset:20480
    ds_read_b64_tr_b16 v[186:187], v226 offset:21504
    v_add_u32 v218, s80, v218
    v_add_u32 v219, s80, v219
    v_add_u32 v220, s80, v220
    v_add_u32 v221, s80, v221
    v_mfma_f32_32x32x16_bf16 v[48:63], v[188:191], v[212:215], v[48:63]
    ds_read_b64_tr_b16 v[188:189], v227 offset:20480
    ds_read_b64_tr_b16 v[190:191], v227 offset:21504
    v_add_u32 v222, s80, v222
    v_add_u32 v223, s80, v223
    s_cbranch_vccnz L_slow_ae1
L_back_ae1:
    s_waitcnt lgkmcnt(10)
    v_mfma_f32_32x32x16_bf16 v[112:127], v[128:131], v[72:75], v[192:207]
    v_exp_f32 v96, v96
    v_exp_f32 v97, v97
    v_exp_f32 v98, v98
    v_mfma_f32_32x32x16_bf16 v[112:127], v[132:135], v[76:79], v[112:127]
    v_exp_f32 v99, v99
    v_cvt_pk_bf16_f32 v208, v96, v97
    v_exp_f32 v100, v100
    v_mfma_f32_32x32x16_bf16 v[112:127], v[136:139], v[88:91], v[112:127]
    v_exp_f32 v101, v101
    v_cvt_pk_bf16_f32 v209, v98, v99
    v_exp_f32 v102, v102
    v_mfma_f32_32x32x16_bf16 v[112:127], v[140:143], v[92:95], v[112:127]
    v_exp_f32 v103, v103
    v_cvt_pk_bf16_f32 v210, v100, v101
    v_exp_f32 v104, v104
    v_mfma_f32_32x32x16_bf16 v[112:127], v[144:147], v[64:67], v[112:127]
    v_exp_f32 v105, v105
    v_cvt_pk_bf16_f32 v211, v102, v103
    v_exp_f32 v106, v106
    v_mfma_f32_32x32x16_bf16 v[112:127], v[148:151], v[68:71], v[112:127]
    v_exp_f32 v107, v107
    v_cvt_pk_bf16_f32 v212, v104, v105
    v_exp_f32 v108, v108
    v_mfma_f32_32x32x16_bf16 v[112:127], v[152:155], v[80:83], v[112:127]
    v_exp_f32 v109, v109
    v_cvt_pk_bf16_f32 v213, v106, v107
    v_exp_f32 v110, v110
    v_mfma_f32_32x32x16_bf16 v[112:127], v[156:159], v[84:87], v[112:127]
    v_exp_f32 v111, v111
    v_cvt_pk_bf16_f32 v214, v108, v109
    v_cvt_pk_bf16_f32 v215, v110, v111
    s_waitcnt lgkmcnt(0)
    v_mfma_f32_32x32x16_bf16 v[0:15], v[160:163], v[208:211], v[0:15]
    ds_read_b64_tr_b16 v[128:129], v224 offset:24576
    ds_read_b64_tr_b16 v[130:131], v224 offset:25600
    ds_read_b64_tr_b16 v[132:133], v225 offset:24576
    ds_read_b64_tr_b16 v[134:135], v225 offset:25600
    v_add_f32 v232, v232, v96
    v_add_f32 v233, v233, v97
    v_mfma_f32_32x32x16_bf16 v[16:31], v[164:167], v[208:211], v[16:31]
    ds_read_b64_tr_b16 v[136:137], v226 offset:24576
    ds_read_b64_tr_b16 v[138:139], v226 offset:25600
    ds_read_b64_tr_b16 v[140:141], v227 offset:24576
    ds_read_b64_tr_b16 v[142:143], v227 offset:25600
    v_add_f32 v232, v232, v98
    v_add_f32 v233, v233, v99
    v_mfma_f32_32x32x16_bf16 v[32:47], v[168:171], v[208:211], v[32:47]
    ds_read_b64_tr_b16 v[144:145], v224 offset:28672
    ds_read_b64_tr_b16 v[146:147], v224 offset:29696
    ds_read_b64_tr_b16 v[148:149], v225 offset:28672
    ds_read_b64_tr_b16 v[150:151], v225 offset:29696
    v_add_f32 v232, v232, v100
    v_max3_f32 v234, v112, v113, v114
    v_mfma_f32_32x32x16_bf16 v[48:63], v[172:175], v[208:211], v[48:63]
    ds_read_b64_tr_b16 v[152:153], v226 offset:28672
    ds_read_b64_tr_b16 v[154:155], v226 offset:29696
    ds_read_b64_tr_b16 v[156:157], v227 offset:28672
    ds_read_b64_tr_b16 v[158:159], v227 offset:29696
    v_add_f32 v233, v233, v101
    v_max3_f32 v234, v234, v115, v116
    v_mfma_f32_32x32x16_bf16 v[0:15], v[176:179], v[212:215], v[0:15]
    v_add_f32 v232, v232, v102
    v_add_f32 v233, v233, v103
    v_max3_f32 v234, v234, v117, v118
    v_max3_f32 v234, v234, v119, v120
    v_max3_f32 v234, v234, v121, v122
    v_mfma_f32_32x32x16_bf16 v[16:31], v[180:183], v[212:215], v[16:31]
    v_add_f32 v232, v232, v104
    v_add_f32 v233, v233, v105
    v_add_f32 v232, v232, v106
    v_max3_f32 v234, v234, v123, v124
    v_max3_f32 v234, v234, v125, v126
    v_max_f32 v234, v234, v127
    v_mfma_f32_32x32x16_bf16 v[32:47], v[184:187], v[212:215], v[32:47]
    v_cmp_lt_f32 vcc, s88, v234
    v_add_f32 v233, v233, v107
    v_add_u32 v224, s80, v224
    v_add_u32 v225, s80, v225
    v_add_u32 v226, s80, v226
    v_add_u32 v227, s80, v227
    v_mfma_f32_32x32x16_bf16 v[48:63], v[188:191], v[212:215], v[48:63]
    v_add_f32 v232, v232, v108
    v_add_f32 v233, v233, v109
    v_add_f32 v232, v232, v110
    v_add_f32 v233, v233, v111
    s_cbranch_vccnz L_slow_ae2
L_back_ae2:
    s_waitcnt lgkmcnt(0)
    s_barrier
    s_branch L_att_ao
L_att_drain:
    s_add_u32 s34, s34, 1
    s_cmp_eq_u32 s34, 4
    s_cbranch_scc1 L_att_fin
L_att_ab:
    ds_read_b128 v[72:75], v236 offset:0
    ds_read_b128 v[76:79], v236 offset:3072
    ds_read_b128 v[88:91], v236 offset:6144
    ds_read_b128 v[92:95], v236 offset:9216
    ds_read_b128 v[64:67], v236 offset:12288
    ds_read_b128 v[68:71], v236 offset:15360
    ds_read_b128 v[80:83], v236 offset:18432
    ds_read_b128 v[84:87], v236 offset:21504
    ds_read_b128 v[128:131], v216 offset:0
    ds_read_b128 v[132:135], v217 offset:0
    ds_read_b128 v[136:139], v218 offset:0
    ds_read_b128 v[140:143], v219 offset:0
    ds_read_b128 v[144:147], v220 offset:0
    ds_read_b128 v[148:151], v221 offset:0
    ds_read_b128 v[152:155], v222 offset:0
    v_exp_f32 v112, v112
    v_exp_f32 v113, v113
    v_exp_f32 v114, v114
    v_exp_f32 v115, v115
    v_cvt_pk_bf16_f32 v208, v112, v113
    v_exp_f32 v116, v116
    v_exp_f32 v117, v117
    v_cvt_pk_bf16_f32 v209, v114, v115
    v_exp_f32 v118, v118
    v_exp_f32 v119, v119
    v_cvt_pk_bf16_f32 v210, v116, v117
    v_exp_f32 v120, v120
    v_exp_f32 v121, v121
    v_cvt_pk_bf16_f32 v211, v118, v119
    s_nop 1
    v_mfma_f32_32x32x16_bf16 v[0:15], v[160:163], v[208:211], v[0:15]
    ds_read_b128 v[156:159], v223 offset:0
    v_exp_f32 v122, v122
    v_exp_f32 v123, v123
    v_cvt_pk_bf16_f32 v212, v120, v121
    v_mfma_f32_32x32x16_bf16 v[16:31], v[164:167], v[208:211], v[16:31]
    v_exp_f32 v124, v124
    v_exp_f32 v125, v125
    v_cvt_pk_bf16_f32 v213, v122, v123
    v_mfma_f32_32x32x16_bf16 v[32:47], v[168:171], v[208:211], v[32:47]
    v_exp_f32 v126, v126
    v_exp_f32 v127, v127
    v_cvt_pk_bf16_f32 v214, v124, v125
    v_mfma_f32_32x32x16_bf16 v[48:63], v[172:175], v[208:211], v[48:63]
    v_cvt_pk_bf16_f32 v215, v126, v127
    v_add_f32 v232, v232, v112
    v_add_f32 v233, v233, v113
    v_mfma_f32_32x32x16_bf16 v[0:15], v[176:179], v[212:215], v[0:15]
    v_add_f32 v232, v232, v114
    v_add_f32 v233, v233, v115
    v_add_f32 v232, v232, v116
    v_mfma_f32_32x32x16_bf16 v[16:31], v[180:183], v[212:215], v[16:31]
    v_add_f32 v233, v233, v117
    v_add_f32 v232, v232, v118
    v_add_f32 v233, v233, v119
    v_mfma_f32_32x32x16_bf16 v[32:47], v[184:187], v[212:215], v[32:47]
    v_add_f32 v232, v232, v120
    v_add_f32 v233, v233, v121
    v_add_f32 v232, v232, v122
    v_add_f32 v233, v233, v123
    v_mfma_f32_32x32x16_bf16 v[48:63], v[188:191], v[212:215], v[48:63]
    v_add_f32 v232, v232, v124
    v_add_f32 v233, v233, v125
    v_add_f32 v232, v232, v126
    v_add_f32 v233, v233, v127
    v_add_f32 v238, v232, v233
    v_mov_b32 v239, v238
    s_nop 1
    v_permlane32_swap_b32 v238, v239
    v_add_f32 v238, v238, v239
    v_rcp_f32 v238, v238
    s_nop 0
    v_mov_b32 v239, v238
    v_mov_b32 v232, 0
    v_mov_b32 v233, 0
    s_waitcnt lgkmcnt(7)
    v_mfma_f32_32x32x16_bf16 v[96:111], v[128:131], v[72:75], 0
    ds_read_b128 v[128:131], v216 offset:8192
    ds_read_b64_tr_b16 v[160:161], v224 offset:16384
    ds_read_b64_tr_b16 v[162:163], v224 offset:17408
    s_waitcnt lgkmcnt(9)
    v_mfma_f32_32x32x16_bf16 v[96:111], v[132:135], v[76:79], v[96:111]
    ds_read_b128 v[132:135], v217 offset:8192
    ds_read_b64_tr_b16 v[164:165], v225 offset:16384
    ds_read_b64_tr_b16 v[166:167], v225 offset:17408
    v_mul_f32 v0, v238, v0
    v_mul_f32 v1, v238, v1
    v_mul_f32 v2, v238, v2
    v_mul_f32 v3, v238, v3
    v_mul_f32 v4, v238, v4
    v_mul_f32 v5, v238, v5
    v_mul_f32 v6, v238, v6
    s_waitcnt lgkmcnt(11)
    v_mfma_f32_32x32x16_bf16 v[96:111], v[136:139], v[88:91], v[96:111]
    ds_read_b128 v[136:139], v218 offset:8192
    ds_read_b64_tr_b16 v[168:169], v226 offset:16384
    ds_read_b64_tr_b16 v[170:171], v226 offset:17408
    v_mul_f32 v7, v238, v7
    v_cvt_pk_bf16_f32 v0, v0, v1
    v_cvt_pk_bf16_f32 v1, v2, v3
    v_cvt_pk_bf16_f32 v2, v4, v5
    v_cvt_pk_bf16_f32 v3, v6, v7
    ds_write_b128 v236, v[0:3] offset:0
    v_mul_f32 v8, v238, v8
    s_waitcnt lgkmcnt(14)
    v_mfma_f32_32x32x16_bf16 v[96:111], v[140:143], v[92:95], v[96:111]
    ds_read_b128 v[140:143], v219 offset:8192
    ds_read_b64_tr_b16 v[172:173], v227 offset:16384
    ds_read_b64_tr_b16 v[174:175], v227 offset:17408
    v_mul_f32 v9, v238, v9
    v_mul_f32 v10, v238, v10
    v_mul_f32 v11, v238, v11
    v_mul_f32 v12, v238, v12
    v_mul_f32 v13, v238, v13
    v_mul_f32 v14, v238, v14
    v_mul_f32 v15, v238, v15
    v_cvt_pk_bf16_f32 v4, v8, v9
    s_waitcnt lgkmcnt(14)
    v_mfma_f32_32x32x16_bf16 v[96:111], v[144:147], v[64:67], v[96:111]
    ds_read_b128 v[144:147], v220 offset:8192
    ds_read_b64_tr_b16 v[176:177], v224 offset:20480
    ds_read_b64_tr_b16 v[178:179], v224 offset:21504
    v_cvt_pk_bf16_f32 v5, v10, v11
    v_cvt_pk_bf16_f32 v6, v12, v13
    v_cvt_pk_bf16_f32 v7, v14, v15
    ds_write_b128 v236, v[4:7] offset:3072
    v_mul_f32 v16, v238, v16
    v_mul_f32 v17, v238, v17
    v_mul_f32 v18, v238, v18
    v_mfma_f32_32x32x16_bf16 v[96:111], v[148:151], v[68:71], v[96:111]
    ds_read_b128 v[148:151], v221 offset:8192
    ds_read_b64_tr_b16 v[180:181], v225 offset:20480
    ds_read_b64_tr_b16 v[182:183], v225 offset:21504
    v_mul_f32 v19, v238, v19
    v_mul_f32 v20, v238, v20
    v_mul_f32 v21, v238, v21
    v_mul_f32 v22, v238, v22
    v_mul_f32 v23, v238, v23
    v_cvt_pk_bf16_f32 v16, v16, v17
    v_cvt_pk_bf16_f32 v17, v18, v19
    v_cvt_pk_bf16_f32 v18, v20, v21
    v_mfma_f32_32x32x16_bf16 v[96:111], v[152:155], v[80:83], v[96:111]
    ds_read_b128 v[152:155], v222 offset:8192
    ds_read_b64_tr_b16 v[184:185], v226 offset:20480
    ds_read_b64_tr_b16 v[186:187], v226 offset:21504
    v_cvt_pk_bf16_f32 v19, v22, v23
    ds_write_b128 v236, v[16:19] offset:6144
    v_mul_f32 v24, v238, v24
    v_mul_f32 v25, v238, v25
    v_mul_f32 v26, v238, v26
    v_mul_f32 v27, v238, v27
    v_mul_f32 v28, v238, v28
    s_waitcnt lgkmcnt(14)
    v_mfma_f32_32x32x16_bf16 v[96:111], v[156:159], v[84:87], v[96:111]
    ds_read_b128 v[156:159], v223 offset:8192
    ds_read_b64_tr_b16 v[188:189], v227 offset:20480
    ds_read_b64_tr_b16 v[190:191], v227 offset:21504
    v_mul_f32 v29, v238, v29
    v_mul_f32 v30, v238, v30
    v_mul_f32 v31, v238, v31
    v_cvt_pk_bf16_f32 v20, v24, v25
    v_cvt_pk_bf16_f32 v21, v26, v27
    v_cvt_pk_bf16_f32 v22, v28, v29
    v_cvt_pk_bf16_f32 v23, v30, v31
    ds_write_b128 v236, v[20:23] offset:9216
    s_nop 0
    v_max3_f32 v234, v96, v97, v98
    v_mul_f32 v32, v238, v32
    v_max3_f32 v234, v234, v99, v100
    v_mul_f32 v33, v238, v33
    v_max3_f32 v234, v234, v101, v102
    v_mul_f32 v34, v238, v34
    v_max3_f32 v234, v234, v103, v104
    v_mul_f32 v35, v238, v35
    v_max3_f32 v234, v234, v105, v106
    v_mul_f32 v36, v238, v36
    v_max3_f32 v234, v234, v107, v108
    v_mul_f32 v37, v238, v37
    v_max3_f32 v234, v234, v109, v110
    v_mul_f32 v38, v238, v38
    v_max_f32 v234, v234, v111
    v_mul_f32 v39, v238, v39
    v_mov_b32 v235, v234
    v_cvt_pk_bf16_f32 v32, v32, v33
    s_nop 0
    v_permlane32_swap_b32 v234, v235
    v_cvt_pk_bf16_f32 v33, v34, v35
    v_max_f32 v234, v234, v235
    v_cvt_pk_bf16_f32 v34, v36, v37
    v_mul_f32 v192, -1.0, v234
    v_mul_f32 v193, -1.0, v234
    v_mul_f32 v194, -1.0, v234
    v_mul_f32 v195, -1.0, v234
    v_mul_f32 v196, -1.0, v234
    v_mul_f32 v197, -1.0, v234
    v_mul_f32 v198, -1.0, v234
    v_mul_f32 v199, -1.0, v234
    v_mul_f32 v200, -1.0, v234
    v_mul_f32 v201, -1.0, v234
    v_mul_f32 v202, -1.0, v234
    v_mul_f32 v203, -1.0, v234
    v_mul_f32 v204, -1.0, v234
    v_mul_f32 v205, -1.0, v234
    v_mul_f32 v206, -1.0, v234
    v_mul_f32 v207, -1.0, v234
    v_sub_f32 v96, v96, v234
    v_sub_f32 v97, v97, v234
    v_sub_f32 v98, v98, v234
    v_sub_f32 v99, v99, v234
    s_waitcnt lgkmcnt(3)
    v_mfma_f32_32x32x16_bf16 v[112:127], v[128:131], v[72:75], v[192:207]
    v_sub_f32 v100, v100, v234
    v_sub_f32 v101, v101, v234
    v_exp_f32 v96, v96
    v_exp_f32 v97, v97
    v_exp_f32 v98, v98
    v_cvt_pk_bf16_f32 v35, v38, v39
    ds_write_b128 v236, v[32:35] offset:12288
    v_mul_f32 v40, v238, v40
    v_mul_f32 v41, v238, v41
    v_mul_f32 v42, v238, v42
    v_mfma_f32_32x32x16_bf16 v[112:127], v[132:135], v[76:79], v[112:127]
    v_sub_f32 v102, v102, v234
    v_sub_f32 v103, v103, v234
    v_exp_f32 v99, v99
    v_cvt_pk_bf16_f32 v208, v96, v97
    v_exp_f32 v100, v100
    v_mul_f32 v43, v238, v43
    v_mul_f32 v44, v238, v44
    v_mul_f32 v45, v238, v45
    v_mul_f32 v46, v238, v46
    v_mul_f32 v47, v238, v47
    v_cvt_pk_bf16_f32 v36, v40, v41
    v_mfma_f32_32x32x16_bf16 v[112:127], v[136:139], v[88:91], v[112:127]
    v_sub_f32 v104, v104, v234
    v_sub_f32 v105, v105, v234
    v_exp_f32 v101, v101
    v_cvt_pk_bf16_f32 v209, v98, v99
    v_exp_f32 v102, v102
    v_cvt_pk_bf16_f32 v37, v42, v43
    v_cvt_pk_bf16_f32 v38, v44, v45
    v_cvt_pk_bf16_f32 v39, v46, v47
    ds_write_b128 v236, v[36:39] offset:15360
    v_mul_f32 v48, v238, v48
    v_mul_f32 v49, v238, v49
    v_mfma_f32_32x32x16_bf16 v[112:127], v[140:143], v[92:95], v[112:127]
    v_sub_f32 v106, v106, v234
    v_sub_f32 v107, v107, v234
    v_exp_f32 v103, v103
    v_cvt_pk_bf16_f32 v210, v100, v101
    v_exp_f32 v104, v104
    v_mul_f32 v50, v238, v50
    v_mul_f32 v51, v238, v51
    v_mul_f32 v52, v238, v52
    v_mul_f32 v53, v238, v53
    v_mul_f32 v54, v238, v54
    v_mul_f32 v55, v238, v55
    v_mfma_f32_32x32x16_bf16 v[112:127], v[144:147], v[64:67], v[112:127]
    v_sub_f32 v108, v108, v234
    v_sub_f32 v109, v109, v234
    v_exp_f32 v105, v105
    v_cvt_pk_bf16_f32 v211, v102, v103
    v_exp_f32 v106, v106
    v_cvt_pk_bf16_f32 v48, v48, v49
    v_cvt_pk_bf16_f32 v49, v50, v51
    v_cvt_pk_bf16_f32 v50, v52, v53
    v_cvt_pk_bf16_f32 v51, v54, v55
    ds_write_b128 v236, v[48:51] offset:18432
    v_mul_f32 v56, v238, v56
    v_mfma_f32_32x32x16_bf16 v[112:127], v[148:151], v[68:71], v[112:127]
    v_sub_f32 v110, v110, v234
    v_sub_f32 v111, v111, v234
    v_exp_f32 v107, v107
    v_cvt_pk_bf16_f32 v212, v104, v105
    v_exp_f32 v108, v108
    v_mul_f32 v57, v238, v57
    v_mul_f32 v58, v238, v58
    v_mul_f32 v59, v238, v59
    v_mul_f32 v60, v238, v60
    v_mul_f32 v61, v238, v61
    v_mul_f32 v62, v238, v62
    v_mfma_f32_32x32x16_bf16 v[112:127], v[152:155], v[80:83], v[112:127]
    v_exp_f32 v109, v109
    v_cvt_pk_bf16_f32 v213, v106, v107
    v_exp_f32 v110, v110
    v_mul_f32 v63, v238, v63
    v_cvt_pk_bf16_f32 v52, v56, v57
    v_cvt_pk_bf16_f32 v53, v58, v59
    v_cvt_pk_bf16_f32 v54, v60, v61
    v_cvt_pk_bf16_f32 v55, v62, v63
    ds_write_b128 v236, v[52:55] offset:21504
    v_mfma_f32_32x32x16_bf16 v[112:127], v[156:159], v[84:87], v[112:127]
    v_exp_f32 v111, v111
    v_cvt_pk_bf16_f32 v214, v108, v109
    v_cvt_pk_bf16_f32 v215, v110, v111
    s_waitcnt lgkmcnt(5)
    v_mfma_f32_32x32x16_bf16 v[0:15], v[160:163], v[208:211], 0
    ds_read_b64_tr_b16 v[128:129], v224 offset:24576
    ds_read_b64_tr_b16 v[130:131], v224 offset:25600
    ds_read_b64_tr_b16 v[132:133], v225 offset:24576
    ds_read_b64_tr_b16 v[134:135], v225 offset:25600
    v_add_f32 v232, v232, v96
    v_add_f32 v233, v233, v97
    v_mfma_f32_32x32x16_bf16 v[16:31], v[164:167], v[208:211], 0
    ds_read_b64_tr_b16 v[136:137], v226 offset:24576
    ds_read_b64_tr_b16 v[138:139], v226 offset:25600
    ds_read_b64_tr_b16 v[140:141], v227 offset:24576
    ds_read_b64_tr_b16 v[142:143], v227 offset:25600
    v_add_f32 v232, v232, v98
    v_add_f32 v233, v233, v99
    v_mfma_f32_32x32x16_bf16 v[32:47], v[168:171], v[208:211], 0
    ds_read_b64_tr_b16 v[144:145], v224 offset:28672
    ds_read_b64_tr_b16 v[146:147], v224 offset:29696
    ds_read_b64_tr_b16 v[148:149], v225 offset:28672
    ds_read_b64_tr_b16 v[150:151], v225 offset:29696
    v_add_f32 v232, v232, v100
    v_max3_f32 v234, v112, v113, v114
    v_mfma_f32_32x32x16_bf16 v[48:63], v[172:175], v[208:211], 0
    ds_read_b64_tr_b16 v[152:153], v226 offset:28672
    ds_read_b64_tr_b16 v[154:155], v226 offset:29696
    ds_read_b64_tr_b16 v[156:157], v227 offset:28672
    ds_read_b64_tr_b16 v[158:159], v227 offset:29696
    v_add_f32 v233, v233, v101
    v_max3_f32 v234, v234, v115, v116
    v_mfma_f32_32x32x16_bf16 v[0:15], v[176:179], v[212:215], v[0:15]
    v_add_f32 v232, v232, v102
    v_add_f32 v233, v233, v103
    v_max3_f32 v234, v234, v117, v118
    v_max3_f32 v234, v234, v119, v120
    v_max3_f32 v234, v234, v121, v122
    s_add_u32 s72, s81, 32768
    s_cmp_eq_u32 s72, 98304
    s_cselect_b32 s72, 0, s72
    s_sub_u32 s80, s72, s81
    s_mov_b32 s81, s72
    v_mfma_f32_32x32x16_bf16 v[16:31], v[180:183], v[212:215], v[16:31]
    v_add_f32 v232, v232, v104
    v_add_f32 v233, v233, v105
    v_add_f32 v232, v232, v106
    v_max3_f32 v234, v234, v123, v124
    v_max3_f32 v234, v234, v125, v126
    v_max_f32 v234, v234, v127
    v_add_u32 v216, s80, v216
    v_add_u32 v217, s80, v217
    v_add_u32 v218, s80, v218
    v_add_u32 v219, s80, v219
    v_add_u32 v220, s80, v220
    v_add_u32 v221, s80, v221
    v_add_u32 v222, s80, v222
    v_add_u32 v223, s80, v223
    v_mfma_f32_32x32x16_bf16 v[32:47], v[184:187], v[212:215], v[32:47]
    v_cmp_lt_f32 vcc, s88, v234
    v_add_f32 v233, v233, v107
    v_add_u32 v224, s80, v224
    v_add_u32 v225, s80, v225
    v_add_u32 v226, s80, v226
    v_add_u32 v227, s80, v227
    v_mfma_f32_32x32x16_bf16 v[48:63], v[188:191], v[212:215], v[48:63]
    v_add_f32 v232, v232, v108
    v_add_f32 v233, v233, v109
    v_add_f32 v232, v232, v110
    v_add_f32 v233, v233, v111
    s_mov_b32 s35, 4
    s_cbranch_vccnz L_slow_ab
L_back_ab:
    s_waitcnt lgkmcnt(0)
    s_barrier
    s_branch L_att_ao
L_att_fin:
    s_setprio 3
    v_subrev_u32 v236, 106496, v236
    v_exp_f32 v112, v112
    v_exp_f32 v113, v113
    v_exp_f32 v114, v114
    v_exp_f32 v115, v115
    v_cvt_pk_bf16_f32 v208, v112, v113
    v_exp_f32 v116, v116
    v_exp_f32 v117, v117
    v_cvt_pk_bf16_f32 v209, v114, v115
    v_exp_f32 v118, v118
    v_exp_f32 v119, v119
    v_cvt_pk_bf16_f32 v210, v116, v117
    v_exp_f32 v120, v120
    v_exp_f32 v121, v121
    v_cvt_pk_bf16_f32 v211, v118, v119
    s_nop 1
    v_mfma_f32_32x32x16_bf16 v[0:15], v[160:163], v[208:211], v[0:15]
    v_exp_f32 v122, v122
    v_exp_f32 v123, v123
    v_cvt_pk_bf16_f32 v212, v120, v121
    v_mfma_f32_32x32x16_bf16 v[16:31], v[164:167], v[208:211], v[16:31]
    v_exp_f32 v124, v124
    v_exp_f32 v125, v125
    v_cvt_pk_bf16_f32 v213, v122, v123
    v_mfma_f32_32x32x16_bf16 v[32:47], v[168:171], v[208:211], v[32:47]
    v_exp_f32 v126, v126
    v_exp_f32 v127, v127
    v_cvt_pk_bf16_f32 v214, v124, v125
    v_mfma_f32_32x32x16_bf16 v[48:63], v[172:175], v[208:211], v[48:63]
    v_cvt_pk_bf16_f32 v215, v126, v127
    v_add_f32 v232, v232, v112
    v_add_f32 v233, v233, v113
    v_mfma_f32_32x32x16_bf16 v[0:15], v[176:179], v[212:215], v[0:15]
    v_add_f32 v232, v232, v114
    v_add_f32 v233, v233, v115
    v_add_f32 v232, v232, v116
    v_mfma_f32_32x32x16_bf16 v[16:31], v[180:183], v[212:215], v[16:31]
    v_add_f32 v233, v233, v117
    v_add_f32 v232, v232, v118
    v_add_f32 v233, v233, v119
    v_mfma_f32_32x32x16_bf16 v[32:47], v[184:187], v[212:215], v[32:47]
    v_add_f32 v232, v232, v120
    v_add_f32 v233, v233, v121
    v_add_f32 v232, v232, v122
    v_add_f32 v233, v233, v123
    v_mfma_f32_32x32x16_bf16 v[48:63], v[188:191], v[212:215], v[48:63]
    v_add_f32 v232, v232, v124
    v_add_f32 v233, v233, v125
    v_add_f32 v232, v232, v126
    v_add_f32 v233, v233, v127
    v_add_f32 v238, v232, v233
    v_mov_b32 v239, v238
    s_nop 1
    v_permlane32_swap_b32 v238, v239
    v_add_f32 v238, v238, v239
    v_rcp_f32 v238, v238
    s_nop 0
    v_mov_b32 v239, v238
    v_mul_f32 v0, v238, v0
    v_mul_f32 v1, v238, v1
    v_mul_f32 v2, v238, v2
    v_mul_f32 v3, v238, v3
    v_mul_f32 v4, v238, v4
    v_mul_f32 v5, v238, v5
    v_mul_f32 v6, v238, v6
    v_mul_f32 v7, v238, v7
    v_cvt_pk_bf16_f32 v0, v0, v1
    v_cvt_pk_bf16_f32 v1, v2, v3
    v_cvt_pk_bf16_f32 v2, v4, v5
    v_cvt_pk_bf16_f32 v3, v6, v7
    ds_write_b128 v236, v[0:3] offset:0
    v_mul_f32 v8, v238, v8
    v_mul_f32 v9, v238, v9
    v_mul_f32 v10, v238, v10
    v_mul_f32 v11, v238, v11
    v_mul_f32 v12, v238, v12
    v_mul_f32 v13, v238, v13
    v_mul_f32 v14, v238, v14
    v_mul_f32 v15, v238, v15
    v_cvt_pk_bf16_f32 v4, v8, v9
    v_cvt_pk_bf16_f32 v5, v10, v11
    v_cvt_pk_bf16_f32 v6, v12, v13
    v_cvt_pk_bf16_f32 v7, v14, v15
    ds_write_b128 v236, v[4:7] offset:3072
    v_mul_f32 v16, v238, v16
    v_mul_f32 v17, v238, v17
    v_mul_f32 v18, v238, v18
    v_mul_f32 v19, v238, v19
    v_mul_f32 v20, v238, v20
    v_mul_f32 v21, v238, v21
    v_mul_f32 v22, v238, v22
    v_mul_f32 v23, v238, v23
    v_cvt_pk_bf16_f32 v16, v16, v17
    v_cvt_pk_bf16_f32 v17, v18, v19
    v_cvt_pk_bf16_f32 v18, v20, v21
    v_cvt_pk_bf16_f32 v19, v22, v23
    ds_write_b128 v236, v[16:19] offset:6144
    v_mul_f32 v24, v238, v24
    v_mul_f32 v25, v238, v25
    v_mul_f32 v26, v238, v26
    v_mul_f32 v27, v238, v27
    v_mul_f32 v28, v238, v28
    v_mul_f32 v29, v238, v29
    v_mul_f32 v30, v238, v30
    v_mul_f32 v31, v238, v31
    v_cvt_pk_bf16_f32 v20, v24, v25
    v_cvt_pk_bf16_f32 v21, v26, v27
    v_cvt_pk_bf16_f32 v22, v28, v29
    v_cvt_pk_bf16_f32 v23, v30, v31
    ds_write_b128 v236, v[20:23] offset:9216
    v_mul_f32 v32, v238, v32
    v_mul_f32 v33, v238, v33
    v_mul_f32 v34, v238, v34
    v_mul_f32 v35, v238, v35
    v_mul_f32 v36, v238, v36
    v_mul_f32 v37, v238, v37
    v_mul_f32 v38, v238, v38
    v_mul_f32 v39, v238, v39
    v_cvt_pk_bf16_f32 v32, v32, v33
    v_cvt_pk_bf16_f32 v33, v34, v35
    v_cvt_pk_bf16_f32 v34, v36, v37
    v_cvt_pk_bf16_f32 v35, v38, v39
    ds_write_b128 v236, v[32:35] offset:12288
    v_mul_f32 v40, v238, v40
    v_mul_f32 v41, v238, v41
    v_mul_f32 v42, v238, v42
    v_mul_f32 v43, v238, v43
    v_mul_f32 v44, v238, v44
    v_mul_f32 v45, v238, v45
    v_mul_f32 v46, v238, v46
    v_mul_f32 v47, v238, v47
    v_cvt_pk_bf16_f32 v36, v40, v41
    v_cvt_pk_bf16_f32 v37, v42, v43
    v_cvt_pk_bf16_f32 v38, v44, v45
    v_cvt_pk_bf16_f32 v39, v46, v47
    ds_write_b128 v236, v[36:39] offset:15360
    v_mul_f32 v48, v238, v48
    v_mul_f32 v49, v238, v49
    v_mul_f32 v50, v238, v50
    v_mul_f32 v51, v238, v51
    v_mul_f32 v52, v238, v52
    v_mul_f32 v53, v238, v53
    v_mul_f32 v54, v238, v54
    v_mul_f32 v55, v238, v55
    v_cvt_pk_bf16_f32 v48, v48, v49
    v_cvt_pk_bf16_f32 v49, v50, v51
    v_cvt_pk_bf16_f32 v50, v52, v53
    v_cvt_pk_bf16_f32 v51, v54, v55
    ds_write_b128 v236, v[48:51] offset:18432
    v_mul_f32 v56, v238, v56
    v_mul_f32 v57, v238, v57
    v_mul_f32 v58, v238, v58
    v_mul_f32 v59, v238, v59
    v_mul_f32 v60, v238, v60
    v_mul_f32 v61, v238, v61
    v_mul_f32 v62, v238, v62
    v_mul_f32 v63, v238, v63
    v_cvt_pk_bf16_f32 v52, v56, v57
    v_cvt_pk_bf16_f32 v53, v58, v59
    v_cvt_pk_bf16_f32 v54, v60, v61
    v_cvt_pk_bf16_f32 v55, v62, v63
    ds_write_b128 v236, v[52:55] offset:21504
    s_waitcnt lgkmcnt(0)
    s_barrier
    s_branch L_tb
L_qp:
    s_setprio 2
    v_xor_b32 v5, 0, v3
    v_lshl_add_u32 v240, v5, 6, v2
    v_add_u32 v240, 98304, v240
    v_xor_b32 v5, 1, v3
    v_lshl_add_u32 v241, v5, 6, v2
    v_add_u32 v241, 98304, v241
    v_xor_b32 v5, 2, v3
    v_lshl_add_u32 v242, v5, 6, v2
    v_add_u32 v242, 98304, v242
    v_xor_b32 v5, 3, v3
    v_lshl_add_u32 v243, v5, 6, v2
    v_add_u32 v243, 98304, v243
    v_xor_b32 v224, 0, v6
    v_xor_b32 v225, 32, v6
    v_xor_b32 v226, 64, v6
    v_xor_b32 v227, 96, v6
    v_mov_b32 v244, v7
    v_lshrrev_b32 v245, 1, v0
    v_mul_u32_u24 v245, 1280, v245
    v_and_b32 v5, 1, v0
    v_lshl_add_u32 v245, v5, 7, v245
    s_cmp_lg_u32 s3, 4
    s_cbranch_scc1 L_qp1
L_qpz:
    s_lshl_b32 s72, s66, 9
    s_lshl_b32 s78, s65, 2
    s_add_u32 s78, s78, s72
    s_add_u32 s78, s78, 41943040
    v_lshlrev_b32 v160, 5, v0
    v_mov_b32 v161, 0
    s_mov_b64 exec, 0xffff
    buffer_store_dword v161, v160, s[24:27], s78 offen sc1
    s_mov_b64 exec, -1
    v_lshlrev_b32 v245, 13, v0
L_qp1:
    s_barrier
    ds_read_b128 v[0:3], v224
    ds_read_b128 v[4:7], v225
    ds_read_b128 v[8:11], v226
    ds_read_b128 v[12:15], v227
    v_add_u32 v224, 28672, v224
    v_add_u32 v225, 28672, v225
    v_add_u32 v226, 28672, v226
    v_add_u32 v227, 28672, v227
    s_waitcnt lgkmcnt(0)
    s_barrier
    ds_read_b128 v[16:19], v224
    ds_read_b128 v[20:23], v225
    ds_read_b128 v[24:27], v226
    ds_read_b128 v[28:31], v227
    v_add_u32 v224, 28672, v224
    v_add_u32 v225, 28672, v225
    v_add_u32 v226, 28672, v226
    v_add_u32 v227, 28672, v227
    s_waitcnt lgkmcnt(0)
    s_barrier
    ds_read_b128 v[32:35], v224
    ds_read_b128 v[36:39], v225
    ds_read_b128 v[40:43], v226
    ds_read_b128 v[44:47], v227
    v_subrev_u32 v224, 57344, v224
    v_subrev_u32 v225, 57344, v225
    v_subrev_u32 v226, 57344, v226
    v_subrev_u32 v227, 57344, v227
    s_waitcnt lgkmcnt(0)
    s_barrier
    ds_read_b128 v[48:51], v224
    ds_read_b128 v[52:55], v225
    ds_read_b128 v[56:59], v226
    ds_read_b128 v[60:63], v227
    v_add_u32 v224, 28672, v224
    v_add_u32 v225, 28672, v225
    v_add_u32 v226, 28672, v226
    v_add_u32 v227, 28672, v227
    s_waitcnt lgkmcnt(0)
    s_barrier
    ds_read_b128 v[64:67], v224
    ds_read_b128 v[68:71], v225
    ds_read_b128 v[72:75], v226
    ds_read_b128 v[76:79], v227
    v_add_u32 v224, 28672, v224
    v_add_u32 v225, 28672, v225
    v_add_u32 v226, 28672, v226
    v_add_u32 v227, 28672, v227
    s_cmp_lg_u32 s3, 4
    s_cbranch_scc1 L_qp3
    s_add_u32 s72, s64, s34
    s_lshl_b32 s72, s72, 8
    s_mul_i32 s78, s62, 327680
    s_add_u32 s72, s72, s78
    s_mov_b32 exec_hi, 0xff
    buffer_load_dword v255, v245, s[16:19], s72 offen offset:256
    buffer_load_dword v255, v245, s[16:19], s72 offen offset:384
    s_mov_b64 exec, -1
L_qp3:
    s_waitcnt lgkmcnt(0)
    s_barrier
    ds_read_b128 v[80:83], v224
    ds_read_b128 v[84:87], v225
    ds_read_b128 v[88:91], v226
    ds_read_b128 v[92:95], v227
    v_subrev_u32 v224, 57344, v224
    v_subrev_u32 v225, 57344, v225
    v_subrev_u32 v226, 57344, v226
    v_subrev_u32 v227, 57344, v227
    s_waitcnt lgkmcnt(0)
    s_barrier
    ds_read_b128 v[96:99], v224
    ds_read_b128 v[100:103], v225
    ds_read_b128 v[104:107], v226
    ds_read_b128 v[108:111], v227
    v_add_u32 v224, 28672, v224
    v_add_u32 v225, 28672, v225
    v_add_u32 v226, 28672, v226
    v_add_u32 v227, 28672, v227
    s_cmp_lg_u32 s3, 4
    s_cbranch_scc1 L_qp2
    s_lshl_b32 s72, s66, 3
    v_mov_b32 v162, s72
    v_mov_b32 v163, 1
    s_mov_b64 exec, 1
    s_waitcnt vmcnt(0)
    global_atomic_add v162, v163, s[32:33] sc1
    s_mov_b64 exec, -1
L_qp2:
    s_waitcnt lgkmcnt(0)
    s_barrier
    ds_read_b128 v[112:115], v224
    ds_read_b128 v[116:119], v225
    ds_read_b128 v[120:123], v226
    ds_read_b128 v[124:127], v227
    v_add_u32 v224, 28672, v224
    v_add_u32 v225, 28672, v225
    v_add_u32 v226, 28672, v226
    v_add_u32 v227, 28672, v227
    s_waitcnt lgkmcnt(0)
    s_barrier
    ds_read_b128 v[128:131], v224
    ds_read_b128 v[132:135], v225
    ds_read_b128 v[136:139], v226
    ds_read_b128 v[140:143], v227
    v_subrev_u32 v224, 57344, v224
    v_subrev_u32 v225, 57344, v225
    v_subrev_u32 v226, 57344, v226
    v_subrev_u32 v227, 57344, v227
    s_waitcnt lgkmcnt(0)
    s_barrier
    ds_read_b128 v[144:147], v224
    ds_read_b128 v[148:151], v225
    ds_read_b128 v[152:155], v226
    ds_read_b128 v[156:159], v227
    s_waitcnt lgkmcnt(0)
    s_barrier
L_qp_m:
    ds_read_b64_tr_b16 v[224:225], v240 offset:0
    ds_read_b64_tr_b16 v[226:227], v240 offset:1024
    ds_read_b64_tr_b16 v[228:229], v241 offset:0
    ds_read_b64_tr_b16 v[230:231], v241 offset:1024
    ds_read_b64_tr_b16 v[232:233], v242 offset:0
    ds_read_b64_tr_b16 v[234:235], v242 offset:1024
    ds_read_b64_tr_b16 v[236:237], v243 offset:0
    ds_read_b64_tr_b16 v[238:239], v243 offset:1024
    s_waitcnt lgkmcnt(6)
    v_mfma_f32_32x32x16_bf16 v[160:175], v[224:227], v[0:3], 0
    ds_read_b64_tr_b16 v[224:225], v240 offset:4096
    ds_read_b64_tr_b16 v[226:227], v240 offset:5120
    s_waitcnt lgkmcnt(6)
    v_mfma_f32_32x32x16_bf16 v[176:191], v[228:231], v[0:3], 0
    ds_read_b64_tr_b16 v[228:229], v241 offset:4096
    ds_read_b64_tr_b16 v[230:231], v241 offset:5120
    s_waitcnt lgkmcnt(6)
    v_mfma_f32_32x32x16_bf16 v[192:207], v[232:235], v[0:3], 0
    ds_read_b64_tr_b16 v[232:233], v242 offset:4096
    ds_read_b64_tr_b16 v[234:235], v242 offset:5120
    s_waitcnt lgkmcnt(6)
    v_mfma_f32_32x32x16_bf16 v[208:223], v[236:239], v[0:3], 0
    ds_read_b64_tr_b16 v[236:237], v243 offset:4096
    ds_read_b64_tr_b16 v[238:239], v243 offset:5120
    s_waitcnt lgkmcnt(6)
    v_mfma_f32_32x32x16_bf16 v[160:175], v[224:227], v[4:7], v[160:175]
    ds_read_b64_tr_b16 v[224:225], v240 offset:8192
    ds_read_b64_tr_b16 v[226:227], v240 offset:9216
    s_waitcnt lgkmcnt(6)
    v_mfma_f32_32x32x16_bf16 v[176:191], v[228:231], v[4:7], v[176:191]
    ds_read_b64_tr_b16 v[228:229], v241 offset:8192
    ds_read_b64_tr_b16 v[230:231], v241 offset:9216
    s_waitcnt lgkmcnt(6)
    v_mfma_f32_32x32x16_bf16 v[192:207], v[232:235], v[4:7], v[192:207]
    ds_read_b64_tr_b16 v[232:233], v242 offset:8192
    ds_read_b64_tr_b16 v[234:235], v242 offset:9216
    s_waitcnt lgkmcnt(6)
    v_mfma_f32_32x32x16_bf16 v[208:223], v[236:239], v[4:7], v[208:223]
    ds_read_b64_tr_b16 v[236:237], v243 offset:8192
    ds_read_b64_tr_b16 v[238:239], v243 offset:9216
    s_waitcnt lgkmcnt(6)
    v_mfma_f32_32x32x16_bf16 v[160:175], v[224:227], v[8:11], v[160:175]
    ds_read_b64_tr_b16 v[224:225], v240 offset:12288
    ds_read_b64_tr_b16 v[226:227], v240 offset:13312
    s_waitcnt lgkmcnt(6)
    v_mfma_f32_32x32x16_bf16 v[176:191], v[228:231], v[8:11], v[176:191]
    ds_read_b64_tr_b16 v[228:229], v241 offset:12288
    ds_read_b64_tr_b16 v[230:231], v241 offset:13312
    s_waitcnt lgkmcnt(6)
    v_mfma_f32_32x32x16_bf16 v[192:207], v[232:235], v[8:11], v[192:207]
    ds_read_b64_tr_b16 v[232:233], v242 offset:12288
    ds_read_b64_tr_b16 v[234:235], v242 offset:13312
    s_waitcnt lgkmcnt(6)
    v_mfma_f32_32x32x16_bf16 v[208:223], v[236:239], v[8:11], v[208:223]
    ds_read_b64_tr_b16 v[236:237], v243 offset:12288
    ds_read_b64_tr_b16 v[238:239], v243 offset:13312
    s_waitcnt lgkmcnt(6)
    v_mfma_f32_32x32x16_bf16 v[160:175], v[224:227], v[12:15], v[160:175]
    ds_read_b64_tr_b16 v[224:225], v240 offset:16384
    ds_read_b64_tr_b16 v[226:227], v240 offset:17408
    s_waitcnt lgkmcnt(6)
    v_mfma_f32_32x32x16_bf16 v[176:191], v[228:231], v[12:15], v[176:191]
    ds_read_b64_tr_b16 v[228:229], v241 offset:16384
    ds_read_b64_tr_b16 v[230:231], v241 offset:17408
    s_waitcnt lgkmcnt(6)
    v_mfma_f32_32x32x16_bf16 v[192:207], v[232:235], v[12:15], v[192:207]
    ds_read_b64_tr_b16 v[232:233], v242 offset:16384
    ds_read_b64_tr_b16 v[234:235], v242 offset:17408
    s_waitcnt lgkmcnt(6)
    v_mfma_f32_32x32x16_bf16 v[208:223], v[236:239], v[12:15], v[208:223]
    ds_read_b64_tr_b16 v[236:237], v243 offset:16384
    ds_read_b64_tr_b16 v[238:239], v243 offset:17408
    s_waitcnt lgkmcnt(6)
    v_mfma_f32_32x32x16_bf16 v[160:175], v[224:227], v[16:19], v[160:175]
    s_waitcnt lgkmcnt(4)
    v_mfma_f32_32x32x16_bf16 v[176:191], v[228:231], v[16:19], v[176:191]
    s_waitcnt lgkmcnt(2)
    v_mfma_f32_32x32x16_bf16 v[192:207], v[232:235], v[16:19], v[192:207]
    s_waitcnt lgkmcnt(0)
    v_mfma_f32_32x32x16_bf16 v[208:223], v[236:239], v[16:19], v[208:223]
    s_waitcnt lgkmcnt(0)
    s_barrier
    ds_read_b64_tr_b16 v[224:225], v240 offset:20480
    ds_read_b64_tr_b16 v[226:227], v240 offset:21504
    ds_read_b64_tr_b16 v[228:229], v241 offset:20480
    ds_read_b64_tr_b16 v[230:231], v241 offset:21504
    ds_read_b64_tr_b16 v[232:233], v242 offset:20480
    ds_read_b64_tr_b16 v[234:235], v242 offset:21504
    ds_read_b64_tr_b16 v[236:237], v243 offset:20480
    ds_read_b64_tr_b16 v[238:239], v243 offset:21504
    s_waitcnt lgkmcnt(6)
    v_mfma_f32_32x32x16_bf16 v[160:175], v[224:227], v[20:23], v[160:175]
    ds_read_b64_tr_b16 v[224:225], v240 offset:24576
    ds_read_b64_tr_b16 v[226:227], v240 offset:25600
    s_waitcnt lgkmcnt(6)
    v_mfma_f32_32x32x16_bf16 v[176:191], v[228:231], v[20:23], v[176:191]
    ds_read_b64_tr_b16 v[228:229], v241 offset:24576
    ds_read_b64_tr_b16 v[230:231], v241 offset:25600
    s_waitcnt lgkmcnt(6)
    v_mfma_f32_32x32x16_bf16 v[192:207], v[232:235], v[20:23], v[192:207]
    ds_read_b64_tr_b16 v[232:233], v242 offset:24576
    ds_read_b64_tr_b16 v[234:235], v242 offset:25600
    s_waitcnt lgkmcnt(6)
    v_mfma_f32_32x32x16_bf16 v[208:223], v[236:239], v[20:23], v[208:223]
    ds_read_b64_tr_b16 v[236:237], v243 offset:24576
    ds_read_b64_tr_b16 v[238:239], v243 offset:25600
    s_waitcnt lgkmcnt(6)
    v_mfma_f32_32x32x16_bf16 v[160:175], v[224:227], v[24:27], v[160:175]
    ds_read_b64_tr_b16 v[224:225], v240 offset:28672
    ds_read_b64_tr_b16 v[226:227], v240 offset:29696
    s_waitcnt lgkmcnt(6)
    v_mfma_f32_32x32x16_bf16 v[176:191], v[228:231], v[24:27], v[176:191]
    ds_read_b64_tr_b16 v[228:229], v241 offset:28672
    ds_read_b64_tr_b16 v[230:231], v241 offset:29696
    s_waitcnt lgkmcnt(6)
    v_mfma_f32_32x32x16_bf16 v[192:207], v[232:235], v[24:27], v[192:207]
    ds_read_b64_tr_b16 v[232:233], v242 offset:28672
    ds_read_b64_tr_b16 v[234:235], v242 offset:29696
    s_waitcnt lgkmcnt(6)
    v_mfma_f32_32x32x16_bf16 v[208:223], v[236:239], v[24:27], v[208:223]
    ds_read_b64_tr_b16 v[236:237], v243 offset:28672
    ds_read_b64_tr_b16 v[238:239], v243 offset:29696
    s_waitcnt lgkmcnt(6)
    v_mfma_f32_32x32x16_bf16 v[160:175], v[224:227], v[28:31], v[160:175]
    ds_read_b64_tr_b16 v[224:225], v240 offset:32768
    ds_read_b64_tr_b16 v[226:227], v240 offset:33792
    s_waitcnt lgkmcnt(6)
    v_mfma_f32_32x32x16_bf16 v[176:191], v[228:231], v[28:31], v[176:191]
    ds_read_b64_tr_b16 v[228:229], v241 offset:32768
    ds_read_b64_tr_b16 v[230:231], v241 offset:33792
    s_waitcnt lgkmcnt(6)
    v_mfma_f32_32x32x16_bf16 v[192:207], v[232:235], v[28:31], v[192:207]
    ds_read_b64_tr_b16 v[232:233], v242 offset:32768
    ds_read_b64_tr_b16 v[234:235], v242 offset:33792
    s_waitcnt lgkmcnt(6)
    v_mfma_f32_32x32x16_bf16 v[208:223], v[236:239], v[28:31], v[208:223]
    ds_read_b64_tr_b16 v[236:237], v243 offset:32768
    ds_read_b64_tr_b16 v[238:239], v243 offset:33792
    s_waitcnt lgkmcnt(6)
    v_mfma_f32_32x32x16_bf16 v[160:175], v[224:227], v[32:35], v[160:175]
    ds_read_b64_tr_b16 v[224:225], v240 offset:36864
    ds_read_b64_tr_b16 v[226:227], v240 offset:37888
    s_waitcnt lgkmcnt(6)
    v_mfma_f32_32x32x16_bf16 v[176:191], v[228:231], v[32:35], v[176:191]
    ds_read_b64_tr_b16 v[228:229], v241 offset:36864
    ds_read_b64_tr_b16 v[230:231], v241 offset:37888
    s_waitcnt lgkmcnt(6)
    v_mfma_f32_32x32x16_bf16 v[192:207], v[232:235], v[32:35], v[192:207]
    ds_read_b64_tr_b16 v[232:233], v242 offset:36864
    ds_read_b64_tr_b16 v[234:235], v242 offset:37888
    s_waitcnt lgkmcnt(6)
    v_mfma_f32_32x32x16_bf16 v[208:223], v[236:239], v[32:35], v[208:223]
    ds_read_b64_tr_b16 v[236:237], v243 offset:36864
    ds_read_b64_tr_b16 v[238:239], v243 offset:37888
    s_waitcnt lgkmcnt(6)
    v_mfma_f32_32x32x16_bf16 v[160:175], v[224:227], v[36:39], v[160:175]
    s_waitcnt lgkmcnt(4)
    v_mfma_f32_32x32x16_bf16 v[176:191], v[228:231], v[36:39], v[176:191]
    s_waitcnt lgkmcnt(2)
    v_mfma_f32_32x32x16_bf16 v[192:207], v[232:235], v[36:39], v[192:207]
    s_waitcnt lgkmcnt(0)
    v_mfma_f32_32x32x16_bf16 v[208:223], v[236:239], v[36:39], v[208:223]
    s_waitcnt lgkmcnt(0)
    s_barrier
    ds_read_b64_tr_b16 v[224:225], v240 offset:0
    ds_read_b64_tr_b16 v[226:227], v240 offset:1024
    ds_read_b64_tr_b16 v[228:229], v241 offset:0
    ds_read_b64_tr_b16 v[230:231], v241 offset:1024
    ds_read_b64_tr_b16 v[232:233], v242 offset:0
    ds_read_b64_tr_b16 v[234:235], v242 offset:1024
    ds_read_b64_tr_b16 v[236:237], v243 offset:0
    ds_read_b64_tr_b16 v[238:239], v243 offset:1024
    s_waitcnt lgkmcnt(6)
    v_mfma_f32_32x32x16_bf16 v[160:175], v[224:227], v[40:43], v[160:175]
    ds_read_b64_tr_b16 v[224:225], v240 offset:4096
    ds_read_b64_tr_b16 v[226:227], v240 offset:5120
    s_waitcnt lgkmcnt(6)
    v_mfma_f32_32x32x16_bf16 v[176:191], v[228:231], v[40:43], v[176:191]
    ds_read_b64_tr_b16 v[228:229], v241 offset:4096
    ds_read_b64_tr_b16 v[230:231], v241 offset:5120
    s_waitcnt lgkmcnt(6)
    v_mfma_f32_32x32x16_bf16 v[192:207], v[232:235], v[40:43], v[192:207]
    ds_read_b64_tr_b16 v[232:233], v242 offset:4096
    ds_read_b64_tr_b16 v[234:235], v242 offset:5120
    s_waitcnt lgkmcnt(6)
    v_mfma_f32_32x32x16_bf16 v[208:223], v[236:239], v[40:43], v[208:223]
    ds_read_b64_tr_b16 v[236:237], v243 offset:4096
    ds_read_b64_tr_b16 v[238:239], v243 offset:5120
    s_waitcnt lgkmcnt(6)
    v_mfma_f32_32x32x16_bf16 v[160:175], v[224:227], v[44:47], v[160:175]
    ds_read_b64_tr_b16 v[224:225], v240 offset:8192
    ds_read_b64_tr_b16 v[226:227], v240 offset:9216
    s_waitcnt lgkmcnt(6)
    v_mfma_f32_32x32x16_bf16 v[176:191], v[228:231], v[44:47], v[176:191]
    ds_read_b64_tr_b16 v[228:229], v241 offset:8192
    ds_read_b64_tr_b16 v[230:231], v241 offset:9216
    s_waitcnt lgkmcnt(6)
    v_mfma_f32_32x32x16_bf16 v[192:207], v[232:235], v[44:47], v[192:207]
    ds_read_b64_tr_b16 v[232:233], v242 offset:8192
    ds_read_b64_tr_b16 v[234:235], v242 offset:9216
    s_waitcnt lgkmcnt(6)
    v_mfma_f32_32x32x16_bf16 v[208:223], v[236:239], v[44:47], v[208:223]
    ds_read_b64_tr_b16 v[236:237], v243 offset:8192
    ds_read_b64_tr_b16 v[238:239], v243 offset:9216
    s_waitcnt lgkmcnt(6)
    v_mfma_f32_32x32x16_bf16 v[160:175], v[224:227], v[48:51], v[160:175]
    ds_read_b64_tr_b16 v[224:225], v240 offset:12288
    ds_read_b64_tr_b16 v[226:227], v240 offset:13312
    s_waitcnt lgkmcnt(6)
    v_mfma_f32_32x32x16_bf16 v[176:191], v[228:231], v[48:51], v[176:191]
    ds_read_b64_tr_b16 v[228:229], v241 offset:12288
    ds_read_b64_tr_b16 v[230:231], v241 offset:13312
    s_waitcnt lgkmcnt(6)
    v_mfma_f32_32x32x16_bf16 v[192:207], v[232:235], v[48:51], v[192:207]
    ds_read_b64_tr_b16 v[232:233], v242 offset:12288
    ds_read_b64_tr_b16 v[234:235], v242 offset:13312
    s_waitcnt lgkmcnt(6)
    v_mfma_f32_32x32x16_bf16 v[208:223], v[236:239], v[48:51], v[208:223]
    ds_read_b64_tr_b16 v[236:237], v243 offset:12288
    ds_read_b64_tr_b16 v[238:239], v243 offset:13312
    s_waitcnt lgkmcnt(6)
    v_mfma_f32_32x32x16_bf16 v[160:175], v[224:227], v[52:55], v[160:175]
    ds_read_b64_tr_b16 v[224:225], v240 offset:16384
    ds_read_b64_tr_b16 v[226:227], v240 offset:17408
    s_waitcnt lgkmcnt(6)
    v_mfma_f32_32x32x16_bf16 v[176:191], v[228:231], v[52:55], v[176:191]
    ds_read_b64_tr_b16 v[228:229], v241 offset:16384
    ds_read_b64_tr_b16 v[230:231], v241 offset:17408
    s_waitcnt lgkmcnt(6)
    v_mfma_f32_32x32x16_bf16 v[192:207], v[232:235], v[52:55], v[192:207]
    ds_read_b64_tr_b16 v[232:233], v242 offset:16384
    ds_read_b64_tr_b16 v[234:235], v242 offset:17408
    s_waitcnt lgkmcnt(6)
    v_mfma_f32_32x32x16_bf16 v[208:223], v[236:239], v[52:55], v[208:223]
    ds_read_b64_tr_b16 v[236:237], v243 offset:16384
    ds_read_b64_tr_b16 v[238:239], v243 offset:17408
    s_waitcnt lgkmcnt(6)
    v_mfma_f32_32x32x16_bf16 v[160:175], v[224:227], v[56:59], v[160:175]
    s_waitcnt lgkmcnt(4)
    v_mfma_f32_32x32x16_bf16 v[176:191], v[228:231], v[56:59], v[176:191]
    s_waitcnt lgkmcnt(2)
    v_mfma_f32_32x32x16_bf16 v[192:207], v[232:235], v[56:59], v[192:207]
    s_waitcnt lgkmcnt(0)
    v_mfma_f32_32x32x16_bf16 v[208:223], v[236:239], v[56:59], v[208:223]
    s_lshl_b32 s72, s3, 2
    s_add_u32 s72, s72, s34
    s_cmp_ge_u32 s72, 18
    s_cbranch_scc1 L_qp4
    s_add_u32 s72, s64, s34
    s_lshl_b32 s72, s72, 8
    s_mul_i32 s78, s62, 327680
    s_add_u32 s72, s72, s78
    s_mov_b32 exec_hi, 0xff
    buffer_load_dword v255, v245, s[16:19], s72 offen offset:512
    buffer_load_dword v255, v245, s[16:19], s72 offen offset:640
    s_mov_b64 exec, -1
L_qp4:
    s_waitcnt lgkmcnt(0)
    s_barrier
    ds_read_b64_tr_b16 v[224:225], v240 offset:20480
    ds_read_b64_tr_b16 v[226:227], v240 offset:21504
    ds_read_b64_tr_b16 v[228:229], v241 offset:20480
    ds_read_b64_tr_b16 v[230:231], v241 offset:21504
    ds_read_b64_tr_b16 v[232:233], v242 offset:20480
    ds_read_b64_tr_b16 v[234:235], v242 offset:21504
    ds_read_b64_tr_b16 v[236:237], v243 offset:20480
    ds_read_b64_tr_b16 v[238:239], v243 offset:21504
    s_waitcnt lgkmcnt(6)
    v_mfma_f32_32x32x16_bf16 v[160:175], v[224:227], v[60:63], v[160:175]
    ds_read_b64_tr_b16 v[224:225], v240 offset:24576
    ds_read_b64_tr_b16 v[226:227], v240 offset:25600
    s_waitcnt lgkmcnt(6)
    v_mfma_f32_32x32x16_bf16 v[176:191], v[228:231], v[60:63], v[176:191]
    ds_read_b64_tr_b16 v[228:229], v241 offset:24576
    ds_read_b64_tr_b16 v[230:231], v241 offset:25600
    s_waitcnt lgkmcnt(6)
    v_mfma_f32_32x32x16_bf16 v[192:207], v[232:235], v[60:63], v[192:207]
    ds_read_b64_tr_b16 v[232:233], v242 offset:24576
    ds_read_b64_tr_b16 v[234:235], v242 offset:25600
    s_waitcnt lgkmcnt(6)
    v_mfma_f32_32x32x16_bf16 v[208:223], v[236:239], v[60:63], v[208:223]
    ds_read_b64_tr_b16 v[236:237], v243 offset:24576
    ds_read_b64_tr_b16 v[238:239], v243 offset:25600
    s_waitcnt lgkmcnt(6)
    v_mfma_f32_32x32x16_bf16 v[160:175], v[224:227], v[64:67], v[160:175]
    ds_read_b64_tr_b16 v[224:225], v240 offset:28672
    ds_read_b64_tr_b16 v[226:227], v240 offset:29696
    s_waitcnt lgkmcnt(6)
    v_mfma_f32_32x32x16_bf16 v[176:191], v[228:231], v[64:67], v[176:191]
    ds_read_b64_tr_b16 v[228:229], v241 offset:28672
    ds_read_b64_tr_b16 v[230:231], v241 offset:29696
    s_waitcnt lgkmcnt(6)
    v_mfma_f32_32x32x16_bf16 v[192:207], v[232:235], v[64:67], v[192:207]
    ds_read_b64_tr_b16 v[232:233], v242 offset:28672
    ds_read_b64_tr_b16 v[234:235], v242 offset:29696
    s_waitcnt lgkmcnt(6)
    v_mfma_f32_32x32x16_bf16 v[208:223], v[236:239], v[64:67], v[208:223]
    ds_read_b64_tr_b16 v[236:237], v243 offset:28672
    ds_read_b64_tr_b16 v[238:239], v243 offset:29696
    s_waitcnt lgkmcnt(6)
    v_mfma_f32_32x32x16_bf16 v[160:175], v[224:227], v[68:71], v[160:175]
    ds_read_b64_tr_b16 v[224:225], v240 offset:32768
    ds_read_b64_tr_b16 v[226:227], v240 offset:33792
    s_waitcnt lgkmcnt(6)
    v_mfma_f32_32x32x16_bf16 v[176:191], v[228:231], v[68:71], v[176:191]
    ds_read_b64_tr_b16 v[228:229], v241 offset:32768
    ds_read_b64_tr_b16 v[230:231], v241 offset:33792
    s_waitcnt lgkmcnt(6)
    v_mfma_f32_32x32x16_bf16 v[192:207], v[232:235], v[68:71], v[192:207]
    ds_read_b64_tr_b16 v[232:233], v242 offset:32768
    ds_read_b64_tr_b16 v[234:235], v242 offset:33792
    s_waitcnt lgkmcnt(6)
    v_mfma_f32_32x32x16_bf16 v[208:223], v[236:239], v[68:71], v[208:223]
    ds_read_b64_tr_b16 v[236:237], v243 offset:32768
    ds_read_b64_tr_b16 v[238:239], v243 offset:33792
    s_waitcnt lgkmcnt(6)
    v_mfma_f32_32x32x16_bf16 v[160:175], v[224:227], v[72:75], v[160:175]
    ds_read_b64_tr_b16 v[224:225], v240 offset:36864
    ds_read_b64_tr_b16 v[226:227], v240 offset:37888
    s_waitcnt lgkmcnt(6)
    v_mfma_f32_32x32x16_bf16 v[176:191], v[228:231], v[72:75], v[176:191]
    ds_read_b64_tr_b16 v[228:229], v241 offset:36864
    ds_read_b64_tr_b16 v[230:231], v241 offset:37888
    s_waitcnt lgkmcnt(6)
    v_mfma_f32_32x32x16_bf16 v[192:207], v[232:235], v[72:75], v[192:207]
    ds_read_b64_tr_b16 v[232:233], v242 offset:36864
    ds_read_b64_tr_b16 v[234:235], v242 offset:37888
    s_waitcnt lgkmcnt(6)
    v_mfma_f32_32x32x16_bf16 v[208:223], v[236:239], v[72:75], v[208:223]
    ds_read_b64_tr_b16 v[236:237], v243 offset:36864
    ds_read_b64_tr_b16 v[238:239], v243 offset:37888
    s_waitcnt lgkmcnt(6)
    v_mfma_f32_32x32x16_bf16 v[160:175], v[224:227], v[76:79], v[160:175]
    s_waitcnt lgkmcnt(4)
    v_mfma_f32_32x32x16_bf16 v[176:191], v[228:231], v[76:79], v[176:191]
    s_waitcnt lgkmcnt(2)
    v_mfma_f32_32x32x16_bf16 v[192:207], v[232:235], v[76:79], v[192:207]
    s_waitcnt lgkmcnt(0)
    v_mfma_f32_32x32x16_bf16 v[208:223], v[236:239], v[76:79], v[208:223]
    s_waitcnt lgkmcnt(0)
    s_barrier
    ds_read_b64_tr_b16 v[224:225], v240 offset:0
    ds_read_b64_tr_b16 v[226:227], v240 offset:1024
    ds_read_b64_tr_b16 v[228:229], v241 offset:0
    ds_read_b64_tr_b16 v[230:231], v241 offset:1024
    ds_read_b64_tr_b16 v[232:233], v242 offset:0
    ds_read_b64_tr_b16 v[234:235], v242 offset:1024
    ds_read_b64_tr_b16 v[236:237], v243 offset:0
    ds_read_b64_tr_b16 v[238:239], v243 offset:1024
    s_waitcnt lgkmcnt(6)
    v_mfma_f32_32x32x16_bf16 v[160:175], v[224:227], v[80:83], v[160:175]
    ds_read_b64_tr_b16 v[224:225], v240 offset:4096
    ds_read_b64_tr_b16 v[226:227], v240 offset:5120
    s_waitcnt lgkmcnt(6)
    v_mfma_f32_32x32x16_bf16 v[176:191], v[228:231], v[80:83], v[176:191]
    ds_read_b64_tr_b16 v[228:229], v241 offset:4096
    ds_read_b64_tr_b16 v[230:231], v241 offset:5120
    s_waitcnt lgkmcnt(6)
    v_mfma_f32_32x32x16_bf16 v[192:207], v[232:235], v[80:83], v[192:207]
    ds_read_b64_tr_b16 v[232:233], v242 offset:4096
    ds_read_b64_tr_b16 v[234:235], v242 offset:5120
    s_waitcnt lgkmcnt(6)
    v_mfma_f32_32x32x16_bf16 v[208:223], v[236:239], v[80:83], v[208:223]
    ds_read_b64_tr_b16 v[236:237], v243 offset:4096
    ds_read_b64_tr_b16 v[238:239], v243 offset:5120
    s_waitcnt lgkmcnt(6)
    v_mfma_f32_32x32x16_bf16 v[160:175], v[224:227], v[84:87], v[160:175]
    ds_read_b64_tr_b16 v[224:225], v240 offset:8192
    ds_read_b64_tr_b16 v[226:227], v240 offset:9216
    s_waitcnt lgkmcnt(6)
    v_mfma_f32_32x32x16_bf16 v[176:191], v[228:231], v[84:87], v[176:191]
    ds_read_b64_tr_b16 v[228:229], v241 offset:8192
    ds_read_b64_tr_b16 v[230:231], v241 offset:9216
    s_waitcnt lgkmcnt(6)
    v_mfma_f32_32x32x16_bf16 v[192:207], v[232:235], v[84:87], v[192:207]
    ds_read_b64_tr_b16 v[232:233], v242 offset:8192
    ds_read_b64_tr_b16 v[234:235], v242 offset:9216
    s_waitcnt lgkmcnt(6)
    v_mfma_f32_32x32x16_bf16 v[208:223], v[236:239], v[84:87], v[208:223]
    ds_read_b64_tr_b16 v[236:237], v243 offset:8192
    ds_read_b64_tr_b16 v[238:239], v243 offset:9216
    s_waitcnt lgkmcnt(6)
    v_mfma_f32_32x32x16_bf16 v[160:175], v[224:227], v[88:91], v[160:175]
    ds_read_b64_tr_b16 v[224:225], v240 offset:12288
    ds_read_b64_tr_b16 v[226:227], v240 offset:13312
    s_waitcnt lgkmcnt(6)
    v_mfma_f32_32x32x16_bf16 v[176:191], v[228:231], v[88:91], v[176:191]
    ds_read_b64_tr_b16 v[228:229], v241 offset:12288
    ds_read_b64_tr_b16 v[230:231], v241 offset:13312
    s_waitcnt lgkmcnt(6)
    v_mfma_f32_32x32x16_bf16 v[192:207], v[232:235], v[88:91], v[192:207]
    ds_read_b64_tr_b16 v[232:233], v242 offset:12288
    ds_read_b64_tr_b16 v[234:235], v242 offset:13312
    s_waitcnt lgkmcnt(6)
    v_mfma_f32_32x32x16_bf16 v[208:223], v[236:239], v[88:91], v[208:223]
    ds_read_b64_tr_b16 v[236:237], v243 offset:12288
    ds_read_b64_tr_b16 v[238:239], v243 offset:13312
    s_waitcnt lgkmcnt(6)
    v_mfma_f32_32x32x16_bf16 v[160:175], v[224:227], v[92:95], v[160:175]
    ds_read_b64_tr_b16 v[224:225], v240 offset:16384
    ds_read_b64_tr_b16 v[226:227], v240 offset:17408
    s_waitcnt lgkmcnt(6)
    v_mfma_f32_32x32x16_bf16 v[176:191], v[228:231], v[92:95], v[176:191]
    ds_read_b64_tr_b16 v[228:229], v241 offset:16384
    ds_read_b64_tr_b16 v[230:231], v241 offset:17408
    s_waitcnt lgkmcnt(6)
    v_mfma_f32_32x32x16_bf16 v[192:207], v[232:235], v[92:95], v[192:207]
    ds_read_b64_tr_b16 v[232:233], v242 offset:16384
    ds_read_b64_tr_b16 v[234:235], v242 offset:17408
    s_waitcnt lgkmcnt(6)
    v_mfma_f32_32x32x16_bf16 v[208:223], v[236:239], v[92:95], v[208:223]
    ds_read_b64_tr_b16 v[236:237], v243 offset:16384
    ds_read_b64_tr_b16 v[238:239], v243 offset:17408
    s_waitcnt lgkmcnt(6)
    v_mfma_f32_32x32x16_bf16 v[160:175], v[224:227], v[96:99], v[160:175]
    s_waitcnt lgkmcnt(4)
    v_mfma_f32_32x32x16_bf16 v[176:191], v[228:231], v[96:99], v[176:191]
    s_waitcnt lgkmcnt(2)
    v_mfma_f32_32x32x16_bf16 v[192:207], v[232:235], v[96:99], v[192:207]
    s_waitcnt lgkmcnt(0)
    v_mfma_f32_32x32x16_bf16 v[208:223], v[236:239], v[96:99], v[208:223]
    s_waitcnt lgkmcnt(0)
    s_barrier
    ds_read_b64_tr_b16 v[224:225], v240 offset:20480
    ds_read_b64_tr_b16 v[226:227], v240 offset:21504
    ds_read_b64_tr_b16 v[228:229], v241 offset:20480
    ds_read_b64_tr_b16 v[230:231], v241 offset:21504
    ds_read_b64_tr_b16 v[232:233], v242 offset:20480
    ds_read_b64_tr_b16 v[234:235], v242 offset:21504
    ds_read_b64_tr_b16 v[236:237], v243 offset:20480
    ds_read_b64_tr_b16 v[238:239], v243 offset:21504
    s_waitcnt lgkmcnt(6)
    v_mfma_f32_32x32x16_bf16 v[160:175], v[224:227], v[100:103], v[160:175]
    ds_read_b64_tr_b16 v[224:225], v240 offset:24576
    ds_read_b64_tr_b16 v[226:227], v240 offset:25600
    s_waitcnt lgkmcnt(6)
    v_mfma_f32_32x32x16_bf16 v[176:191], v[228:231], v[100:103], v[176:191]
    ds_read_b64_tr_b16 v[228:229], v241 offset:24576
    ds_read_b64_tr_b16 v[230:231], v241 offset:25600
    s_waitcnt lgkmcnt(6)
    v_mfma_f32_32x32x16_bf16 v[192:207], v[232:235], v[100:103], v[192:207]
    ds_read_b64_tr_b16 v[232:233], v242 offset:24576
    ds_read_b64_tr_b16 v[234:235], v242 offset:25600
    s_waitcnt lgkmcnt(6)
    v_mfma_f32_32x32x16_bf16 v[208:223], v[236:239], v[100:103], v[208:223]
    ds_read_b64_tr_b16 v[236:237], v243 offset:24576
    ds_read_b64_tr_b16 v[238:239], v243 offset:25600
    s_waitcnt lgkmcnt(6)
    v_mfma_f32_32x32x16_bf16 v[160:175], v[224:227], v[104:107], v[160:175]
    ds_read_b64_tr_b16 v[224:225], v240 offset:28672
    ds_read_b64_tr_b16 v[226:227], v240 offset:29696
    s_waitcnt lgkmcnt(6)
    v_mfma_f32_32x32x16_bf16 v[176:191], v[228:231], v[104:107], v[176:191]
    ds_read_b64_tr_b16 v[228:229], v241 offset:28672
    ds_read_b64_tr_b16 v[230:231], v241 offset:29696
    s_waitcnt lgkmcnt(6)
    v_mfma_f32_32x32x16_bf16 v[192:207], v[232:235], v[104:107], v[192:207]
    ds_read_b64_tr_b16 v[232:233], v242 offset:28672
    ds_read_b64_tr_b16 v[234:235], v242 offset:29696
    s_waitcnt lgkmcnt(6)
    v_mfma_f32_32x32x16_bf16 v[208:223], v[236:239], v[104:107], v[208:223]
    ds_read_b64_tr_b16 v[236:237], v243 offset:28672
    ds_read_b64_tr_b16 v[238:239], v243 offset:29696
    s_waitcnt lgkmcnt(6)
    v_mfma_f32_32x32x16_bf16 v[160:175], v[224:227], v[108:111], v[160:175]
    ds_read_b64_tr_b16 v[224:225], v240 offset:32768
    ds_read_b64_tr_b16 v[226:227], v240 offset:33792
    s_waitcnt lgkmcnt(6)
    v_mfma_f32_32x32x16_bf16 v[176:191], v[228:231], v[108:111], v[176:191]
    ds_read_b64_tr_b16 v[228:229], v241 offset:32768
    ds_read_b64_tr_b16 v[230:231], v241 offset:33792
    s_waitcnt lgkmcnt(6)
    v_mfma_f32_32x32x16_bf16 v[192:207], v[232:235], v[108:111], v[192:207]
    ds_read_b64_tr_b16 v[232:233], v242 offset:32768
    ds_read_b64_tr_b16 v[234:235], v242 offset:33792
    s_waitcnt lgkmcnt(6)
    v_mfma_f32_32x32x16_bf16 v[208:223], v[236:239], v[108:111], v[208:223]
    ds_read_b64_tr_b16 v[236:237], v243 offset:32768
    ds_read_b64_tr_b16 v[238:239], v243 offset:33792
    s_waitcnt lgkmcnt(6)
    v_mfma_f32_32x32x16_bf16 v[160:175], v[224:227], v[112:115], v[160:175]
    ds_read_b64_tr_b16 v[224:225], v240 offset:36864
    ds_read_b64_tr_b16 v[226:227], v240 offset:37888
    s_waitcnt lgkmcnt(6)
    v_mfma_f32_32x32x16_bf16 v[176:191], v[228:231], v[112:115], v[176:191]
    ds_read_b64_tr_b16 v[228:229], v241 offset:36864
    ds_read_b64_tr_b16 v[230:231], v241 offset:37888
    s_waitcnt lgkmcnt(6)
    v_mfma_f32_32x32x16_bf16 v[192:207], v[232:235], v[112:115], v[192:207]
    ds_read_b64_tr_b16 v[232:233], v242 offset:36864
    ds_read_b64_tr_b16 v[234:235], v242 offset:37888
    s_waitcnt lgkmcnt(6)
    v_mfma_f32_32x32x16_bf16 v[208:223], v[236:239], v[112:115], v[208:223]
    ds_read_b64_tr_b16 v[236:237], v243 offset:36864
    ds_read_b64_tr_b16 v[238:239], v243 offset:37888
    s_waitcnt lgkmcnt(6)
    v_mfma_f32_32x32x16_bf16 v[160:175], v[224:227], v[116:119], v[160:175]
    s_waitcnt lgkmcnt(4)
    v_mfma_f32_32x32x16_bf16 v[176:191], v[228:231], v[116:119], v[176:191]
    s_waitcnt lgkmcnt(2)
    v_mfma_f32_32x32x16_bf16 v[192:207], v[232:235], v[116:119], v[192:207]
    s_waitcnt lgkmcnt(0)
    v_mfma_f32_32x32x16_bf16 v[208:223], v[236:239], v[116:119], v[208:223]
    s_lshl_b32 s72, s3, 2
    s_add_u32 s72, s72, s34
    s_cmp_lg_u32 s72, 22
    s_cbranch_scc1 L_qp5
    s_mul_i32 s72, s64, 163840
    s_mul_i32 s78, s62, 40960
    s_add_u32 s72, s72, s78
    buffer_load_dword v255, v245, s[20:23], s72 offen offset:0
    buffer_load_dword v255, v245, s[20:23], s72 offen offset:256
L_qp5:
    s_waitcnt lgkmcnt(0)
    s_barrier
    ds_read_b64_tr_b16 v[224:225], v240 offset:0
    ds_read_b64_tr_b16 v[226:227], v240 offset:1024
    ds_read_b64_tr_b16 v[228:229], v241 offset:0
    ds_read_b64_tr_b16 v[230:231], v241 offset:1024
    ds_read_b64_tr_b16 v[232:233], v242 offset:0
    ds_read_b64_tr_b16 v[234:235], v242 offset:1024
    ds_read_b64_tr_b16 v[236:237], v243 offset:0
    ds_read_b64_tr_b16 v[238:239], v243 offset:1024
    s_waitcnt lgkmcnt(6)
    v_mfma_f32_32x32x16_bf16 v[160:175], v[224:227], v[120:123], v[160:175]
    ds_read_b64_tr_b16 v[224:225], v240 offset:4096
    ds_read_b64_tr_b16 v[226:227], v240 offset:5120
    s_waitcnt lgkmcnt(6)
    v_mfma_f32_32x32x16_bf16 v[176:191], v[228:231], v[120:123], v[176:191]
    ds_read_b64_tr_b16 v[228:229], v241 offset:4096
    ds_read_b64_tr_b16 v[230:231], v241 offset:5120
    s_waitcnt lgkmcnt(6)
    v_mfma_f32_32x32x16_bf16 v[192:207], v[232:235], v[120:123], v[192:207]
    ds_read_b64_tr_b16 v[232:233], v242 offset:4096
    ds_read_b64_tr_b16 v[234:235], v242 offset:5120
    s_waitcnt lgkmcnt(6)
    v_mfma_f32_32x32x16_bf16 v[208:223], v[236:239], v[120:123], v[208:223]
    ds_read_b64_tr_b16 v[236:237], v243 offset:4096
    ds_read_b64_tr_b16 v[238:239], v243 offset:5120
    s_waitcnt lgkmcnt(6)
    v_mfma_f32_32x32x16_bf16 v[160:175], v[224:227], v[124:127], v[160:175]
    ds_read_b64_tr_b16 v[224:225], v240 offset:8192
    ds_read_b64_tr_b16 v[226:227], v240 offset:9216
    s_waitcnt lgkmcnt(6)
    v_mfma_f32_32x32x16_bf16 v[176:191], v[228:231], v[124:127], v[176:191]
    ds_read_b64_tr_b16 v[228:229], v241 offset:8192
    ds_read_b64_tr_b16 v[230:231], v241 offset:9216
    s_waitcnt lgkmcnt(6)
    v_mfma_f32_32x32x16_bf16 v[192:207], v[232:235], v[124:127], v[192:207]
    ds_read_b64_tr_b16 v[232:233], v242 offset:8192
    ds_read_b64_tr_b16 v[234:235], v242 offset:9216
    s_waitcnt lgkmcnt(6)
    v_mfma_f32_32x32x16_bf16 v[208:223], v[236:239], v[124:127], v[208:223]
    ds_read_b64_tr_b16 v[236:237], v243 offset:8192
    ds_read_b64_tr_b16 v[238:239], v243 offset:9216
    s_waitcnt lgkmcnt(6)
    v_mfma_f32_32x32x16_bf16 v[160:175], v[224:227], v[128:131], v[160:175]
    ds_read_b64_tr_b16 v[224:225], v240 offset:12288
    ds_read_b64_tr_b16 v[226:227], v240 offset:13312
    s_waitcnt lgkmcnt(6)
    v_mfma_f32_32x32x16_bf16 v[176:191], v[228:231], v[128:131], v[176:191]
    ds_read_b64_tr_b16 v[228:229], v241 offset:12288
    ds_read_b64_tr_b16 v[230:231], v241 offset:13312
    s_waitcnt lgkmcnt(6)
    v_mfma_f32_32x32x16_bf16 v[192:207], v[232:235], v[128:131], v[192:207]
    ds_read_b64_tr_b16 v[232:233], v242 offset:12288
    ds_read_b64_tr_b16 v[234:235], v242 offset:13312
    s_waitcnt lgkmcnt(6)
    v_mfma_f32_32x32x16_bf16 v[208:223], v[236:239], v[128:131], v[208:223]
    ds_read_b64_tr_b16 v[236:237], v243 offset:12288
    ds_read_b64_tr_b16 v[238:239], v243 offset:13312
    s_waitcnt lgkmcnt(6)
    v_mfma_f32_32x32x16_bf16 v[160:175], v[224:227], v[132:135], v[160:175]
    ds_read_b64_tr_b16 v[224:225], v240 offset:16384
    ds_read_b64_tr_b16 v[226:227], v240 offset:17408
    s_waitcnt lgkmcnt(6)
    v_mfma_f32_32x32x16_bf16 v[176:191], v[228:231], v[132:135], v[176:191]
    ds_read_b64_tr_b16 v[228:229], v241 offset:16384
    ds_read_b64_tr_b16 v[230:231], v241 offset:17408
    s_waitcnt lgkmcnt(6)
    v_mfma_f32_32x32x16_bf16 v[192:207], v[232:235], v[132:135], v[192:207]
    ds_read_b64_tr_b16 v[232:233], v242 offset:16384
    ds_read_b64_tr_b16 v[234:235], v242 offset:17408
    s_waitcnt lgkmcnt(6)
    v_mfma_f32_32x32x16_bf16 v[208:223], v[236:239], v[132:135], v[208:223]
    ds_read_b64_tr_b16 v[236:237], v243 offset:16384
    ds_read_b64_tr_b16 v[238:239], v243 offset:17408
    s_waitcnt lgkmcnt(6)
    v_mfma_f32_32x32x16_bf16 v[160:175], v[224:227], v[136:139], v[160:175]
    s_waitcnt lgkmcnt(4)
    v_mfma_f32_32x32x16_bf16 v[176:191], v[228:231], v[136:139], v[176:191]
    s_waitcnt lgkmcnt(2)
    v_mfma_f32_32x32x16_bf16 v[192:207], v[232:235], v[136:139], v[192:207]
    s_waitcnt lgkmcnt(0)
    v_mfma_f32_32x32x16_bf16 v[208:223], v[236:239], v[136:139], v[208:223]
    s_waitcnt lgkmcnt(0)
    s_barrier
    ds_read_b64_tr_b16 v[224:225], v240 offset:20480
    ds_read_b64_tr_b16 v[226:227], v240 offset:21504
    ds_read_b64_tr_b16 v[228:229], v241 offset:20480
    ds_read_b64_tr_b16 v[230:231], v241 offset:21504
    ds_read_b64_tr_b16 v[232:233], v242 offset:20480
    ds_read_b64_tr_b16 v[234:235], v242 offset:21504
    ds_read_b64_tr_b16 v[236:237], v243 offset:20480
    ds_read_b64_tr_b16 v[238:239], v243 offset:21504
    s_waitcnt lgkmcnt(6)
    v_mfma_f32_32x32x16_bf16 v[160:175], v[224:227], v[140:143], v[160:175]
    ds_read_b64_tr_b16 v[224:225], v240 offset:24576
    ds_read_b64_tr_b16 v[226:227], v240 offset:25600
    s_waitcnt lgkmcnt(6)
    v_mfma_f32_32x32x16_bf16 v[176:191], v[228:231], v[140:143], v[176:191]
    ds_read_b64_tr_b16 v[228:229], v241 offset:24576
    ds_read_b64_tr_b16 v[230:231], v241 offset:25600
    s_waitcnt lgkmcnt(6)
    v_mfma_f32_32x32x16_bf16 v[192:207], v[232:235], v[140:143], v[192:207]
    ds_read_b64_tr_b16 v[232:233], v242 offset:24576
    ds_read_b64_tr_b16 v[234:235], v242 offset:25600
    s_waitcnt lgkmcnt(6)
    v_mfma_f32_32x32x16_bf16 v[208:223], v[236:239], v[140:143], v[208:223]
    ds_read_b64_tr_b16 v[236:237], v243 offset:24576
    ds_read_b64_tr_b16 v[238:239], v243 offset:25600
    s_waitcnt lgkmcnt(6)
    v_mfma_f32_32x32x16_bf16 v[160:175], v[224:227], v[144:147], v[160:175]
    ds_read_b64_tr_b16 v[224:225], v240 offset:28672
    ds_read_b64_tr_b16 v[226:227], v240 offset:29696
    s_waitcnt lgkmcnt(6)
    v_mfma_f32_32x32x16_bf16 v[176:191], v[228:231], v[144:147], v[176:191]
    ds_read_b64_tr_b16 v[228:229], v241 offset:28672
    ds_read_b64_tr_b16 v[230:231], v241 offset:29696
    s_waitcnt lgkmcnt(6)
    v_mfma_f32_32x32x16_bf16 v[192:207], v[232:235], v[144:147], v[192:207]
    ds_read_b64_tr_b16 v[232:233], v242 offset:28672
    ds_read_b64_tr_b16 v[234:235], v242 offset:29696
    s_waitcnt lgkmcnt(6)
    v_mfma_f32_32x32x16_bf16 v[208:223], v[236:239], v[144:147], v[208:223]
    ds_read_b64_tr_b16 v[236:237], v243 offset:28672
    ds_read_b64_tr_b16 v[238:239], v243 offset:29696
    s_waitcnt lgkmcnt(6)
    v_mfma_f32_32x32x16_bf16 v[160:175], v[224:227], v[148:151], v[160:175]
    ds_read_b64_tr_b16 v[224:225], v240 offset:32768
    ds_read_b64_tr_b16 v[226:227], v240 offset:33792
    s_waitcnt lgkmcnt(6)
    v_mfma_f32_32x32x16_bf16 v[176:191], v[228:231], v[148:151], v[176:191]
    ds_read_b64_tr_b16 v[228:229], v241 offset:32768
    ds_read_b64_tr_b16 v[230:231], v241 offset:33792
    s_waitcnt lgkmcnt(6)
    v_mfma_f32_32x32x16_bf16 v[192:207], v[232:235], v[148:151], v[192:207]
    ds_read_b64_tr_b16 v[232:233], v242 offset:32768
    ds_read_b64_tr_b16 v[234:235], v242 offset:33792
    s_waitcnt lgkmcnt(6)
    v_mfma_f32_32x32x16_bf16 v[208:223], v[236:239], v[148:151], v[208:223]
    ds_read_b64_tr_b16 v[236:237], v243 offset:32768
    ds_read_b64_tr_b16 v[238:239], v243 offset:33792
    s_waitcnt lgkmcnt(6)
    v_mfma_f32_32x32x16_bf16 v[160:175], v[224:227], v[152:155], v[160:175]
    ds_read_b64_tr_b16 v[224:225], v240 offset:36864
    ds_read_b64_tr_b16 v[226:227], v240 offset:37888
    s_waitcnt lgkmcnt(6)
    v_mfma_f32_32x32x16_bf16 v[176:191], v[228:231], v[152:155], v[176:191]
    ds_read_b64_tr_b16 v[228:229], v241 offset:36864
    ds_read_b64_tr_b16 v[230:231], v241 offset:37888
    s_waitcnt lgkmcnt(6)
    v_mfma_f32_32x32x16_bf16 v[192:207], v[232:235], v[152:155], v[192:207]
    ds_read_b64_tr_b16 v[232:233], v242 offset:36864
    ds_read_b64_tr_b16 v[234:235], v242 offset:37888
    s_waitcnt lgkmcnt(6)
    v_mfma_f32_32x32x16_bf16 v[208:223], v[236:239], v[152:155], v[208:223]
    ds_read_b64_tr_b16 v[236:237], v243 offset:36864
    ds_read_b64_tr_b16 v[238:239], v243 offset:37888
    s_waitcnt lgkmcnt(6)
    v_mfma_f32_32x32x16_bf16 v[160:175], v[224:227], v[156:159], v[160:175]
    s_waitcnt lgkmcnt(4)
    v_mfma_f32_32x32x16_bf16 v[176:191], v[228:231], v[156:159], v[176:191]
    s_waitcnt lgkmcnt(2)
    v_mfma_f32_32x32x16_bf16 v[192:207], v[232:235], v[156:159], v[192:207]
    s_waitcnt lgkmcnt(0)
    v_mfma_f32_32x32x16_bf16 v[208:223], v[236:239], v[156:159], v[208:223]
    s_nop 5
    v_mul_f32 v160, s86, v160
    v_mul_f32 v161, s86, v161
    v_mul_f32 v162, s86, v162
    v_mul_f32 v163, s86, v163
    v_mul_f32 v164, s86, v164
    v_mul_f32 v165, s86, v165
    v_mul_f32 v166, s86, v166
    v_mul_f32 v167, s86, v167
    v_cvt_pk_bf16_f32 v160, v160, v161
    v_cvt_pk_bf16_f32 v161, v162, v163
    v_cvt_pk_bf16_f32 v162, v164, v165
    v_cvt_pk_bf16_f32 v163, v166, v167
    ds_write_b128 v244, v[160:163] offset:0
    v_mul_f32 v168, s86, v168
    v_mul_f32 v169, s86, v169
    v_mul_f32 v170, s86, v170
    v_mul_f32 v171, s86, v171
    v_mul_f32 v172, s86, v172
    v_mul_f32 v173, s86, v173
    v_mul_f32 v174, s86, v174
    v_mul_f32 v175, s86, v175
    v_cvt_pk_bf16_f32 v164, v168, v169
    v_cvt_pk_bf16_f32 v165, v170, v171
    v_cvt_pk_bf16_f32 v166, v172, v173
    v_cvt_pk_bf16_f32 v167, v174, v175
    ds_write_b128 v244, v[164:167] offset:3072
    v_mul_f32 v176, s86, v176
    v_mul_f32 v177, s86, v177
    v_mul_f32 v178, s86, v178
    v_mul_f32 v179, s86, v179
    v_mul_f32 v180, s86, v180
    v_mul_f32 v181, s86, v181
    v_mul_f32 v182, s86, v182
    v_mul_f32 v183, s86, v183
    v_cvt_pk_bf16_f32 v176, v176, v177
    v_cvt_pk_bf16_f32 v177, v178, v179
    v_cvt_pk_bf16_f32 v178, v180, v181
    v_cvt_pk_bf16_f32 v179, v182, v183
    ds_write_b128 v244, v[176:179] offset:6144
    v_mul_f32 v184, s86, v184
    v_mul_f32 v185, s86, v185
    v_mul_f32 v186, s86, v186
    v_mul_f32 v187, s86, v187
    v_mul_f32 v188, s86, v188
    v_mul_f32 v189, s86, v189
    v_mul_f32 v190, s86, v190
    v_mul_f32 v191, s86, v191
    v_cvt_pk_bf16_f32 v180, v184, v185
    v_cvt_pk_bf16_f32 v181, v186, v187
    v_cvt_pk_bf16_f32 v182, v188, v189
    v_cvt_pk_bf16_f32 v183, v190, v191
    ds_write_b128 v244, v[180:183] offset:9216
    v_mul_f32 v192, s86, v192
    v_mul_f32 v193, s86, v193
    v_mul_f32 v194, s86, v194
    v_mul_f32 v195, s86, v195
    v_mul_f32 v196, s86, v196
    v_mul_f32 v197, s86, v197
    v_mul_f32 v198, s86, v198
    v_mul_f32 v199, s86, v199
    v_cvt_pk_bf16_f32 v192, v192, v193
    v_cvt_pk_bf16_f32 v193, v194, v195
    v_cvt_pk_bf16_f32 v194, v196, v197
    v_cvt_pk_bf16_f32 v195, v198, v199
    ds_write_b128 v244, v[192:195] offset:12288
    v_mul_f32 v200, s86, v200
    v_mul_f32 v201, s86, v201
    v_mul_f32 v202, s86, v202
    v_mul_f32 v203, s86, v203
    v_mul_f32 v204, s86, v204
    v_mul_f32 v205, s86, v205
    v_mul_f32 v206, s86, v206
    v_mul_f32 v207, s86, v207
    v_cvt_pk_bf16_f32 v196, v200, v201
    v_cvt_pk_bf16_f32 v197, v202, v203
    v_cvt_pk_bf16_f32 v198, v204, v205
    v_cvt_pk_bf16_f32 v199, v206, v207
    ds_write_b128 v244, v[196:199] offset:15360
    v_mul_f32 v208, s86, v208
    v_mul_f32 v209, s86, v209
    v_mul_f32 v210, s86, v210
    v_mul_f32 v211, s86, v211
    v_mul_f32 v212, s86, v212
    v_mul_f32 v213, s86, v213
    v_mul_f32 v214, s86, v214
    v_mul_f32 v215, s86, v215
    v_cvt_pk_bf16_f32 v208, v208, v209
    v_cvt_pk_bf16_f32 v209, v210, v211
    v_cvt_pk_bf16_f32 v210, v212, v213
    v_cvt_pk_bf16_f32 v211, v214, v215
    ds_write_b128 v244, v[208:211] offset:18432
    v_mul_f32 v216, s86, v216
    v_mul_f32 v217, s86, v217
    v_mul_f32 v218, s86, v218
    v_mul_f32 v219, s86, v219
    v_mul_f32 v220, s86, v220
    v_mul_f32 v221, s86, v221
    v_mul_f32 v222, s86, v222
    v_mul_f32 v223, s86, v223
    v_cvt_pk_bf16_f32 v212, v216, v217
    v_cvt_pk_bf16_f32 v213, v218, v219
    v_cvt_pk_bf16_f32 v214, v220, v221
    v_cvt_pk_bf16_f32 v215, v222, v223
    ds_write_b128 v244, v[212:215] offset:21504
    s_waitcnt lgkmcnt(0)
    s_add_u32 s34, s34, 1
    s_cmp_lg_u32 s34, 3
    s_barrier
    s_cbranch_scc1 L_qp_m
L_a24:
    s_setprio 2
    s_lshl_b32 s72, s66, 3
    v_mov_b32 v0, s72
    global_load_dword v1, v0, s[32:33] sc1
    v_mbcnt_lo_u32_b32 v188, -1, 0
    v_mbcnt_hi_u32_b32 v188, -1, v188
    v_lshrrev_b32 v191, 3, v188
    v_mul_u32_u24 v189, 1280, v191
    v_bfe_u32 v191, v188, 4, 1
    v_lshlrev_b32 v191, 2, v191
    v_and_b32 v192, 7, v188
    v_xor_b32 v191, v191, v192
    v_lshl_add_u32 v189, v191, 4, v189
    s_lshl_b32 s78, s79, 7
    s_mul_i32 s76, s64, 163840
    s_add_u32 s74, s76, s78
    s_add_u32 s72, s74, 0
    buffer_load_dwordx4 v[194:197], v189, s[20:23], s72 offen
    s_add_u32 s72, s74, 10240
    buffer_load_dwordx4 v[198:201], v189, s[20:23], s72 offen
    s_add_u32 s72, s74, 20480
    buffer_load_dwordx4 v[202:205], v189, s[20:23], s72 offen
    s_add_u32 s72, s74, 30720
    buffer_load_dwordx4 v[206:209], v189, s[20:23], s72 offen
    s_add_u32 s72, s74, 40960
    buffer_load_dwordx4 v[210:213], v189, s[20:23], s72 offen
    s_add_u32 s72, s74, 51200
    buffer_load_dwordx4 v[214:217], v189, s[20:23], s72 offen
    s_add_u32 s72, s74, 61440
    buffer_load_dwordx4 v[218:221], v189, s[20:23], s72 offen
    s_add_u32 s72, s74, 71680
    buffer_load_dwordx4 v[222:225], v189, s[20:23], s72 offen
    s_lshl_b32 s92, s79, 12
    s_add_u32 s92, s92, 122880
    s_lshl_b32 s78, s79, 6
    s_add_u32 s76, s76, s78
    s_add_u32 s76, s76, 1024
    v_bfe_u32 v191, v188, 4, 1
    v_lshlrev_b32 v186, 5, v191
    v_and_b32 v191, 1, v188
    v_lshl_add_u32 v186, v191, 4, v186
    v_bfe_u32 v191, v188, 1, 1
    v_lshl_add_u32 v186, v191, 3, v186
    v_add_u32 v186, s92, v186
    v_lshrrev_b32 v191, 5, v188
    v_bfe_u32 v192, v188, 2, 2
    v_lshl_add_u32 v191, v191, 3, v192
    v_lshl_add_u32 v184, v191, 7, v186
    v_lshl_add_u32 v186, v191, 6, v186
    v_bfe_u32 v192, v188, 3, 1
    v_lshl_add_u32 v184, v192, 6, v184
    v_xor_b32 v185, 64, v184
    v_lshrrev_b32 v191, 2, v188
    v_mul_u32_u24 v190, 1280, v191
    v_and_b32 v191, 3, v188
    v_lshl_add_u32 v190, v191, 4, v190
    v_lshlrev_b32 v188, 4, v188
    v_add_u32 v193, s92, v188
    v_mov_b32 v191, 1
    v_mov_b32 v192, 0
    s_lshl_b32 s72, s66, 3
    s_add_u32 s72, s72, s65
    s_mul_i32 s69, s72, 122880
    s_mul_i32 s72, s79, 12288
    s_add_u32 s69, s69, s72
    s_lshl_b32 s70, s66, 9
    s_lshl_b32 s72, s79, 7
    s_add_u32 s70, s70, s72
    s_lshl_b32 s72, s65, 2
    s_add_u32 s70, s70, s72
    s_add_u32 s70, s70, 41943040
    v_lshrrev_b32 v2, 2, v188
    v_and_b32 v2, 0x7f, v2
    s_mul_i32 s73, s66, 983040
    s_lshl_b32 s72, s79, 11
    s_add_u32 s73, s73, s72
    s_mul_i32 s72, s65, 6144
    s_add_u32 s42, s73, s72
    s_lshr_b32 s78, s65, 1
    s_lshl_b32 s45, s66, 9
    s_lshl_b32 s72, s78, 7
    s_add_u32 s45, s45, s72
    s_add_u32 s45, s45, 41943040
    s_mul_i32 s73, s62, 245760
    s_mul_i32 s72, s63, 1280
    s_add_u32 s73, s73, s72
    s_mul_i32 s72, s79, 81920
    s_add_u32 s73, s73, s72
    s_lshl_b32 s72, s65, 6
    s_add_u32 s36, s73, s72
    s_mov_b32 s35, 0x40000
    s_waitcnt vmcnt(8)
L_a_c:
    v_readfirstlane_b32 s72, v1
    s_sub_u32 s35, s35, 1
    s_cmp_ge_u32 s72, 8
    s_cbranch_scc1 L_a_m
L_a_c2:
    global_load_dword v1, v0, s[32:33] sc1
    s_cmp_gt_i32 s35, 0
    s_waitcnt vmcnt(0)
    s_cbranch_scc1 L_a_c
L_a_m:
    s_waitcnt vmcnt(6)
    ds_write_b128 v193, v[194:197] offset:0
    ds_write_b128 v193, v[198:201] offset:1024
    s_add_u32 s72, s74, 81920
    buffer_load_dwordx4 v[226:229], v189, s[20:23], s72 offen
    s_add_u32 s72, s74, 92160
    buffer_load_dwordx4 v[230:233], v189, s[20:23], s72 offen
    s_waitcnt vmcnt(6)
    ds_write_b128 v193, v[202:205] offset:2048
    ds_write_b128 v193, v[206:209] offset:3072
    s_add_u32 s72, s74, 102400
    buffer_load_dwordx4 v[234:237], v189, s[20:23], s72 offen
    s_add_u32 s72, s74, 112640
    buffer_load_dwordx4 v[238:241], v189, s[20:23], s72 offen
    s_barrier
    v_add_u32 v187, 98304, v188
    ds_read_b64_tr_b16 v[168:169], v184 offset:0
    ds_read_b64_tr_b16 v[170:171], v184 offset:512
    ds_read_b128 v[144:147], v187 offset:0
    ds_read_b128 v[148:151], v187 offset:1024
    ds_read_b128 v[152:155], v187 offset:2048
    ds_read_b64_tr_b16 v[172:173], v185 offset:0
    ds_read_b64_tr_b16 v[174:175], v185 offset:512
    s_add_u32 s72, s74, 122880
    buffer_load_dwordx4 v[242:245], v189, s[20:23], s72 offen
    s_add_u32 s72, s74, 133120
    buffer_load_dwordx4 v[246:249], v189, s[20:23], s72 offen
    s_add_u32 s72, s74, 143360
    buffer_load_dwordx4 v[194:197], v189, s[20:23], s72 offen
    s_add_u32 s72, s74, 153600
    buffer_load_dwordx4 v[198:201], v189, s[20:23], s72 offen
    s_add_u32 s72, s74, 327680
    buffer_load_dwordx4 v[202:205], v189, s[20:23], s72 offen
    s_add_u32 s72, s74, 337920
    buffer_load_dwordx4 v[206:209], v189, s[20:23], s72 offen
    s_waitcnt lgkmcnt(0)
    v_mfma_f32_32x32x16_bf16 v[0:15], v[168:171], v[144:147], 0
    ds_read_b64_tr_b16 v[176:177], v184 offset:2048
    ds_read_b64_tr_b16 v[178:179], v184 offset:2560
    ds_read_b128 v[156:159], v187 offset:3072
    v_mfma_f32_32x32x16_bf16 v[32:47], v[168:171], v[148:151], 0
    ds_read_b128 v[160:163], v187 offset:4096
    ds_read_b128 v[164:167], v187 offset:5120
    ds_read_b64_tr_b16 v[180:181], v185 offset:2048
    v_mfma_f32_32x32x16_bf16 v[64:79], v[168:171], v[152:155], 0
    ds_read_b64_tr_b16 v[182:183], v185 offset:2560
    v_mfma_f32_32x32x16_bf16 v[16:31], v[172:175], v[144:147], 0
    s_waitcnt vmcnt(12)
    ds_write_b128 v193, v[210:213] offset:0
    ds_write_b128 v193, v[214:217] offset:1024
    v_mfma_f32_32x32x16_bf16 v[48:63], v[172:175], v[148:151], 0
    s_add_u32 s72, s74, 348160
    buffer_load_dwordx4 v[210:213], v189, s[20:23], s72 offen
    s_add_u32 s72, s74, 358400
    buffer_load_dwordx4 v[214:217], v189, s[20:23], s72 offen
    v_mfma_f32_32x32x16_bf16 v[80:95], v[172:175], v[152:155], 0
    s_waitcnt lgkmcnt(2)
    v_mfma_f32_32x32x16_bf16 v[0:15], v[176:179], v[156:159], v[0:15]
    ds_read_b64_tr_b16 v[168:169], v184 offset:0
    ds_read_b64_tr_b16 v[170:171], v184 offset:512
    ds_read_b128 v[144:147], v187 offset:6144
    v_mfma_f32_32x32x16_bf16 v[32:47], v[176:179], v[160:163], v[32:47]
    ds_read_b128 v[148:151], v187 offset:7168
    ds_read_b128 v[152:155], v187 offset:8192
    ds_read_b64_tr_b16 v[172:173], v185 offset:0
    v_mfma_f32_32x32x16_bf16 v[64:79], v[176:179], v[164:167], v[64:79]
    ds_read_b64_tr_b16 v[174:175], v185 offset:512
    v_mfma_f32_32x32x16_bf16 v[16:31], v[180:183], v[156:159], v[16:31]
    s_waitcnt vmcnt(12)
    ds_write_b128 v193, v[218:221] offset:2048
    ds_write_b128 v193, v[222:225] offset:3072
    v_mfma_f32_32x32x16_bf16 v[48:63], v[180:183], v[160:163], v[48:63]
    s_add_u32 s72, s74, 368640
    buffer_load_dwordx4 v[218:221], v189, s[20:23], s72 offen
    s_add_u32 s72, s74, 378880
    buffer_load_dwordx4 v[222:225], v189, s[20:23], s72 offen
    v_mfma_f32_32x32x16_bf16 v[80:95], v[180:183], v[164:167], v[80:95]
    s_waitcnt lgkmcnt(2)
    v_mfma_f32_32x32x16_bf16 v[0:15], v[168:171], v[144:147], v[0:15]
    ds_read_b64_tr_b16 v[176:177], v184 offset:2048
    ds_read_b64_tr_b16 v[178:179], v184 offset:2560
    ds_read_b128 v[156:159], v187 offset:9216
    v_mfma_f32_32x32x16_bf16 v[32:47], v[168:171], v[148:151], v[32:47]
    ds_read_b128 v[160:163], v187 offset:10240
    ds_read_b128 v[164:167], v187 offset:11264
    ds_read_b64_tr_b16 v[180:181], v185 offset:2048
    v_mfma_f32_32x32x16_bf16 v[64:79], v[168:171], v[152:155], v[64:79]
    ds_read_b64_tr_b16 v[182:183], v185 offset:2560
    v_mfma_f32_32x32x16_bf16 v[16:31], v[172:175], v[144:147], v[16:31]
    s_waitcnt vmcnt(12)
    ds_write_b128 v193, v[226:229] offset:0
    ds_write_b128 v193, v[230:233] offset:1024
    v_mfma_f32_32x32x16_bf16 v[48:63], v[172:175], v[148:151], v[48:63]
    s_add_u32 s72, s74, 389120
    buffer_load_dwordx4 v[226:229], v189, s[20:23], s72 offen
    s_add_u32 s72, s74, 399360
    buffer_load_dwordx4 v[230:233], v189, s[20:23], s72 offen
    v_mfma_f32_32x32x16_bf16 v[80:95], v[172:175], v[152:155], v[80:95]
    s_waitcnt lgkmcnt(2)
    v_mfma_f32_32x32x16_bf16 v[0:15], v[176:179], v[156:159], v[0:15]
    ds_read_b64_tr_b16 v[168:169], v184 offset:0
    ds_read_b64_tr_b16 v[170:171], v184 offset:512
    ds_read_b128 v[144:147], v187 offset:12288
    v_mfma_f32_32x32x16_bf16 v[32:47], v[176:179], v[160:163], v[32:47]
    ds_read_b128 v[148:151], v187 offset:13312
    ds_read_b128 v[152:155], v187 offset:14336
    ds_read_b64_tr_b16 v[172:173], v185 offset:0
    v_mfma_f32_32x32x16_bf16 v[64:79], v[176:179], v[164:167], v[64:79]
    ds_read_b64_tr_b16 v[174:175], v185 offset:512
    v_mfma_f32_32x32x16_bf16 v[16:31], v[180:183], v[156:159], v[16:31]
    s_waitcnt vmcnt(12)
    ds_write_b128 v193, v[234:237] offset:2048
    ds_write_b128 v193, v[238:241] offset:3072
    v_mfma_f32_32x32x16_bf16 v[48:63], v[180:183], v[160:163], v[48:63]
    s_add_u32 s72, s74, 409600
    buffer_load_dwordx4 v[234:237], v189, s[20:23], s72 offen
    s_add_u32 s72, s74, 419840
    buffer_load_dwordx4 v[238:241], v189, s[20:23], s72 offen
    v_mfma_f32_32x32x16_bf16 v[80:95], v[180:183], v[164:167], v[80:95]
    s_waitcnt lgkmcnt(2)
    s_barrier
    v_mfma_f32_32x32x16_bf16 v[0:15], v[168:171], v[144:147], v[0:15]
    ds_read_b64_tr_b16 v[176:177], v184 offset:2048
    ds_read_b64_tr_b16 v[178:179], v184 offset:2560
    ds_read_b128 v[156:159], v187 offset:15360
    v_mfma_f32_32x32x16_bf16 v[32:47], v[168:171], v[148:151], v[32:47]
    ds_read_b128 v[160:163], v187 offset:16384
    ds_read_b128 v[164:167], v187 offset:17408
    ds_read_b64_tr_b16 v[180:181], v185 offset:2048
    v_mfma_f32_32x32x16_bf16 v[64:79], v[168:171], v[152:155], v[64:79]
    ds_read_b64_tr_b16 v[182:183], v185 offset:2560
    v_mfma_f32_32x32x16_bf16 v[16:31], v[172:175], v[144:147], v[16:31]
    s_waitcnt vmcnt(12)
    ds_write_b128 v193, v[242:245] offset:0
    ds_write_b128 v193, v[246:249] offset:1024
    v_mfma_f32_32x32x16_bf16 v[48:63], v[172:175], v[148:151], v[48:63]
    s_add_u32 s72, s74, 430080
    buffer_load_dwordx4 v[242:245], v189, s[20:23], s72 offen
    s_add_u32 s72, s74, 440320
    buffer_load_dwordx4 v[246:249], v189, s[20:23], s72 offen
    v_mfma_f32_32x32x16_bf16 v[80:95], v[172:175], v[152:155], v[80:95]
    s_waitcnt lgkmcnt(2)
    v_mfma_f32_32x32x16_bf16 v[0:15], v[176:179], v[156:159], v[0:15]
    ds_read_b64_tr_b16 v[168:169], v184 offset:0
    ds_read_b64_tr_b16 v[170:171], v184 offset:512
    ds_read_b128 v[144:147], v187 offset:18432
    v_mfma_f32_32x32x16_bf16 v[32:47], v[176:179], v[160:163], v[32:47]
    ds_read_b128 v[148:151], v187 offset:19456
    ds_read_b128 v[152:155], v187 offset:20480
    ds_read_b64_tr_b16 v[172:173], v185 offset:0
    v_mfma_f32_32x32x16_bf16 v[64:79], v[176:179], v[164:167], v[64:79]
    ds_read_b64_tr_b16 v[174:175], v185 offset:512
    v_mfma_f32_32x32x16_bf16 v[16:31], v[180:183], v[156:159], v[16:31]
    s_waitcnt vmcnt(12)
    ds_write_b128 v193, v[194:197] offset:2048
    ds_write_b128 v193, v[198:201] offset:3072
    v_mfma_f32_32x32x16_bf16 v[48:63], v[180:183], v[160:163], v[48:63]
    s_add_u32 s72, s74, 450560
    buffer_load_dwordx4 v[194:197], v189, s[20:23], s72 offen
    s_add_u32 s72, s74, 460800
    buffer_load_dwordx4 v[198:201], v189, s[20:23], s72 offen
    v_mfma_f32_32x32x16_bf16 v[80:95], v[180:183], v[164:167], v[80:95]
    s_waitcnt lgkmcnt(2)
    v_mfma_f32_32x32x16_bf16 v[0:15], v[168:171], v[144:147], v[0:15]
    ds_read_b64_tr_b16 v[176:177], v184 offset:2048
    ds_read_b64_tr_b16 v[178:179], v184 offset:2560
    ds_read_b128 v[156:159], v187 offset:21504
    v_mfma_f32_32x32x16_bf16 v[32:47], v[168:171], v[148:151], v[32:47]
    ds_read_b128 v[160:163], v187 offset:22528
    ds_read_b128 v[164:167], v187 offset:23552
    ds_read_b64_tr_b16 v[180:181], v185 offset:2048
    v_mfma_f32_32x32x16_bf16 v[64:79], v[168:171], v[152:155], v[64:79]
    ds_read_b64_tr_b16 v[182:183], v185 offset:2560
    v_mfma_f32_32x32x16_bf16 v[16:31], v[172:175], v[144:147], v[16:31]
    s_waitcnt vmcnt(12)
    ds_write_b128 v193, v[202:205] offset:0
    ds_write_b128 v193, v[206:209] offset:1024
    v_mfma_f32_32x32x16_bf16 v[48:63], v[172:175], v[148:151], v[48:63]
    s_add_u32 s72, s74, 471040
    buffer_load_dwordx4 v[202:205], v189, s[20:23], s72 offen
    s_add_u32 s72, s74, 481280
    buffer_load_dwordx4 v[206:209], v189, s[20:23], s72 offen
    v_mfma_f32_32x32x16_bf16 v[80:95], v[172:175], v[152:155], v[80:95]
    s_waitcnt lgkmcnt(2)
    v_mfma_f32_32x32x16_bf16 v[0:15], v[176:179], v[156:159], v[0:15]
    v_add_u32 v187, 139264, v188
    ds_read_b64_tr_b16 v[168:169], v184 offset:0
    ds_read_b64_tr_b16 v[170:171], v184 offset:512
    v_mfma_f32_32x32x16_bf16 v[32:47], v[176:179], v[160:163], v[32:47]
    ds_read_b128 v[144:147], v187 offset:0
    ds_read_b128 v[148:151], v187 offset:1024
    ds_read_b128 v[152:155], v187 offset:2048
    v_mfma_f32_32x32x16_bf16 v[64:79], v[176:179], v[164:167], v[64:79]
    ds_read_b64_tr_b16 v[172:173], v185 offset:0
    ds_read_b64_tr_b16 v[174:175], v185 offset:512
    v_mfma_f32_32x32x16_bf16 v[16:31], v[180:183], v[156:159], v[16:31]
    s_waitcnt vmcnt(12)
    ds_write_b128 v193, v[210:213] offset:2048
    ds_write_b128 v193, v[214:217] offset:3072
    v_mfma_f32_32x32x16_bf16 v[48:63], v[180:183], v[160:163], v[48:63]
    s_add_u32 s72, s74, 163840
    buffer_load_dwordx4 v[210:213], v189, s[20:23], s72 offen
    s_add_u32 s72, s74, 174080
    buffer_load_dwordx4 v[214:217], v189, s[20:23], s72 offen
    v_mfma_f32_32x32x16_bf16 v[80:95], v[180:183], v[164:167], v[80:95]
    s_waitcnt lgkmcnt(2)
    s_barrier
    v_mfma_f32_32x32x16_bf16 v[0:15], v[168:171], v[144:147], v[0:15]
    ds_read_b64_tr_b16 v[176:177], v184 offset:2048
    ds_read_b64_tr_b16 v[178:179], v184 offset:2560
    ds_read_b128 v[156:159], v187 offset:3072
    v_mfma_f32_32x32x16_bf16 v[32:47], v[168:171], v[148:151], v[32:47]
    ds_read_b128 v[160:163], v187 offset:4096
    ds_read_b128 v[164:167], v187 offset:5120
    ds_read_b64_tr_b16 v[180:181], v185 offset:2048
    v_mfma_f32_32x32x16_bf16 v[64:79], v[168:171], v[152:155], v[64:79]
    ds_read_b64_tr_b16 v[182:183], v185 offset:2560
    v_mfma_f32_32x32x16_bf16 v[16:31], v[172:175], v[144:147], v[16:31]
    s_waitcnt vmcnt(12)
    ds_write_b128 v193, v[218:221] offset:0
    ds_write_b128 v193, v[222:225] offset:1024
    v_mfma_f32_32x32x16_bf16 v[48:63], v[172:175], v[148:151], v[48:63]
    s_add_u32 s72, s74, 184320
    buffer_load_dwordx4 v[218:221], v189, s[20:23], s72 offen
    s_add_u32 s72, s74, 194560
    buffer_load_dwordx4 v[222:225], v189, s[20:23], s72 offen
    v_mfma_f32_32x32x16_bf16 v[80:95], v[172:175], v[152:155], v[80:95]
    s_waitcnt lgkmcnt(2)
    v_mfma_f32_32x32x16_bf16 v[0:15], v[176:179], v[156:159], v[0:15]
    ds_read_b64_tr_b16 v[168:169], v184 offset:0
    ds_read_b64_tr_b16 v[170:171], v184 offset:512
    ds_read_b128 v[144:147], v187 offset:6144
    v_mfma_f32_32x32x16_bf16 v[32:47], v[176:179], v[160:163], v[32:47]
    ds_read_b128 v[148:151], v187 offset:7168
    ds_read_b128 v[152:155], v187 offset:8192
    ds_read_b64_tr_b16 v[172:173], v185 offset:0
    v_mfma_f32_32x32x16_bf16 v[64:79], v[176:179], v[164:167], v[64:79]
    ds_read_b64_tr_b16 v[174:175], v185 offset:512
    v_mfma_f32_32x32x16_bf16 v[16:31], v[180:183], v[156:159], v[16:31]
    s_waitcnt vmcnt(12)
    ds_write_b128 v193, v[226:229] offset:2048
    ds_write_b128 v193, v[230:233] offset:3072
    v_mfma_f32_32x32x16_bf16 v[48:63], v[180:183], v[160:163], v[48:63]
    s_add_u32 s72, s74, 204800
    buffer_load_dwordx4 v[226:229], v189, s[20:23], s72 offen
    s_add_u32 s72, s74, 215040
    buffer_load_dwordx4 v[230:233], v189, s[20:23], s72 offen
    v_mfma_f32_32x32x16_bf16 v[80:95], v[180:183], v[164:167], v[80:95]
    s_waitcnt lgkmcnt(2)
    v_mfma_f32_32x32x16_bf16 v[0:15], v[168:171], v[144:147], v[0:15]
    ds_read_b64_tr_b16 v[176:177], v184 offset:2048
    ds_read_b64_tr_b16 v[178:179], v184 offset:2560
    ds_read_b128 v[156:159], v187 offset:9216
    v_mfma_f32_32x32x16_bf16 v[32:47], v[168:171], v[148:151], v[32:47]
    ds_read_b128 v[160:163], v187 offset:10240
    ds_read_b128 v[164:167], v187 offset:11264
    ds_read_b64_tr_b16 v[180:181], v185 offset:2048
    v_mfma_f32_32x32x16_bf16 v[64:79], v[168:171], v[152:155], v[64:79]
    ds_read_b64_tr_b16 v[182:183], v185 offset:2560
    v_mfma_f32_32x32x16_bf16 v[16:31], v[172:175], v[144:147], v[16:31]
    s_waitcnt vmcnt(12)
    ds_write_b128 v193, v[234:237] offset:0
    ds_write_b128 v193, v[238:241] offset:1024
    v_mfma_f32_32x32x16_bf16 v[48:63], v[172:175], v[148:151], v[48:63]
    s_add_u32 s72, s74, 225280
    buffer_load_dwordx4 v[234:237], v189, s[20:23], s72 offen
    s_add_u32 s72, s74, 235520
    buffer_load_dwordx4 v[238:241], v189, s[20:23], s72 offen
    v_mfma_f32_32x32x16_bf16 v[80:95], v[172:175], v[152:155], v[80:95]
    s_waitcnt lgkmcnt(2)
    v_mfma_f32_32x32x16_bf16 v[0:15], v[176:179], v[156:159], v[0:15]
    ds_read_b64_tr_b16 v[168:169], v184 offset:0
    ds_read_b64_tr_b16 v[170:171], v184 offset:512
    ds_read_b128 v[144:147], v187 offset:12288
    v_mfma_f32_32x32x16_bf16 v[32:47], v[176:179], v[160:163], v[32:47]
    ds_read_b128 v[148:151], v187 offset:13312
    ds_read_b128 v[152:155], v187 offset:14336
    ds_read_b64_tr_b16 v[172:173], v185 offset:0
    v_mfma_f32_32x32x16_bf16 v[64:79], v[176:179], v[164:167], v[64:79]
    ds_read_b64_tr_b16 v[174:175], v185 offset:512
    v_mfma_f32_32x32x16_bf16 v[16:31], v[180:183], v[156:159], v[16:31]
    s_waitcnt vmcnt(12)
    ds_write_b128 v193, v[242:245] offset:2048
    ds_write_b128 v193, v[246:249] offset:3072
    v_mfma_f32_32x32x16_bf16 v[48:63], v[180:183], v[160:163], v[48:63]
    s_add_u32 s72, s74, 245760
    buffer_load_dwordx4 v[242:245], v189, s[20:23], s72 offen
    s_add_u32 s72, s74, 256000
    buffer_load_dwordx4 v[246:249], v189, s[20:23], s72 offen
    v_mfma_f32_32x32x16_bf16 v[80:95], v[180:183], v[164:167], v[80:95]
    s_waitcnt lgkmcnt(2)
    s_barrier
    v_mfma_f32_32x32x16_bf16 v[0:15], v[168:171], v[144:147], v[0:15]
    ds_read_b64_tr_b16 v[176:177], v184 offset:2048
    ds_read_b64_tr_b16 v[178:179], v184 offset:2560
    ds_read_b128 v[156:159], v187 offset:15360
    v_mfma_f32_32x32x16_bf16 v[32:47], v[168:171], v[148:151], v[32:47]
    ds_read_b128 v[160:163], v187 offset:16384
    ds_read_b128 v[164:167], v187 offset:17408
    ds_read_b64_tr_b16 v[180:181], v185 offset:2048
    v_mfma_f32_32x32x16_bf16 v[64:79], v[168:171], v[152:155], v[64:79]
    ds_read_b64_tr_b16 v[182:183], v185 offset:2560
    v_mfma_f32_32x32x16_bf16 v[16:31], v[172:175], v[144:147], v[16:31]
    s_waitcnt vmcnt(12)
    ds_write_b128 v193, v[194:197] offset:0
    ds_write_b128 v193, v[198:201] offset:1024
    v_mfma_f32_32x32x16_bf16 v[48:63], v[172:175], v[148:151], v[48:63]
    s_add_u32 s72, s74, 266240
    buffer_load_dwordx4 v[194:197], v189, s[20:23], s72 offen
    s_add_u32 s72, s74, 276480
    buffer_load_dwordx4 v[198:201], v189, s[20:23], s72 offen
    v_mfma_f32_32x32x16_bf16 v[80:95], v[172:175], v[152:155], v[80:95]
    s_waitcnt lgkmcnt(2)
    v_mfma_f32_32x32x16_bf16 v[0:15], v[176:179], v[156:159], v[0:15]
    ds_read_b64_tr_b16 v[168:169], v184 offset:0
    ds_read_b64_tr_b16 v[170:171], v184 offset:512
    ds_read_b128 v[144:147], v187 offset:18432
    v_mfma_f32_32x32x16_bf16 v[32:47], v[176:179], v[160:163], v[32:47]
    ds_read_b128 v[148:151], v187 offset:19456
    ds_read_b128 v[152:155], v187 offset:20480
    ds_read_b64_tr_b16 v[172:173], v185 offset:0
    v_mfma_f32_32x32x16_bf16 v[64:79], v[176:179], v[164:167], v[64:79]
    ds_read_b64_tr_b16 v[174:175], v185 offset:512
    v_mfma_f32_32x32x16_bf16 v[16:31], v[180:183], v[156:159], v[16:31]
    s_waitcnt vmcnt(12)
    ds_write_b128 v193, v[202:205] offset:2048
    ds_write_b128 v193, v[206:209] offset:3072
    v_mfma_f32_32x32x16_bf16 v[48:63], v[180:183], v[160:163], v[48:63]
    s_add_u32 s72, s74, 286720
    buffer_load_dwordx4 v[202:205], v189, s[20:23], s72 offen
    s_add_u32 s72, s74, 296960
    buffer_load_dwordx4 v[206:209], v189, s[20:23], s72 offen
    v_mfma_f32_32x32x16_bf16 v[80:95], v[180:183], v[164:167], v[80:95]
    s_waitcnt lgkmcnt(2)
    v_mfma_f32_32x32x16_bf16 v[0:15], v[168:171], v[144:147], v[0:15]
    ds_read_b64_tr_b16 v[176:177], v184 offset:2048
    ds_read_b64_tr_b16 v[178:179], v184 offset:2560
    ds_read_b128 v[156:159], v187 offset:21504
    v_mfma_f32_32x32x16_bf16 v[32:47], v[168:171], v[148:151], v[32:47]
    ds_read_b128 v[160:163], v187 offset:22528
    ds_read_b128 v[164:167], v187 offset:23552
    ds_read_b64_tr_b16 v[180:181], v185 offset:2048
    v_mfma_f32_32x32x16_bf16 v[64:79], v[168:171], v[152:155], v[64:79]
    ds_read_b64_tr_b16 v[182:183], v185 offset:2560
    v_mfma_f32_32x32x16_bf16 v[16:31], v[172:175], v[144:147], v[16:31]
    s_waitcnt vmcnt(12)
    ds_write_b128 v193, v[210:213] offset:0
    ds_write_b128 v193, v[214:217] offset:1024
    v_mfma_f32_32x32x16_bf16 v[48:63], v[172:175], v[148:151], v[48:63]
    s_add_u32 s72, s74, 307200
    buffer_load_dwordx4 v[210:213], v189, s[20:23], s72 offen
    s_add_u32 s72, s74, 317440
    buffer_load_dwordx4 v[214:217], v189, s[20:23], s72 offen
    v_mfma_f32_32x32x16_bf16 v[80:95], v[172:175], v[152:155], v[80:95]
    s_waitcnt lgkmcnt(2)
    v_mfma_f32_32x32x16_bf16 v[0:15], v[176:179], v[156:159], v[0:15]
    v_add_u32 v187, 98304, v188
    ds_read_b64_tr_b16 v[168:169], v184 offset:0
    ds_read_b64_tr_b16 v[170:171], v184 offset:512
    v_mfma_f32_32x32x16_bf16 v[32:47], v[176:179], v[160:163], v[32:47]
    ds_read_b128 v[144:147], v187 offset:0
    ds_read_b128 v[148:151], v187 offset:1024
    ds_read_b128 v[152:155], v187 offset:2048
    v_mfma_f32_32x32x16_bf16 v[64:79], v[176:179], v[164:167], v[64:79]
    ds_read_b64_tr_b16 v[172:173], v185 offset:0
    ds_read_b64_tr_b16 v[174:175], v185 offset:512
    v_mfma_f32_32x32x16_bf16 v[16:31], v[180:183], v[156:159], v[16:31]
    s_waitcnt vmcnt(12)
    ds_write_b128 v193, v[218:221] offset:2048
    ds_write_b128 v193, v[222:225] offset:3072
    v_mfma_f32_32x32x16_bf16 v[48:63], v[180:183], v[160:163], v[48:63]
    s_add_u32 s72, s76, 327680
    buffer_load_dwordx4 v[218:221], v190, s[20:23], s72 offen
    s_add_u32 s72, s76, 348160
    buffer_load_dwordx4 v[222:225], v190, s[20:23], s72 offen
    v_mfma_f32_32x32x16_bf16 v[80:95], v[180:183], v[164:167], v[80:95]
    s_waitcnt lgkmcnt(2)
    s_barrier
    v_mfma_f32_32x32x16_bf16 v[0:15], v[168:171], v[144:147], v[0:15]
    ds_read_b64_tr_b16 v[176:177], v184 offset:2048
    ds_read_b64_tr_b16 v[178:179], v184 offset:2560
    ds_read_b128 v[156:159], v187 offset:3072
    v_mfma_f32_32x32x16_bf16 v[32:47], v[168:171], v[148:151], v[32:47]
    ds_read_b128 v[160:163], v187 offset:4096
    ds_read_b128 v[164:167], v187 offset:5120
    ds_read_b64_tr_b16 v[180:181], v185 offset:2048
    v_mfma_f32_32x32x16_bf16 v[64:79], v[168:171], v[152:155], v[64:79]
    ds_read_b64_tr_b16 v[182:183], v185 offset:2560
    v_mfma_f32_32x32x16_bf16 v[16:31], v[172:175], v[144:147], v[16:31]
    s_waitcnt vmcnt(12)
    ds_write_b128 v193, v[226:229] offset:0
    ds_write_b128 v193, v[230:233] offset:1024
    v_mfma_f32_32x32x16_bf16 v[48:63], v[172:175], v[148:151], v[48:63]
    s_add_u32 s72, s76, 368640
    buffer_load_dwordx4 v[226:229], v190, s[20:23], s72 offen
    s_add_u32 s72, s76, 389120
    buffer_load_dwordx4 v[230:233], v190, s[20:23], s72 offen
    v_mfma_f32_32x32x16_bf16 v[80:95], v[172:175], v[152:155], v[80:95]
    s_waitcnt lgkmcnt(2)
    v_mfma_f32_32x32x16_bf16 v[0:15], v[176:179], v[156:159], v[0:15]
    ds_read_b64_tr_b16 v[168:169], v184 offset:0
    ds_read_b64_tr_b16 v[170:171], v184 offset:512
    ds_read_b128 v[144:147], v187 offset:6144
    v_mfma_f32_32x32x16_bf16 v[32:47], v[176:179], v[160:163], v[32:47]
    ds_read_b128 v[148:151], v187 offset:7168
    ds_read_b128 v[152:155], v187 offset:8192
    ds_read_b64_tr_b16 v[172:173], v185 offset:0
    v_mfma_f32_32x32x16_bf16 v[64:79], v[176:179], v[164:167], v[64:79]
    ds_read_b64_tr_b16 v[174:175], v185 offset:512
    v_mfma_f32_32x32x16_bf16 v[16:31], v[180:183], v[156:159], v[16:31]
    s_waitcnt vmcnt(12)
    ds_write_b128 v193, v[234:237] offset:2048
    ds_write_b128 v193, v[238:241] offset:3072
    v_mfma_f32_32x32x16_bf16 v[48:63], v[180:183], v[160:163], v[48:63]
    s_add_u32 s72, s76, 409600
    buffer_load_dwordx4 v[234:237], v190, s[20:23], s72 offen
    s_add_u32 s72, s76, 430080
    buffer_load_dwordx4 v[238:241], v190, s[20:23], s72 offen
    v_mfma_f32_32x32x16_bf16 v[80:95], v[180:183], v[164:167], v[80:95]
    s_waitcnt lgkmcnt(2)
    v_mfma_f32_32x32x16_bf16 v[0:15], v[168:171], v[144:147], v[0:15]
    ds_read_b64_tr_b16 v[176:177], v184 offset:2048
    ds_read_b64_tr_b16 v[178:179], v184 offset:2560
    ds_read_b128 v[156:159], v187 offset:9216
    v_mfma_f32_32x32x16_bf16 v[32:47], v[168:171], v[148:151], v[32:47]
    ds_read_b128 v[160:163], v187 offset:10240
    ds_read_b128 v[164:167], v187 offset:11264
    ds_read_b64_tr_b16 v[180:181], v185 offset:2048
    v_mfma_f32_32x32x16_bf16 v[64:79], v[168:171], v[152:155], v[64:79]
    ds_read_b64_tr_b16 v[182:183], v185 offset:2560
    v_mfma_f32_32x32x16_bf16 v[16:31], v[172:175], v[144:147], v[16:31]
    s_waitcnt vmcnt(12)
    ds_write_b128 v193, v[242:245] offset:0
    ds_write_b128 v193, v[246:249] offset:1024
    v_mfma_f32_32x32x16_bf16 v[48:63], v[172:175], v[148:151], v[48:63]
    s_add_u32 s72, s76, 450560
    buffer_load_dwordx4 v[242:245], v190, s[20:23], s72 offen
    s_add_u32 s72, s76, 471040
    buffer_load_dwordx4 v[246:249], v190, s[20:23], s72 offen
    v_mfma_f32_32x32x16_bf16 v[80:95], v[172:175], v[152:155], v[80:95]
    s_waitcnt lgkmcnt(2)
    v_mfma_f32_32x32x16_bf16 v[0:15], v[176:179], v[156:159], v[0:15]
    ds_read_b64_tr_b16 v[168:169], v184 offset:0
    ds_read_b64_tr_b16 v[170:171], v184 offset:512
    ds_read_b128 v[144:147], v187 offset:12288
    v_mfma_f32_32x32x16_bf16 v[32:47], v[176:179], v[160:163], v[32:47]
    ds_read_b128 v[148:151], v187 offset:13312
    ds_read_b128 v[152:155], v187 offset:14336
    ds_read_b64_tr_b16 v[172:173], v185 offset:0
    v_mfma_f32_32x32x16_bf16 v[64:79], v[176:179], v[164:167], v[64:79]
    ds_read_b64_tr_b16 v[174:175], v185 offset:512
    v_mfma_f32_32x32x16_bf16 v[16:31], v[180:183], v[156:159], v[16:31]
    s_waitcnt vmcnt(12)
    ds_write_b128 v193, v[194:197] offset:2048
    ds_write_b128 v193, v[198:201] offset:3072
    v_mfma_f32_32x32x16_bf16 v[48:63], v[180:183], v[160:163], v[48:63]
    s_add_u32 s72, s76, 163840
    buffer_load_dwordx4 v[194:197], v190, s[20:23], s72 offen
    s_add_u32 s72, s76, 184320
    buffer_load_dwordx4 v[198:201], v190, s[20:23], s72 offen
    v_mfma_f32_32x32x16_bf16 v[80:95], v[180:183], v[164:167], v[80:95]
    s_waitcnt lgkmcnt(2)
    s_barrier
    v_mfma_f32_32x32x16_bf16 v[0:15], v[168:171], v[144:147], v[0:15]
    ds_read_b64_tr_b16 v[176:177], v184 offset:2048
    ds_read_b64_tr_b16 v[178:179], v184 offset:2560
    ds_read_b128 v[156:159], v187 offset:15360
    v_mfma_f32_32x32x16_bf16 v[32:47], v[168:171], v[148:151], v[32:47]
    ds_read_b128 v[160:163], v187 offset:16384
    ds_read_b128 v[164:167], v187 offset:17408
    ds_read_b64_tr_b16 v[180:181], v185 offset:2048
    v_mfma_f32_32x32x16_bf16 v[64:79], v[168:171], v[152:155], v[64:79]
    ds_read_b64_tr_b16 v[182:183], v185 offset:2560
    v_mfma_f32_32x32x16_bf16 v[16:31], v[172:175], v[144:147], v[16:31]
    s_waitcnt vmcnt(12)
    ds_write_b128 v193, v[202:205] offset:0
    ds_write_b128 v193, v[206:209] offset:1024
    v_mfma_f32_32x32x16_bf16 v[48:63], v[172:175], v[148:151], v[48:63]
    s_add_u32 s72, s76, 204800
    buffer_load_dwordx4 v[202:205], v190, s[20:23], s72 offen
    s_add_u32 s72, s74, 491520
    buffer_load_dwordx4 v[206:209], v189, s[20:23], s72 offen
    v_mfma_f32_32x32x16_bf16 v[80:95], v[172:175], v[152:155], v[80:95]
    s_waitcnt lgkmcnt(2)
    v_mfma_f32_32x32x16_bf16 v[0:15], v[176:179], v[156:159], v[0:15]
    ds_read_b64_tr_b16 v[168:169], v184 offset:0
    ds_read_b64_tr_b16 v[170:171], v184 offset:512
    ds_read_b128 v[144:147], v187 offset:18432
    v_mfma_f32_32x32x16_bf16 v[32:47], v[176:179], v[160:163], v[32:47]
    ds_read_b128 v[148:151], v187 offset:19456
    ds_read_b128 v[152:155], v187 offset:20480
    ds_read_b64_tr_b16 v[172:173], v185 offset:0
    v_mfma_f32_32x32x16_bf16 v[64:79], v[176:179], v[164:167], v[64:79]
    ds_read_b64_tr_b16 v[174:175], v185 offset:512
    v_mfma_f32_32x32x16_bf16 v[16:31], v[180:183], v[156:159], v[16:31]
    s_waitcnt vmcnt(12)
    ds_write_b128 v193, v[210:213] offset:2048
    ds_write_b128 v193, v[214:217] offset:3072
    v_mfma_f32_32x32x16_bf16 v[48:63], v[180:183], v[160:163], v[48:63]
    s_add_u32 s72, s74, 501760
    buffer_load_dwordx4 v[210:213], v189, s[20:23], s72 offen
    s_add_u32 s72, s74, 512000
    buffer_load_dwordx4 v[214:217], v189, s[20:23], s72 offen
    v_mfma_f32_32x32x16_bf16 v[80:95], v[180:183], v[164:167], v[80:95]
    s_waitcnt lgkmcnt(2)
    v_mfma_f32_32x32x16_bf16 v[0:15], v[168:171], v[144:147], v[0:15]
    ds_read_b64_tr_b16 v[176:177], v184 offset:2048
    ds_read_b64_tr_b16 v[178:179], v184 offset:2560
    ds_read_b128 v[156:159], v187 offset:21504
    v_mfma_f32_32x32x16_bf16 v[32:47], v[168:171], v[148:151], v[32:47]
    ds_read_b128 v[160:163], v187 offset:22528
    ds_read_b128 v[164:167], v187 offset:23552
    ds_read_b64_tr_b16 v[180:181], v185 offset:2048
    v_mfma_f32_32x32x16_bf16 v[64:79], v[168:171], v[152:155], v[64:79]
    ds_read_b64_tr_b16 v[182:183], v185 offset:2560
    v_mfma_f32_32x32x16_bf16 v[16:31], v[172:175], v[144:147], v[16:31]
    s_waitcnt vmcnt(13)
    ds_write_b128 v193, v[218:221] offset:0
    v_mfma_f32_32x32x16_bf16 v[48:63], v[172:175], v[148:151], v[48:63]
    s_add_u32 s72, s74, 522240
    buffer_load_dwordx4 v[218:221], v189, s[20:23], s72 offen
    v_mfma_f32_32x32x16_bf16 v[80:95], v[172:175], v[152:155], v[80:95]
    s_waitcnt lgkmcnt(1)
    v_mfma_f32_32x32x16_bf16 v[0:15], v[176:179], v[156:159], v[0:15]
    v_add_u32 v187, 139264, v188
    ds_read_b64_tr_b16 v[168:169], v186 offset:0
    ds_read_b64_tr_b16 v[170:171], v186 offset:256
    v_mfma_f32_32x32x16_bf16 v[32:47], v[176:179], v[160:163], v[32:47]
    ds_read_b128 v[144:147], v187 offset:0
    ds_read_b128 v[148:151], v187 offset:1024
    ds_read_b128 v[152:155], v187 offset:2048
    v_mfma_f32_32x32x16_bf16 v[64:79], v[176:179], v[164:167], v[64:79]
    v_mfma_f32_32x32x16_bf16 v[16:31], v[180:183], v[156:159], v[16:31]
    s_waitcnt vmcnt(13)
    ds_write_b128 v193, v[222:225] offset:2048
    v_mfma_f32_32x32x16_bf16 v[48:63], v[180:183], v[160:163], v[48:63]
    s_add_u32 s72, s74, 532480
    buffer_load_dwordx4 v[222:225], v189, s[20:23], s72 offen
    v_mfma_f32_32x32x16_bf16 v[80:95], v[180:183], v[164:167], v[80:95]
    s_waitcnt lgkmcnt(1)
    s_barrier
    s_setprio 0
    v_mfma_f32_32x32x16_bf16 v[96:111], v[168:171], v[144:147], 0
    ds_read_b64_tr_b16 v[176:177], v186 offset:2048
    ds_read_b64_tr_b16 v[178:179], v186 offset:2304
    ds_read_b128 v[156:159], v187 offset:3072
    ds_read_b128 v[160:163], v187 offset:4096
    ds_read_b128 v[164:167], v187 offset:5120
    v_mfma_f32_32x32x16_bf16 v[112:127], v[168:171], v[148:151], 0
    s_waitcnt vmcnt(13)
    ds_write_b128 v193, v[226:229] offset:0
    v_mfma_f32_32x32x16_bf16 v[128:143], v[168:171], v[152:155], 0
    s_add_u32 s72, s74, 542720
    buffer_load_dwordx4 v[226:229], v189, s[20:23], s72 offen
    s_lshl_b32 s78, s79, 13
    s_add_u32 m0, s78, 0
    s_add_u32 s72, s76, 491520
    buffer_load_dwordx4 v190, s[20:23], s72 offen lds
    s_waitcnt lgkmcnt(1)
    v_mfma_f32_32x32x16_bf16 v[96:111], v[176:179], v[156:159], v[96:111]
    ds_read_b64_tr_b16 v[168:169], v186 offset:0
    ds_read_b64_tr_b16 v[170:171], v186 offset:256
    ds_read_b128 v[144:147], v187 offset:6144
    ds_read_b128 v[148:151], v187 offset:7168
    ds_read_b128 v[152:155], v187 offset:8192
    v_mfma_f32_32x32x16_bf16 v[112:127], v[176:179], v[160:163], v[112:127]
    s_waitcnt vmcnt(14)
    ds_write_b128 v193, v[230:233] offset:2048
    v_mfma_f32_32x32x16_bf16 v[128:143], v[176:179], v[164:167], v[128:143]
    s_add_u32 s72, s74, 552960
    buffer_load_dwordx4 v[230:233], v189, s[20:23], s72 offen
    s_lshl_b32 s78, s79, 13
    s_add_u32 m0, s78, 1024
    s_add_u32 s72, s76, 512000
    buffer_load_dwordx4 v190, s[20:23], s72 offen lds
    s_waitcnt lgkmcnt(1)
    v_mfma_f32_32x32x16_bf16 v[96:111], v[168:171], v[144:147], v[96:111]
    ds_read_b64_tr_b16 v[176:177], v186 offset:2048
    ds_read_b64_tr_b16 v[178:179], v186 offset:2304
    ds_read_b128 v[156:159], v187 offset:9216
    ds_read_b128 v[160:163], v187 offset:10240
    ds_read_b128 v[164:167], v187 offset:11264
    v_mfma_f32_32x32x16_bf16 v[112:127], v[168:171], v[148:151], v[112:127]
    s_waitcnt vmcnt(15)
    ds_write_b128 v193, v[234:237] offset:0
    v_mfma_f32_32x32x16_bf16 v[128:143], v[168:171], v[152:155], v[128:143]
    s_add_u32 s72, s74, 563200
    buffer_load_dwordx4 v[234:237], v189, s[20:23], s72 offen
    s_lshl_b32 s78, s79, 13
    s_add_u32 m0, s78, 2048
    s_add_u32 s72, s76, 532480
    buffer_load_dwordx4 v190, s[20:23], s72 offen lds
    s_waitcnt lgkmcnt(1)
    s_barrier
    v_mfma_f32_32x32x16_bf16 v[96:111], v[176:179], v[156:159], v[96:111]
    ds_read_b64_tr_b16 v[168:169], v186 offset:0
    ds_read_b64_tr_b16 v[170:171], v186 offset:256
    ds_read_b128 v[144:147], v187 offset:12288
    ds_read_b128 v[148:151], v187 offset:13312
    ds_read_b128 v[152:155], v187 offset:14336
    v_mfma_f32_32x32x16_bf16 v[112:127], v[176:179], v[160:163], v[112:127]
    s_waitcnt vmcnt(16)
    ds_write_b128 v193, v[238:241] offset:2048
    v_mfma_f32_32x32x16_bf16 v[128:143], v[176:179], v[164:167], v[128:143]
    s_add_u32 s72, s74, 573440
    buffer_load_dwordx4 v[238:241], v189, s[20:23], s72 offen
    s_lshl_b32 s78, s79, 13
    s_add_u32 m0, s78, 3072
    s_add_u32 s72, s76, 552960
    buffer_load_dwordx4 v190, s[20:23], s72 offen lds
    s_waitcnt lgkmcnt(1)
    v_mfma_f32_32x32x16_bf16 v[96:111], v[168:171], v[144:147], v[96:111]
    ds_read_b64_tr_b16 v[176:177], v186 offset:2048
    ds_read_b64_tr_b16 v[178:179], v186 offset:2304
    ds_read_b128 v[156:159], v187 offset:15360
    ds_read_b128 v[160:163], v187 offset:16384
    ds_read_b128 v[164:167], v187 offset:17408
    v_mfma_f32_32x32x16_bf16 v[112:127], v[168:171], v[148:151], v[112:127]
    s_waitcnt vmcnt(17)
    ds_write_b128 v193, v[242:245] offset:0
    v_mfma_f32_32x32x16_bf16 v[128:143], v[168:171], v[152:155], v[128:143]
    s_add_u32 s72, s74, 583680
    buffer_load_dwordx4 v[242:245], v189, s[20:23], s72 offen
    s_lshl_b32 s78, s79, 13
    s_add_u32 m0, s78, 4096
    s_add_u32 s72, s76, 573440
    buffer_load_dwordx4 v190, s[20:23], s72 offen lds
    s_waitcnt lgkmcnt(1)
    v_mfma_f32_32x32x16_bf16 v[96:111], v[176:179], v[156:159], v[96:111]
    ds_read_b64_tr_b16 v[168:169], v186 offset:0
    ds_read_b64_tr_b16 v[170:171], v186 offset:256
    ds_read_b128 v[144:147], v187 offset:18432
    ds_read_b128 v[148:151], v187 offset:19456
    ds_read_b128 v[152:155], v187 offset:20480
    v_mfma_f32_32x32x16_bf16 v[112:127], v[176:179], v[160:163], v[112:127]
    s_waitcnt vmcnt(18)
    ds_write_b128 v193, v[246:249] offset:2048
    v_mfma_f32_32x32x16_bf16 v[128:143], v[176:179], v[164:167], v[128:143]
    s_add_u32 s72, s74, 593920
    buffer_load_dwordx4 v[246:249], v189, s[20:23], s72 offen
    s_lshl_b32 s78, s79, 13
    s_add_u32 m0, s78, 5120
    s_add_u32 s72, s76, 593920
    buffer_load_dwordx4 v190, s[20:23], s72 offen lds
    s_waitcnt lgkmcnt(1)
    v_mfma_f32_32x32x16_bf16 v[96:111], v[168:171], v[144:147], v[96:111]
    ds_read_b64_tr_b16 v[176:177], v186 offset:2048
    ds_read_b64_tr_b16 v[178:179], v186 offset:2304
    ds_read_b128 v[156:159], v187 offset:21504
    ds_read_b128 v[160:163], v187 offset:22528
    ds_read_b128 v[164:167], v187 offset:23552
    v_mfma_f32_32x32x16_bf16 v[112:127], v[168:171], v[148:151], v[112:127]
    s_waitcnt vmcnt(19)
    ds_write_b128 v193, v[194:197] offset:0
    v_mfma_f32_32x32x16_bf16 v[128:143], v[168:171], v[152:155], v[128:143]
    s_add_u32 s72, s74, 604160
    buffer_load_dwordx4 v[194:197], v189, s[20:23], s72 offen
    s_lshl_b32 s78, s79, 13
    s_add_u32 m0, s78, 6144
    s_add_u32 s72, s76, 614400
    buffer_load_dwordx4 v190, s[20:23], s72 offen lds
    s_waitcnt lgkmcnt(1)
    v_mfma_f32_32x32x16_bf16 v[96:111], v[176:179], v[156:159], v[96:111]
    v_add_u32 v187, 98304, v188
    ds_read_b64_tr_b16 v[168:169], v186 offset:0
    ds_read_b64_tr_b16 v[170:171], v186 offset:256
    ds_read_b128 v[144:147], v187 offset:0
    ds_read_b128 v[148:151], v187 offset:1024
    v_mfma_f32_32x32x16_bf16 v[112:127], v[176:179], v[160:163], v[112:127]
    ds_read_b128 v[152:155], v187 offset:2048
    s_waitcnt vmcnt(20)
    ds_write_b128 v193, v[198:201] offset:2048
    v_mfma_f32_32x32x16_bf16 v[128:143], v[176:179], v[164:167], v[128:143]
    s_add_u32 s72, s74, 614400
    buffer_load_dwordx4 v[198:201], v189, s[20:23], s72 offen
    s_lshl_b32 s78, s79, 13
    s_add_u32 m0, s78, 7168
    s_add_u32 s72, s76, 634880
    buffer_load_dwordx4 v190, s[20:23], s72 offen lds
    s_waitcnt lgkmcnt(1)
    v_mfma_f32_32x32x16_bf16 v[96:111], v[168:171], v[144:147], v[96:111]
    ds_read_b64_tr_b16 v[176:177], v186 offset:2048
    ds_read_b64_tr_b16 v[178:179], v186 offset:2304
    ds_read_b128 v[156:159], v187 offset:3072
    ds_read_b128 v[160:163], v187 offset:4096
    ds_read_b128 v[164:167], v187 offset:5120
    v_mfma_f32_32x32x16_bf16 v[112:127], v[168:171], v[148:151], v[112:127]
    s_waitcnt vmcnt(21)
    ds_write_b128 v193, v[202:205] offset:0
    v_mfma_f32_32x32x16_bf16 v[128:143], v[168:171], v[152:155], v[128:143]
    s_add_u32 s72, s74, 624640
    buffer_load_dwordx4 v[202:205], v189, s[20:23], s72 offen
    s_waitcnt lgkmcnt(1)
    v_mfma_f32_32x32x16_bf16 v[96:111], v[176:179], v[156:159], v[96:111]
    ds_read_b64_tr_b16 v[168:169], v186 offset:0
    ds_read_b64_tr_b16 v[170:171], v186 offset:256
    ds_read_b128 v[144:147], v187 offset:6144
    ds_read_b128 v[148:151], v187 offset:7168
    ds_read_b128 v[152:155], v187 offset:8192
    v_mfma_f32_32x32x16_bf16 v[112:127], v[176:179], v[160:163], v[112:127]
    s_waitcnt vmcnt(20)
    ds_write_b128 v193, v[206:209] offset:2048
    ds_write_b128 v193, v[210:213] offset:3072
    v_mfma_f32_32x32x16_bf16 v[128:143], v[176:179], v[164:167], v[128:143]
    s_add_u32 s72, s74, 634880
    buffer_load_dwordx4 v[206:209], v189, s[20:23], s72 offen
    s_add_u32 s72, s74, 645120
    buffer_load_dwordx4 v[210:213], v189, s[20:23], s72 offen
    s_waitcnt lgkmcnt(2)
    s_barrier
    v_mfma_f32_32x32x16_bf16 v[96:111], v[168:171], v[144:147], v[96:111]
    v_add_u32 v187, 32768, v188
    ds_read_b64_tr_b16 v[176:177], v184 offset:2048
    ds_read_b64_tr_b16 v[178:179], v184 offset:2560
    ds_read_b128 v[156:159], v187 offset:0
    ds_read_b128 v[160:163], v187 offset:1024
    v_mfma_f32_32x32x16_bf16 v[112:127], v[168:171], v[148:151], v[112:127]
    ds_read_b128 v[164:167], v187 offset:2048
    ds_read_b64_tr_b16 v[180:181], v185 offset:2048
    ds_read_b64_tr_b16 v[182:183], v185 offset:2560
    s_waitcnt vmcnt(20)
    ds_write_b128 v193, v[214:217] offset:0
    ds_write_b128 v193, v[218:221] offset:1024
    v_mfma_f32_32x32x16_bf16 v[128:143], v[168:171], v[152:155], v[128:143]
    s_add_u32 s72, s76, 225280
    buffer_load_dwordx4 v[214:217], v190, s[20:23], s72 offen
    s_add_u32 s72, s76, 245760
    buffer_load_dwordx4 v[218:221], v190, s[20:23], s72 offen
    s_waitcnt lgkmcnt(2)
    s_setprio 2
    v_mfma_f32_32x32x16_bf16 v[0:15], v[176:179], v[156:159], v[0:15]
    ds_read_b64_tr_b16 v[168:169], v184 offset:0
    ds_read_b64_tr_b16 v[170:171], v184 offset:512
    ds_read_b128 v[144:147], v187 offset:3072
    v_mfma_f32_32x32x16_bf16 v[32:47], v[176:179], v[160:163], v[32:47]
    ds_read_b128 v[148:151], v187 offset:4096
    ds_read_b128 v[152:155], v187 offset:5120
    ds_read_b64_tr_b16 v[172:173], v185 offset:0
    v_mfma_f32_32x32x16_bf16 v[64:79], v[176:179], v[164:167], v[64:79]
    ds_read_b64_tr_b16 v[174:175], v185 offset:512
    v_mfma_f32_32x32x16_bf16 v[16:31], v[180:183], v[156:159], v[16:31]
    s_waitcnt vmcnt(20)
    ds_write_b128 v193, v[222:225] offset:2048
    ds_write_b128 v193, v[226:229] offset:3072
    v_mfma_f32_32x32x16_bf16 v[48:63], v[180:183], v[160:163], v[48:63]
    s_add_u32 s72, s76, 266240
    buffer_load_dwordx4 v[222:225], v190, s[20:23], s72 offen
    s_add_u32 s72, s76, 286720
    buffer_load_dwordx4 v[226:229], v190, s[20:23], s72 offen
    v_mfma_f32_32x32x16_bf16 v[80:95], v[180:183], v[164:167], v[80:95]
    s_waitcnt lgkmcnt(2)
    v_mfma_f32_32x32x16_bf16 v[0:15], v[168:171], v[144:147], v[0:15]
    ds_read_b64_tr_b16 v[176:177], v184 offset:2048
    ds_read_b64_tr_b16 v[178:179], v184 offset:2560
    ds_read_b128 v[156:159], v187 offset:6144
    v_mfma_f32_32x32x16_bf16 v[32:47], v[168:171], v[148:151], v[32:47]
    ds_read_b128 v[160:163], v187 offset:7168
    ds_read_b128 v[164:167], v187 offset:8192
    ds_read_b64_tr_b16 v[180:181], v185 offset:2048
    v_mfma_f32_32x32x16_bf16 v[64:79], v[168:171], v[152:155], v[64:79]
    ds_read_b64_tr_b16 v[182:183], v185 offset:2560
    v_mfma_f32_32x32x16_bf16 v[16:31], v[172:175], v[144:147], v[16:31]
    s_waitcnt vmcnt(18)
    ds_write_b128 v193, v[230:233] offset:0
    ds_write_b128 v193, v[234:237] offset:1024
    v_mfma_f32_32x32x16_bf16 v[48:63], v[172:175], v[148:151], v[48:63]
    s_add_u32 s72, s76, 307200
    buffer_load_dwordx4 v[230:233], v190, s[20:23], s72 offen
    s_add_u32 s72, s76, 0
    buffer_load_dwordx4 v[234:237], v190, s[20:23], s72 offen
    v_mfma_f32_32x32x16_bf16 v[80:95], v[172:175], v[152:155], v[80:95]
    s_waitcnt lgkmcnt(2)
    v_mfma_f32_32x32x16_bf16 v[0:15], v[176:179], v[156:159], v[0:15]
    ds_read_b64_tr_b16 v[168:169], v184 offset:0
    ds_read_b64_tr_b16 v[170:171], v184 offset:512
    ds_read_b128 v[144:147], v187 offset:9216
    v_mfma_f32_32x32x16_bf16 v[32:47], v[176:179], v[160:163], v[32:47]
    ds_read_b128 v[148:151], v187 offset:10240
    ds_read_b128 v[152:155], v187 offset:11264
    ds_read_b64_tr_b16 v[172:173], v185 offset:0
    v_mfma_f32_32x32x16_bf16 v[64:79], v[176:179], v[164:167], v[64:79]
    ds_read_b64_tr_b16 v[174:175], v185 offset:512
    v_mfma_f32_32x32x16_bf16 v[16:31], v[180:183], v[156:159], v[16:31]
    s_waitcnt vmcnt(16)
    ds_write_b128 v193, v[238:241] offset:2048
    ds_write_b128 v193, v[242:245] offset:3072
    v_mfma_f32_32x32x16_bf16 v[48:63], v[180:183], v[160:163], v[48:63]
    s_add_u32 s72, s76, 20480
    buffer_load_dwordx4 v[238:241], v190, s[20:23], s72 offen
    s_add_u32 s72, s76, 40960
    buffer_load_dwordx4 v[242:245], v190, s[20:23], s72 offen
    v_mfma_f32_32x32x16_bf16 v[80:95], v[180:183], v[164:167], v[80:95]
    s_waitcnt lgkmcnt(2)
    v_mfma_f32_32x32x16_bf16 v[0:15], v[168:171], v[144:147], v[0:15]
    ds_read_b64_tr_b16 v[176:177], v184 offset:2048
    ds_read_b64_tr_b16 v[178:179], v184 offset:2560
    ds_read_b128 v[156:159], v187 offset:12288
    v_mfma_f32_32x32x16_bf16 v[32:47], v[168:171], v[148:151], v[32:47]
    ds_read_b128 v[160:163], v187 offset:13312
    ds_read_b128 v[164:167], v187 offset:14336
    ds_read_b64_tr_b16 v[180:181], v185 offset:2048
    v_mfma_f32_32x32x16_bf16 v[64:79], v[168:171], v[152:155], v[64:79]
    ds_read_b64_tr_b16 v[182:183], v185 offset:2560
    v_mfma_f32_32x32x16_bf16 v[16:31], v[172:175], v[144:147], v[16:31]
    s_waitcnt vmcnt(14)
    ds_write_b128 v193, v[246:249] offset:0
    ds_write_b128 v193, v[194:197] offset:1024
    v_mfma_f32_32x32x16_bf16 v[48:63], v[172:175], v[148:151], v[48:63]
    s_add_u32 s72, s76, 61440
    buffer_load_dwordx4 v[246:249], v190, s[20:23], s72 offen
    s_add_u32 s72, s76, 81920
    buffer_load_dwordx4 v[194:197], v190, s[20:23], s72 offen
    v_mfma_f32_32x32x16_bf16 v[80:95], v[172:175], v[152:155], v[80:95]
    s_waitcnt lgkmcnt(2)
    v_mfma_f32_32x32x16_bf16 v[0:15], v[176:179], v[156:159], v[0:15]
    ds_read_b64_tr_b16 v[168:169], v184 offset:0
    ds_read_b64_tr_b16 v[170:171], v184 offset:512
    ds_read_b128 v[144:147], v187 offset:15360
    v_mfma_f32_32x32x16_bf16 v[32:47], v[176:179], v[160:163], v[32:47]
    ds_read_b128 v[148:151], v187 offset:16384
    ds_read_b128 v[152:155], v187 offset:17408
    ds_read_b64_tr_b16 v[172:173], v185 offset:0
    v_mfma_f32_32x32x16_bf16 v[64:79], v[176:179], v[164:167], v[64:79]
    ds_read_b64_tr_b16 v[174:175], v185 offset:512
    v_mfma_f32_32x32x16_bf16 v[16:31], v[180:183], v[156:159], v[16:31]
    s_waitcnt vmcnt(12)
    ds_write_b128 v193, v[198:201] offset:2048
    ds_write_b128 v193, v[202:205] offset:3072
    v_mfma_f32_32x32x16_bf16 v[48:63], v[180:183], v[160:163], v[48:63]
    s_add_u32 s72, s76, 102400
    buffer_load_dwordx4 v[198:201], v190, s[20:23], s72 offen
    s_add_u32 s72, s76, 122880
    buffer_load_dwordx4 v[202:205], v190, s[20:23], s72 offen
    v_mfma_f32_32x32x16_bf16 v[80:95], v[180:183], v[164:167], v[80:95]
    s_waitcnt lgkmcnt(2)
    v_mfma_f32_32x32x16_bf16 v[0:15], v[168:171], v[144:147], v[0:15]
    ds_read_b64_tr_b16 v[176:177], v184 offset:2048
    ds_read_b64_tr_b16 v[178:179], v184 offset:2560
    ds_read_b128 v[156:159], v187 offset:18432
    v_mfma_f32_32x32x16_bf16 v[32:47], v[168:171], v[148:151], v[32:47]
    ds_read_b128 v[160:163], v187 offset:19456
    ds_read_b128 v[164:167], v187 offset:20480
    ds_read_b64_tr_b16 v[180:181], v185 offset:2048
    v_mfma_f32_32x32x16_bf16 v[64:79], v[168:171], v[152:155], v[64:79]
    ds_read_b64_tr_b16 v[182:183], v185 offset:2560
    v_mfma_f32_32x32x16_bf16 v[16:31], v[172:175], v[144:147], v[16:31]
    s_waitcnt vmcnt(12)
    ds_write_b128 v193, v[206:209] offset:0
    ds_write_b128 v193, v[210:213] offset:1024
    v_mfma_f32_32x32x16_bf16 v[48:63], v[172:175], v[148:151], v[48:63]
    s_add_u32 s72, s76, 143360
    buffer_load_dwordx4 v[206:209], v190, s[20:23], s72 offen
    v_mfma_f32_32x32x16_bf16 v[80:95], v[172:175], v[152:155], v[80:95]
    s_waitcnt lgkmcnt(2)
    v_mfma_f32_32x32x16_bf16 v[0:15], v[176:179], v[156:159], v[0:15]
    ds_read_b64_tr_b16 v[168:169], v184 offset:0
    ds_read_b64_tr_b16 v[170:171], v184 offset:512
    ds_read_b128 v[144:147], v187 offset:21504
    v_mfma_f32_32x32x16_bf16 v[32:47], v[176:179], v[160:163], v[32:47]
    ds_read_b128 v[148:151], v187 offset:22528
    ds_read_b128 v[152:155], v187 offset:23552
    ds_read_b64_tr_b16 v[172:173], v185 offset:0
    v_mfma_f32_32x32x16_bf16 v[64:79], v[176:179], v[164:167], v[64:79]
    ds_read_b64_tr_b16 v[174:175], v185 offset:512
    v_mfma_f32_32x32x16_bf16 v[16:31], v[180:183], v[156:159], v[16:31]
    s_waitcnt vmcnt(12)
    ds_write_b128 v193, v[214:217] offset:2048
    v_mfma_f32_32x32x16_bf16 v[48:63], v[180:183], v[160:163], v[48:63]
    v_mfma_f32_32x32x16_bf16 v[80:95], v[180:183], v[164:167], v[80:95]
    s_waitcnt lgkmcnt(1)
    v_mfma_f32_32x32x16_bf16 v[0:15], v[168:171], v[144:147], v[0:15]
    v_add_u32 v187, 98304, v188
    ds_read_b64_tr_b16 v[176:177], v186 offset:2048
    ds_read_b64_tr_b16 v[178:179], v186 offset:2304
    v_mfma_f32_32x32x16_bf16 v[32:47], v[168:171], v[148:151], v[32:47]
    ds_read_b128 v[156:159], v187 offset:9216
    ds_read_b128 v[160:163], v187 offset:10240
    ds_read_b128 v[164:167], v187 offset:11264
    v_mfma_f32_32x32x16_bf16 v[64:79], v[168:171], v[152:155], v[64:79]
    v_mfma_f32_32x32x16_bf16 v[16:31], v[172:175], v[144:147], v[16:31]
    s_waitcnt vmcnt(11)
    ds_write_b128 v193, v[218:221] offset:0
    v_mfma_f32_32x32x16_bf16 v[48:63], v[172:175], v[148:151], v[48:63]
    v_mfma_f32_32x32x16_bf16 v[80:95], v[172:175], v[152:155], v[80:95]
    s_setprio 0
    v_cvt_pk_bf16_f32 v0, v0, v1
    v_cvt_pk_bf16_f32 v1, v2, v3
    v_cvt_pk_bf16_f32 v2, v4, v5
    v_cvt_pk_bf16_f32 v3, v6, v7
    v_cvt_pk_bf16_f32 v4, v8, v9
    v_cvt_pk_bf16_f32 v5, v10, v11
    v_cvt_pk_bf16_f32 v6, v12, v13
    v_cvt_pk_bf16_f32 v7, v14, v15
    s_add_u32 s78, s69, 0
    buffer_store_dwordx4 v[0:3], v188, s[24:27], s78 offen offset:0 sc1
    buffer_store_dwordx4 v[4:7], v188, s[24:27], s78 offen offset:1024 sc1
    v_cvt_pk_bf16_f32 v32, v32, v33
    v_cvt_pk_bf16_f32 v33, v34, v35
    v_cvt_pk_bf16_f32 v34, v36, v37
    v_cvt_pk_bf16_f32 v35, v38, v39
    v_cvt_pk_bf16_f32 v36, v40, v41
    v_cvt_pk_bf16_f32 v37, v42, v43
    v_cvt_pk_bf16_f32 v38, v44, v45
    v_cvt_pk_bf16_f32 v39, v46, v47
    s_add_u32 s78, s69, 2048
    buffer_store_dwordx4 v[32:35], v188, s[24:27], s78 offen offset:0 sc1
    buffer_store_dwordx4 v[36:39], v188, s[24:27], s78 offen offset:1024 sc1
    v_cvt_pk_bf16_f32 v64, v64, v65
    v_cvt_pk_bf16_f32 v65, v66, v67
    v_cvt_pk_bf16_f32 v66, v68, v69
    v_cvt_pk_bf16_f32 v67, v70, v71
    v_cvt_pk_bf16_f32 v68, v72, v73
    v_cvt_pk_bf16_f32 v69, v74, v75
    v_cvt_pk_bf16_f32 v70, v76, v77
    v_cvt_pk_bf16_f32 v71, v78, v79
    s_add_u32 s78, s69, 4096
    buffer_store_dwordx4 v[64:67], v188, s[24:27], s78 offen offset:0 sc1
    buffer_store_dwordx4 v[68:71], v188, s[24:27], s78 offen offset:1024 sc1
    v_cvt_pk_bf16_f32 v16, v16, v17
    v_cvt_pk_bf16_f32 v17, v18, v19
    v_cvt_pk_bf16_f32 v18, v20, v21
    v_cvt_pk_bf16_f32 v19, v22, v23
    v_cvt_pk_bf16_f32 v20, v24, v25
    v_cvt_pk_bf16_f32 v21, v26, v27
    v_cvt_pk_bf16_f32 v22, v28, v29
    v_cvt_pk_bf16_f32 v23, v30, v31
    s_add_u32 s78, s69, 6144
    buffer_store_dwordx4 v[16:19], v188, s[24:27], s78 offen offset:0 sc1
    buffer_store_dwordx4 v[20:23], v188, s[24:27], s78 offen offset:1024 sc1
    v_cvt_pk_bf16_f32 v48, v48, v49
    v_cvt_pk_bf16_f32 v49, v50, v51
    v_cvt_pk_bf16_f32 v50, v52, v53
    v_cvt_pk_bf16_f32 v51, v54, v55
    v_cvt_pk_bf16_f32 v52, v56, v57
    v_cvt_pk_bf16_f32 v53, v58, v59
    v_cvt_pk_bf16_f32 v54, v60, v61
    v_cvt_pk_bf16_f32 v55, v62, v63
    s_add_u32 s78, s69, 8192
    buffer_store_dwordx4 v[48:51], v188, s[24:27], s78 offen offset:0 sc1
    buffer_store_dwordx4 v[52:55], v188, s[24:27], s78 offen offset:1024 sc1
    v_cvt_pk_bf16_f32 v80, v80, v81
    v_cvt_pk_bf16_f32 v81, v82, v83
    v_cvt_pk_bf16_f32 v82, v84, v85
    v_cvt_pk_bf16_f32 v83, v86, v87
    v_cvt_pk_bf16_f32 v84, v88, v89
    v_cvt_pk_bf16_f32 v85, v90, v91
    v_cvt_pk_bf16_f32 v86, v92, v93
    v_cvt_pk_bf16_f32 v87, v94, v95
    s_add_u32 s78, s69, 10240
    buffer_store_dwordx4 v[80:83], v188, s[24:27], s78 offen offset:0 sc1
    buffer_store_dwordx4 v[84:87], v188, s[24:27], s78 offen offset:1024 sc1
    s_waitcnt vmcnt(0)
    s_mov_b64 exec, 1
    buffer_store_dword v191, v192, s[24:27], s70 offen sc1
    s_mov_b64 exec, -1
    s_mul_i32 s72, s79, 6144
    s_sub_u32 s69, s69, s72
    s_add_u32 s69, s69, 98304
    s_add_u32 s70, s70, 64
    v_lshrrev_b32 v65, 2, v188
    v_and_b32 v65, 0x7f, v65
    s_waitcnt lgkmcnt(0)
    s_cmp_eq_u32 s79, 3
    s_cbranch_scc1 L_a_x
L_red_p0:
    buffer_load_dword v64, v65, s[24:27], s45 offen sc1
    s_sub_u32 s35, s35, 1
    s_waitcnt vmcnt(0)
    v_cmp_eq_u32 vcc, 1, v64
    s_cmp_gt_i32 s35, 0
    s_cselect_b32 s78, 0, -1
    s_or_b32 s72, vcc_lo, s78
    s_bfe_u32 s72, s72, 0x80000
    s_cmp_lg_u32 s72, 0xff
    s_cbranch_scc1 L_red_p0
L_red_i0:
    s_add_u32 s72, s42, 0
    buffer_load_dwordx4 v[0:3], v188, s[24:27], s72 offen offset:0 sc1
    buffer_load_dwordx4 v[4:7], v188, s[24:27], s72 offen offset:1024 sc1
    s_add_u32 s72, s42, 122880
    buffer_load_dwordx4 v[8:11], v188, s[24:27], s72 offen offset:0 sc1
    buffer_load_dwordx4 v[12:15], v188, s[24:27], s72 offen offset:1024 sc1
    s_add_u32 s72, s42, 245760
    buffer_load_dwordx4 v[16:19], v188, s[24:27], s72 offen offset:0 sc1
    buffer_load_dwordx4 v[20:23], v188, s[24:27], s72 offen offset:1024 sc1
    s_add_u32 s72, s42, 368640
    buffer_load_dwordx4 v[24:27], v188, s[24:27], s72 offen offset:0 sc1
    buffer_load_dwordx4 v[28:31], v188, s[24:27], s72 offen offset:1024 sc1
    s_add_u32 s72, s42, 491520
    buffer_load_dwordx4 v[32:35], v188, s[24:27], s72 offen offset:0 sc1
    buffer_load_dwordx4 v[36:39], v188, s[24:27], s72 offen offset:1024 sc1
    s_add_u32 s72, s42, 614400
    buffer_load_dwordx4 v[40:43], v188, s[24:27], s72 offen offset:0 sc1
    buffer_load_dwordx4 v[44:47], v188, s[24:27], s72 offen offset:1024 sc1
    s_add_u32 s72, s42, 737280
    buffer_load_dwordx4 v[48:51], v188, s[24:27], s72 offen offset:0 sc1
    buffer_load_dwordx4 v[52:55], v188, s[24:27], s72 offen offset:1024 sc1
    s_add_u32 s72, s42, 860160
    buffer_load_dwordx4 v[56:59], v188, s[24:27], s72 offen offset:0 sc1
    buffer_load_dwordx4 v[60:63], v188, s[24:27], s72 offen offset:1024 sc1
L_a_x:
    v_mfma_f32_32x32x16_bf16 v[96:111], v[176:179], v[156:159], v[96:111]
    ds_read_b64_tr_b16 v[168:169], v186 offset:0
    ds_read_b64_tr_b16 v[170:171], v186 offset:256
    ds_read_b128 v[144:147], v187 offset:12288
    ds_read_b128 v[148:151], v187 offset:13312
    ds_read_b128 v[152:155], v187 offset:14336
    v_mfma_f32_32x32x16_bf16 v[112:127], v[176:179], v[160:163], v[112:127]
    ds_write_b128 v193, v[222:225] offset:2048
    v_mfma_f32_32x32x16_bf16 v[128:143], v[176:179], v[164:167], v[128:143]
    s_waitcnt lgkmcnt(1)
    v_mfma_f32_32x32x16_bf16 v[96:111], v[168:171], v[144:147], v[96:111]
    ds_read_b64_tr_b16 v[176:177], v186 offset:2048
    ds_read_b64_tr_b16 v[178:179], v186 offset:2304
    ds_read_b128 v[156:159], v187 offset:15360
    ds_read_b128 v[160:163], v187 offset:16384
    ds_read_b128 v[164:167], v187 offset:17408
    v_mfma_f32_32x32x16_bf16 v[112:127], v[168:171], v[148:151], v[112:127]
    ds_write_b128 v193, v[226:229] offset:0
    v_mfma_f32_32x32x16_bf16 v[128:143], v[168:171], v[152:155], v[128:143]
    s_waitcnt lgkmcnt(1)
    v_mfma_f32_32x32x16_bf16 v[96:111], v[176:179], v[156:159], v[96:111]
    ds_read_b64_tr_b16 v[168:169], v186 offset:0
    ds_read_b64_tr_b16 v[170:171], v186 offset:256
    ds_read_b128 v[144:147], v187 offset:18432
    ds_read_b128 v[148:151], v187 offset:19456
    ds_read_b128 v[152:155], v187 offset:20480
    v_mfma_f32_32x32x16_bf16 v[112:127], v[176:179], v[160:163], v[112:127]
    ds_write_b128 v193, v[230:233] offset:2048
    v_mfma_f32_32x32x16_bf16 v[128:143], v[176:179], v[164:167], v[128:143]
    s_waitcnt lgkmcnt(1)
    v_mfma_f32_32x32x16_bf16 v[96:111], v[168:171], v[144:147], v[96:111]
    ds_read_b64_tr_b16 v[176:177], v186 offset:2048
    ds_read_b64_tr_b16 v[178:179], v186 offset:2304
    ds_read_b128 v[156:159], v187 offset:21504
    ds_read_b128 v[160:163], v187 offset:22528
    ds_read_b128 v[164:167], v187 offset:23552
    v_mfma_f32_32x32x16_bf16 v[112:127], v[168:171], v[148:151], v[112:127]
    ds_write_b128 v193, v[234:237] offset:0
    v_mfma_f32_32x32x16_bf16 v[128:143], v[168:171], v[152:155], v[128:143]
    s_waitcnt lgkmcnt(1)
    v_mfma_f32_32x32x16_bf16 v[96:111], v[176:179], v[156:159], v[96:111]
    v_add_u32 v187, 65536, v188
    ds_read_b64_tr_b16 v[168:169], v186 offset:0
    ds_read_b64_tr_b16 v[170:171], v186 offset:256
    ds_read_b128 v[144:147], v187 offset:0
    ds_read_b128 v[148:151], v187 offset:1024
    v_mfma_f32_32x32x16_bf16 v[112:127], v[176:179], v[160:163], v[112:127]
    ds_read_b128 v[152:155], v187 offset:2048
    ds_write_b128 v193, v[238:241] offset:2048
    v_mfma_f32_32x32x16_bf16 v[128:143], v[176:179], v[164:167], v[128:143]
    s_waitcnt lgkmcnt(1)
    v_mfma_f32_32x32x16_bf16 v[96:111], v[168:171], v[144:147], v[96:111]
    ds_read_b64_tr_b16 v[176:177], v186 offset:2048
    ds_read_b64_tr_b16 v[178:179], v186 offset:2304
    ds_read_b128 v[156:159], v187 offset:3072
    ds_read_b128 v[160:163], v187 offset:4096
    ds_read_b128 v[164:167], v187 offset:5120
    v_mfma_f32_32x32x16_bf16 v[112:127], v[168:171], v[148:151], v[112:127]
    ds_write_b128 v193, v[242:245] offset:0
    v_mfma_f32_32x32x16_bf16 v[128:143], v[168:171], v[152:155], v[128:143]
    s_waitcnt lgkmcnt(1)
    v_mfma_f32_32x32x16_bf16 v[96:111], v[176:179], v[156:159], v[96:111]
    ds_read_b64_tr_b16 v[168:169], v186 offset:0
    ds_read_b64_tr_b16 v[170:171], v186 offset:256
    ds_read_b128 v[144:147], v187 offset:6144
    ds_read_b128 v[148:151], v187 offset:7168
    ds_read_b128 v[152:155], v187 offset:8192
    v_mfma_f32_32x32x16_bf16 v[112:127], v[176:179], v[160:163], v[112:127]
    ds_write_b128 v193, v[246:249] offset:2048
    v_mfma_f32_32x32x16_bf16 v[128:143], v[176:179], v[164:167], v[128:143]
    s_waitcnt lgkmcnt(1)
    v_mfma_f32_32x32x16_bf16 v[96:111], v[168:171], v[144:147], v[96:111]
    ds_read_b64_tr_b16 v[176:177], v186 offset:2048
    ds_read_b64_tr_b16 v[178:179], v186 offset:2304
    ds_read_b128 v[156:159], v187 offset:9216
    ds_read_b128 v[160:163], v187 offset:10240
    ds_read_b128 v[164:167], v187 offset:11264
    v_mfma_f32_32x32x16_bf16 v[112:127], v[168:171], v[148:151], v[112:127]
    ds_write_b128 v193, v[194:197] offset:0
    v_mfma_f32_32x32x16_bf16 v[128:143], v[168:171], v[152:155], v[128:143]
    s_waitcnt lgkmcnt(1)
    v_mfma_f32_32x32x16_bf16 v[96:111], v[176:179], v[156:159], v[96:111]
    ds_read_b64_tr_b16 v[168:169], v186 offset:0
    ds_read_b64_tr_b16 v[170:171], v186 offset:256
    ds_read_b128 v[144:147], v187 offset:12288
    ds_read_b128 v[148:151], v187 offset:13312
    ds_read_b128 v[152:155], v187 offset:14336
    v_mfma_f32_32x32x16_bf16 v[112:127], v[176:179], v[160:163], v[112:127]
    ds_write_b128 v193, v[198:201] offset:2048
    v_mfma_f32_32x32x16_bf16 v[128:143], v[176:179], v[164:167], v[128:143]
    s_waitcnt lgkmcnt(1)
    v_mfma_f32_32x32x16_bf16 v[96:111], v[168:171], v[144:147], v[96:111]
    ds_read_b64_tr_b16 v[176:177], v186 offset:2048
    ds_read_b64_tr_b16 v[178:179], v186 offset:2304
    ds_read_b128 v[156:159], v187 offset:15360
    ds_read_b128 v[160:163], v187 offset:16384
    ds_read_b128 v[164:167], v187 offset:17408
    v_mfma_f32_32x32x16_bf16 v[112:127], v[168:171], v[148:151], v[112:127]
    ds_write_b128 v193, v[202:205] offset:0
    v_mfma_f32_32x32x16_bf16 v[128:143], v[168:171], v[152:155], v[128:143]
    s_waitcnt lgkmcnt(1)
    v_mfma_f32_32x32x16_bf16 v[96:111], v[176:179], v[156:159], v[96:111]
    ds_read_b64_tr_b16 v[168:169], v186 offset:0
    ds_read_b64_tr_b16 v[170:171], v186 offset:256
    ds_read_b128 v[144:147], v187 offset:18432
    ds_read_b128 v[148:151], v187 offset:19456
    ds_read_b128 v[152:155], v187 offset:20480
    v_mfma_f32_32x32x16_bf16 v[112:127], v[176:179], v[160:163], v[112:127]
    ds_write_b128 v193, v[206:209] offset:2048
    v_mfma_f32_32x32x16_bf16 v[128:143], v[176:179], v[164:167], v[128:143]
    s_waitcnt lgkmcnt(1)
    v_mfma_f32_32x32x16_bf16 v[96:111], v[168:171], v[144:147], v[96:111]
    ds_read_b64_tr_b16 v[176:177], v186 offset:2048
    ds_read_b64_tr_b16 v[178:179], v186 offset:2304
    ds_read_b128 v[156:159], v187 offset:21504
    ds_read_b128 v[160:163], v187 offset:22528
    ds_read_b128 v[164:167], v187 offset:23552
    v_mfma_f32_32x32x16_bf16 v[112:127], v[168:171], v[148:151], v[112:127]
    v_mfma_f32_32x32x16_bf16 v[128:143], v[168:171], v[152:155], v[128:143]
    s_waitcnt lgkmcnt(0)
    v_mfma_f32_32x32x16_bf16 v[96:111], v[176:179], v[156:159], v[96:111]
    v_add_u32 v187, 32768, v188
    s_lshl_b32 s78, s79, 13
    s_sub_u32 s78, s78, s92
    v_add_u32 v186, s78, v186
    v_mfma_f32_32x32x16_bf16 v[112:127], v[176:179], v[160:163], v[112:127]
    ds_read_b64_tr_b16 v[168:169], v186 offset:0
    ds_read_b64_tr_b16 v[170:171], v186 offset:256
    ds_read_b128 v[144:147], v187 offset:0
    ds_read_b128 v[148:151], v187 offset:1024
    ds_read_b128 v[152:155], v187 offset:2048
    v_mfma_f32_32x32x16_bf16 v[128:143], v[176:179], v[164:167], v[128:143]
    s_waitcnt lgkmcnt(0)
    v_mfma_f32_32x32x16_bf16 v[96:111], v[168:171], v[144:147], v[96:111]
    ds_read_b64_tr_b16 v[176:177], v186 offset:1024
    ds_read_b64_tr_b16 v[178:179], v186 offset:1280
    ds_read_b128 v[156:159], v187 offset:3072
    ds_read_b128 v[160:163], v187 offset:4096
    ds_read_b128 v[164:167], v187 offset:5120
    v_mfma_f32_32x32x16_bf16 v[112:127], v[168:171], v[148:151], v[112:127]
    v_mfma_f32_32x32x16_bf16 v[128:143], v[168:171], v[152:155], v[128:143]
    s_waitcnt lgkmcnt(0)
    v_mfma_f32_32x32x16_bf16 v[96:111], v[176:179], v[156:159], v[96:111]
    ds_read_b64_tr_b16 v[168:169], v186 offset:2048
    ds_read_b64_tr_b16 v[170:171], v186 offset:2304
    ds_read_b128 v[144:147], v187 offset:6144
    ds_read_b128 v[148:151], v187 offset:7168
    ds_read_b128 v[152:155], v187 offset:8192
    v_mfma_f32_32x32x16_bf16 v[112:127], v[176:179], v[160:163], v[112:127]
    v_mfma_f32_32x32x16_bf16 v[128:143], v[176:179], v[164:167], v[128:143]
    s_waitcnt lgkmcnt(0)
    v_mfma_f32_32x32x16_bf16 v[96:111], v[168:171], v[144:147], v[96:111]
    ds_read_b64_tr_b16 v[176:177], v186 offset:3072
    ds_read_b64_tr_b16 v[178:179], v186 offset:3328
    ds_read_b128 v[156:159], v187 offset:9216
    ds_read_b128 v[160:163], v187 offset:10240
    ds_read_b128 v[164:167], v187 offset:11264
    v_mfma_f32_32x32x16_bf16 v[112:127], v[168:171], v[148:151], v[112:127]
    v_mfma_f32_32x32x16_bf16 v[128:143], v[168:171], v[152:155], v[128:143]
    s_waitcnt lgkmcnt(0)
    v_mfma_f32_32x32x16_bf16 v[96:111], v[176:179], v[156:159], v[96:111]
    ds_read_b64_tr_b16 v[168:169], v186 offset:4096
    ds_read_b64_tr_b16 v[170:171], v186 offset:4352
    ds_read_b128 v[144:147], v187 offset:12288
    ds_read_b128 v[148:151], v187 offset:13312
    ds_read_b128 v[152:155], v187 offset:14336
    v_mfma_f32_32x32x16_bf16 v[112:127], v[176:179], v[160:163], v[112:127]
    v_mfma_f32_32x32x16_bf16 v[128:143], v[176:179], v[164:167], v[128:143]
    s_waitcnt lgkmcnt(0)
    v_mfma_f32_32x32x16_bf16 v[96:111], v[168:171], v[144:147], v[96:111]
    ds_read_b64_tr_b16 v[176:177], v186 offset:5120
    ds_read_b64_tr_b16 v[178:179], v186 offset:5376
    ds_read_b128 v[156:159], v187 offset:15360
    ds_read_b128 v[160:163], v187 offset:16384
    ds_read_b128 v[164:167], v187 offset:17408
    v_mfma_f32_32x32x16_bf16 v[112:127], v[168:171], v[148:151], v[112:127]
    v_mfma_f32_32x32x16_bf16 v[128:143], v[168:171], v[152:155], v[128:143]
    s_waitcnt lgkmcnt(0)
    v_mfma_f32_32x32x16_bf16 v[96:111], v[176:179], v[156:159], v[96:111]
    ds_read_b64_tr_b16 v[168:169], v186 offset:6144
    ds_read_b64_tr_b16 v[170:171], v186 offset:6400
    ds_read_b128 v[144:147], v187 offset:18432
    ds_read_b128 v[148:151], v187 offset:19456
    ds_read_b128 v[152:155], v187 offset:20480
    v_mfma_f32_32x32x16_bf16 v[112:127], v[176:179], v[160:163], v[112:127]
    v_mfma_f32_32x32x16_bf16 v[128:143], v[176:179], v[164:167], v[128:143]
    s_waitcnt lgkmcnt(0)
    v_mfma_f32_32x32x16_bf16 v[96:111], v[168:171], v[144:147], v[96:111]
    ds_read_b64_tr_b16 v[176:177], v186 offset:7168
    ds_read_b64_tr_b16 v[178:179], v186 offset:7424
    ds_read_b128 v[156:159], v187 offset:21504
    ds_read_b128 v[160:163], v187 offset:22528
    ds_read_b128 v[164:167], v187 offset:23552
    v_mfma_f32_32x32x16_bf16 v[112:127], v[168:171], v[148:151], v[112:127]
    v_mfma_f32_32x32x16_bf16 v[128:143], v[168:171], v[152:155], v[128:143]
    s_waitcnt lgkmcnt(0)
    v_mfma_f32_32x32x16_bf16 v[96:111], v[176:179], v[156:159], v[96:111]
    v_mfma_f32_32x32x16_bf16 v[112:127], v[176:179], v[160:163], v[112:127]
    v_mfma_f32_32x32x16_bf16 v[128:143], v[176:179], v[164:167], v[128:143]
    s_nop 9
    v_cvt_pk_bf16_f32 v96, v96, v97
    v_cvt_pk_bf16_f32 v97, v98, v99
    v_cvt_pk_bf16_f32 v98, v100, v101
    v_cvt_pk_bf16_f32 v99, v102, v103
    v_cvt_pk_bf16_f32 v100, v104, v105
    v_cvt_pk_bf16_f32 v101, v106, v107
    v_cvt_pk_bf16_f32 v102, v108, v109
    v_cvt_pk_bf16_f32 v103, v110, v111
    s_add_u32 s78, s69, 0
    buffer_store_dwordx4 v[96:99], v188, s[24:27], s78 offen offset:0 sc1
    buffer_store_dwordx4 v[100:103], v188, s[24:27], s78 offen offset:1024 sc1
    v_cvt_pk_bf16_f32 v112, v112, v113
    v_cvt_pk_bf16_f32 v113, v114, v115
    v_cvt_pk_bf16_f32 v114, v116, v117
    v_cvt_pk_bf16_f32 v115, v118, v119
    v_cvt_pk_bf16_f32 v116, v120, v121
    v_cvt_pk_bf16_f32 v117, v122, v123
    v_cvt_pk_bf16_f32 v118, v124, v125
    v_cvt_pk_bf16_f32 v119, v126, v127
    s_add_u32 s78, s69, 2048
    buffer_store_dwordx4 v[112:115], v188, s[24:27], s78 offen offset:0 sc1
    buffer_store_dwordx4 v[116:119], v188, s[24:27], s78 offen offset:1024 sc1
    v_cvt_pk_bf16_f32 v128, v128, v129
    v_cvt_pk_bf16_f32 v129, v130, v131
    v_cvt_pk_bf16_f32 v130, v132, v133
    v_cvt_pk_bf16_f32 v131, v134, v135
    v_cvt_pk_bf16_f32 v132, v136, v137
    v_cvt_pk_bf16_f32 v133, v138, v139
    v_cvt_pk_bf16_f32 v134, v140, v141
    v_cvt_pk_bf16_f32 v135, v142, v143
    s_add_u32 s78, s69, 4096
    buffer_store_dwordx4 v[128:131], v188, s[24:27], s78 offen offset:0 sc1
    buffer_store_dwordx4 v[132:135], v188, s[24:27], s78 offen offset:1024 sc1
    s_waitcnt vmcnt(0)
    s_mov_b64 exec, 1
    buffer_store_dword v191, v192, s[24:27], s70 offen sc1
    s_mov_b64 exec, -1
    s_cmp_eq_u32 s79, 3
    s_cbranch_scc1 L_end
L_a_z:
    v_lshrrev_b32 v202, 4, v188
    v_and_b32 v203, 31, v202
    v_lshrrev_b32 v204, 5, v202
    v_mul_u32_u24 v200, 2560, v203
    v_lshl_add_u32 v200, v204, 4, v200
    v_bfe_u32 v205, v203, 2, 1
    v_xor_b32 v205, v205, v204
    v_lshrrev_b32 v206, 4, v203
    v_or_b32 v205, v205, v206
    v_lshlrev_b32 v205, 3, v205
    v_bfe_u32 v206, v203, 3, 1
    v_bfe_u32 v202, v203, 1, 1
    v_lshl_or_b32 v206, v206, 1, v202
    v_or_b32 v205, v205, v206
    v_and_b32 v206, 1, v203
    v_lshlrev_b32 v206, 4, v206
    v_mov_b32 v202, 0x3f80
    v_lshlrev_b32 v206, v206, v202
    v_cmp_eq_u32 vcc, 0, v205
    s_nop 1
    v_cndmask_b32 v196, 0, v206, vcc
    v_cmp_eq_u32 vcc, 1, v205
    s_nop 1
    v_cndmask_b32 v197, 0, v206, vcc
    v_cmp_eq_u32 vcc, 2, v205
    s_nop 1
    v_cndmask_b32 v198, 0, v206, vcc
    v_cmp_eq_u32 vcc, 3, v205
    s_nop 1
    v_cndmask_b32 v199, 0, v206, vcc
    s_nop 1
    v_mfma_f32_32x32x16_bf16 v[64:79], v[196:199], v[0:3], 0
    v_mfma_f32_32x32x16_bf16 v[80:95], v[196:199], v[4:7], 0
    v_mfma_f32_32x32x16_bf16 v[64:79], v[196:199], v[8:11], v[64:79]
    v_mfma_f32_32x32x16_bf16 v[80:95], v[196:199], v[12:15], v[80:95]
    v_mfma_f32_32x32x16_bf16 v[64:79], v[196:199], v[16:19], v[64:79]
    v_mfma_f32_32x32x16_bf16 v[80:95], v[196:199], v[20:23], v[80:95]
    v_mfma_f32_32x32x16_bf16 v[64:79], v[196:199], v[24:27], v[64:79]
    v_mfma_f32_32x32x16_bf16 v[80:95], v[196:199], v[28:31], v[80:95]
    v_mfma_f32_32x32x16_bf16 v[64:79], v[196:199], v[32:35], v[64:79]
    v_mfma_f32_32x32x16_bf16 v[80:95], v[196:199], v[36:39], v[80:95]
    v_mfma_f32_32x32x16_bf16 v[64:79], v[196:199], v[40:43], v[64:79]
    v_mfma_f32_32x32x16_bf16 v[80:95], v[196:199], v[44:47], v[80:95]
    v_mfma_f32_32x32x16_bf16 v[64:79], v[196:199], v[48:51], v[64:79]
    v_mfma_f32_32x32x16_bf16 v[80:95], v[196:199], v[52:55], v[80:95]
    v_mfma_f32_32x32x16_bf16 v[64:79], v[196:199], v[56:59], v[64:79]
    v_mfma_f32_32x32x16_bf16 v[80:95], v[196:199], v[60:63], v[80:95]
    s_nop 10
    v_cvt_pk_bf16_f32 v64, v64, v65
    v_cvt_pk_bf16_f32 v65, v66, v67
    v_cvt_pk_bf16_f32 v66, v68, v69
    v_cvt_pk_bf16_f32 v67, v70, v71
    buffer_store_dwordx4 v[64:67], v200, s[28:31], s36 offen offset:0
    v_cvt_pk_bf16_f32 v80, v80, v81
    v_cvt_pk_bf16_f32 v81, v82, v83
    v_cvt_pk_bf16_f32 v82, v84, v85
    v_cvt_pk_bf16_f32 v83, v86, v87
    buffer_store_dwordx4 v[80:83], v200, s[28:31], s36 offen offset:32
L_a_y:
    s_endpgm
L_tb:
    s_setprio 1
    v_mbcnt_lo_u32_b32 v188, -1, 0
    v_mbcnt_hi_u32_b32 v188, -1, v188
    v_lshrrev_b32 v191, 3, v188
    v_mul_u32_u24 v189, 1280, v191
    v_bfe_u32 v191, v188, 4, 1
    v_lshlrev_b32 v191, 2, v191
    v_and_b32 v192, 7, v188
    v_xor_b32 v191, v191, v192
    v_lshl_add_u32 v189, v191, 4, v189
    s_lshl_b32 s78, s79, 7
    s_add_u32 s78, s78, 512
    s_mul_i32 s76, s64, 163840
    s_add_u32 s74, s76, s78
    s_add_u32 s72, s74, 327680
    buffer_load_dwordx4 v[96:99], v189, s[20:23], s72 offen
    s_add_u32 s72, s74, 337920
    buffer_load_dwordx4 v[100:103], v189, s[20:23], s72 offen
    s_add_u32 s72, s74, 348160
    buffer_load_dwordx4 v[104:107], v189, s[20:23], s72 offen
    s_add_u32 s72, s74, 358400
    buffer_load_dwordx4 v[108:111], v189, s[20:23], s72 offen
    s_add_u32 s72, s74, 368640
    buffer_load_dwordx4 v[112:115], v189, s[20:23], s72 offen
    s_add_u32 s72, s74, 378880
    buffer_load_dwordx4 v[116:119], v189, s[20:23], s72 offen
    s_add_u32 s72, s74, 389120
    buffer_load_dwordx4 v[120:123], v189, s[20:23], s72 offen
    s_add_u32 s72, s74, 399360
    buffer_load_dwordx4 v[124:127], v189, s[20:23], s72 offen
    s_add_u32 s72, s74, 409600
    buffer_load_dwordx4 v[128:131], v189, s[20:23], s72 offen
    s_add_u32 s72, s74, 419840
    buffer_load_dwordx4 v[132:135], v189, s[20:23], s72 offen
    s_add_u32 s72, s74, 430080
    buffer_load_dwordx4 v[136:139], v189, s[20:23], s72 offen
    s_add_u32 s72, s74, 440320
    buffer_load_dwordx4 v[140:143], v189, s[20:23], s72 offen
    s_add_u32 s72, s74, 450560
    buffer_load_dwordx4 v[194:197], v189, s[20:23], s72 offen
    s_add_u32 s72, s74, 460800
    buffer_load_dwordx4 v[198:201], v189, s[20:23], s72 offen
    s_add_u32 s72, s74, 471040
    buffer_load_dwordx4 v[202:205], v189, s[20:23], s72 offen
    s_add_u32 s72, s74, 481280
    buffer_load_dwordx4 v[206:209], v189, s[20:23], s72 offen
    s_add_u32 s72, s74, 163840
    buffer_load_dwordx4 v[210:213], v189, s[20:23], s72 offen
    s_add_u32 s72, s74, 174080
    buffer_load_dwordx4 v[214:217], v189, s[20:23], s72 offen
    s_add_u32 s72, s74, 184320
    buffer_load_dwordx4 v[218:221], v189, s[20:23], s72 offen
    s_add_u32 s72, s74, 194560
    buffer_load_dwordx4 v[222:225], v189, s[20:23], s72 offen
    s_add_u32 s72, s74, 204800
    buffer_load_dwordx4 v[226:229], v189, s[20:23], s72 offen
    s_add_u32 s72, s74, 215040
    buffer_load_dwordx4 v[230:233], v189, s[20:23], s72 offen
    s_add_u32 s72, s74, 225280
    buffer_load_dwordx4 v[234:237], v189, s[20:23], s72 offen
    s_add_u32 s72, s74, 235520
    buffer_load_dwordx4 v[238:241], v189, s[20:23], s72 offen
    s_add_u32 s72, s74, 245760
    buffer_load_dwordx4 v[242:245], v189, s[20:23], s72 offen
    s_add_u32 s72, s74, 256000
    buffer_load_dwordx4 v[246:249], v189, s[20:23], s72 offen
    s_lshl_b32 s72, s79, 3
    s_lshr_b32 s92, 0x0f0e1716, s72
    s_and_b32 s92, s92, 0xff
    s_lshl_b32 s92, s92, 12
    v_bfe_u32 v191, v188, 4, 1
    v_lshlrev_b32 v186, 5, v191
    v_and_b32 v191, 1, v188
    v_lshl_add_u32 v186, v191, 4, v186
    v_bfe_u32 v191, v188, 1, 1
    v_lshl_add_u32 v186, v191, 3, v186
    v_add_u32 v186, s92, v186
    v_lshrrev_b32 v191, 5, v188
    v_bfe_u32 v192, v188, 2, 2
    v_lshl_add_u32 v191, v191, 3, v192
    v_lshl_add_u32 v184, v191, 7, v186
    v_lshl_add_u32 v186, v191, 6, v186
    v_bfe_u32 v192, v188, 3, 1
    v_lshl_add_u32 v184, v192, 6, v184
    v_xor_b32 v185, 64, v184
    v_lshlrev_b32 v188, 4, v188
    v_add_u32 v193, s92, v188
    v_mov_b32 v191, 1
    v_mov_b32 v192, 0
    s_lshl_b32 s72, s66, 3
    s_add_u32 s72, s72, s65
    s_mul_i32 s69, s72, 122880
    s_mul_i32 s72, s79, 12288
    s_add_u32 s69, s69, s72
    s_add_u32 s69, s69, 49152
    s_lshl_b32 s70, s66, 9
    s_lshl_b32 s72, s79, 7
    s_add_u32 s70, s70, s72
    s_lshl_b32 s72, s65, 2
    s_add_u32 s70, s70, s72
    s_add_u32 s70, s70, 41943072
    s_waitcnt vmcnt(24)
    ds_write_b128 v193, v[96:99] offset:0
    ds_write_b128 v193, v[100:103] offset:1024
    s_add_u32 s72, s74, 266240
    buffer_load_dwordx4 v[96:99], v189, s[20:23], s72 offen
    s_add_u32 s72, s74, 276480
    buffer_load_dwordx4 v[100:103], v189, s[20:23], s72 offen
    s_waitcnt vmcnt(24)
    ds_write_b128 v193, v[104:107] offset:2048
    ds_write_b128 v193, v[108:111] offset:3072
    s_add_u32 s72, s74, 286720
    buffer_load_dwordx4 v[104:107], v189, s[20:23], s72 offen
    s_add_u32 s72, s74, 296960
    buffer_load_dwordx4 v[108:111], v189, s[20:23], s72 offen
    v_add_u32 v187, 139264, v188
    ds_read_b64_tr_b16 v[168:169], v184 offset:0
    ds_read_b64_tr_b16 v[170:171], v184 offset:512
    ds_read_b128 v[144:147], v187 offset:0
    ds_read_b128 v[148:151], v187 offset:1024
    ds_read_b128 v[152:155], v187 offset:2048
    ds_read_b64_tr_b16 v[172:173], v185 offset:0
    ds_read_b64_tr_b16 v[174:175], v185 offset:512
    s_waitcnt lgkmcnt(0)
    v_mfma_f32_32x32x16_bf16 v[0:15], v[168:171], v[144:147], 0
    ds_read_b64_tr_b16 v[176:177], v184 offset:2048
    ds_read_b64_tr_b16 v[178:179], v184 offset:2560
    ds_read_b128 v[156:159], v187 offset:3072
    v_mfma_f32_32x32x16_bf16 v[32:47], v[168:171], v[148:151], 0
    ds_read_b128 v[160:163], v187 offset:4096
    ds_read_b128 v[164:167], v187 offset:5120
    ds_read_b64_tr_b16 v[180:181], v185 offset:2048
    v_mfma_f32_32x32x16_bf16 v[64:79], v[168:171], v[152:155], 0
    ds_read_b64_tr_b16 v[182:183], v185 offset:2560
    v_mfma_f32_32x32x16_bf16 v[16:31], v[172:175], v[144:147], 0
    s_waitcnt vmcnt(24)
    ds_write_b128 v193, v[112:115] offset:0
    ds_write_b128 v193, v[116:119] offset:1024
    v_mfma_f32_32x32x16_bf16 v[48:63], v[172:175], v[148:151], 0
    s_add_u32 s72, s74, 307200
    buffer_load_dwordx4 v[112:115], v189, s[20:23], s72 offen
    s_add_u32 s72, s74, 317440
    buffer_load_dwordx4 v[116:119], v189, s[20:23], s72 offen
    v_mfma_f32_32x32x16_bf16 v[80:95], v[172:175], v[152:155], 0
    s_waitcnt lgkmcnt(2)
    v_mfma_f32_32x32x16_bf16 v[0:15], v[176:179], v[156:159], v[0:15]
    ds_read_b64_tr_b16 v[168:169], v184 offset:0
    ds_read_b64_tr_b16 v[170:171], v184 offset:512
    ds_read_b128 v[144:147], v187 offset:6144
    v_mfma_f32_32x32x16_bf16 v[32:47], v[176:179], v[160:163], v[32:47]
    ds_read_b128 v[148:151], v187 offset:7168
    ds_read_b128 v[152:155], v187 offset:8192
    ds_read_b64_tr_b16 v[172:173], v185 offset:0
    v_mfma_f32_32x32x16_bf16 v[64:79], v[176:179], v[164:167], v[64:79]
    ds_read_b64_tr_b16 v[174:175], v185 offset:512
    v_mfma_f32_32x32x16_bf16 v[16:31], v[180:183], v[156:159], v[16:31]
    s_waitcnt vmcnt(24)
    ds_write_b128 v193, v[120:123] offset:2048
    ds_write_b128 v193, v[124:127] offset:3072
    v_mfma_f32_32x32x16_bf16 v[48:63], v[180:183], v[160:163], v[48:63]
    s_add_u32 s72, s74, 0
    buffer_load_dwordx4 v[120:123], v189, s[20:23], s72 offen
    s_add_u32 s72, s74, 10240
    buffer_load_dwordx4 v[124:127], v189, s[20:23], s72 offen
    v_mfma_f32_32x32x16_bf16 v[80:95], v[180:183], v[164:167], v[80:95]
    s_waitcnt lgkmcnt(2)
    v_mfma_f32_32x32x16_bf16 v[0:15], v[168:171], v[144:147], v[0:15]
    ds_read_b64_tr_b16 v[176:177], v184 offset:2048
    ds_read_b64_tr_b16 v[178:179], v184 offset:2560
    ds_read_b128 v[156:159], v187 offset:9216
    v_mfma_f32_32x32x16_bf16 v[32:47], v[168:171], v[148:151], v[32:47]
    ds_read_b128 v[160:163], v187 offset:10240
    ds_read_b128 v[164:167], v187 offset:11264
    ds_read_b64_tr_b16 v[180:181], v185 offset:2048
    v_mfma_f32_32x32x16_bf16 v[64:79], v[168:171], v[152:155], v[64:79]
    ds_read_b64_tr_b16 v[182:183], v185 offset:2560
    v_mfma_f32_32x32x16_bf16 v[16:31], v[172:175], v[144:147], v[16:31]
    s_waitcnt vmcnt(24)
    ds_write_b128 v193, v[128:131] offset:0
    ds_write_b128 v193, v[132:135] offset:1024
    v_mfma_f32_32x32x16_bf16 v[48:63], v[172:175], v[148:151], v[48:63]
    s_add_u32 s72, s74, 20480
    buffer_load_dwordx4 v[128:131], v189, s[20:23], s72 offen
    s_add_u32 s72, s74, 30720
    buffer_load_dwordx4 v[132:135], v189, s[20:23], s72 offen
    v_mfma_f32_32x32x16_bf16 v[80:95], v[172:175], v[152:155], v[80:95]
    s_waitcnt lgkmcnt(2)
    v_mfma_f32_32x32x16_bf16 v[0:15], v[176:179], v[156:159], v[0:15]
    ds_read_b64_tr_b16 v[168:169], v184 offset:0
    ds_read_b64_tr_b16 v[170:171], v184 offset:512
    ds_read_b128 v[144:147], v187 offset:12288
    v_mfma_f32_32x32x16_bf16 v[32:47], v[176:179], v[160:163], v[32:47]
    ds_read_b128 v[148:151], v187 offset:13312
    ds_read_b128 v[152:155], v187 offset:14336
    ds_read_b64_tr_b16 v[172:173], v185 offset:0
    v_mfma_f32_32x32x16_bf16 v[64:79], v[176:179], v[164:167], v[64:79]
    ds_read_b64_tr_b16 v[174:175], v185 offset:512
    v_mfma_f32_32x32x16_bf16 v[16:31], v[180:183], v[156:159], v[16:31]
    s_waitcnt vmcnt(24)
    ds_write_b128 v193, v[136:139] offset:2048
    ds_write_b128 v193, v[140:143] offset:3072
    v_mfma_f32_32x32x16_bf16 v[48:63], v[180:183], v[160:163], v[48:63]
    s_add_u32 s72, s74, 40960
    buffer_load_dwordx4 v[136:139], v189, s[20:23], s72 offen
    s_add_u32 s72, s74, 51200
    buffer_load_dwordx4 v[140:143], v189, s[20:23], s72 offen
    v_mfma_f32_32x32x16_bf16 v[80:95], v[180:183], v[164:167], v[80:95]
    s_waitcnt lgkmcnt(2)
    v_mfma_f32_32x32x16_bf16 v[0:15], v[168:171], v[144:147], v[0:15]
    ds_read_b64_tr_b16 v[176:177], v184 offset:2048
    ds_read_b64_tr_b16 v[178:179], v184 offset:2560
    ds_read_b128 v[156:159], v187 offset:15360
    v_mfma_f32_32x32x16_bf16 v[32:47], v[168:171], v[148:151], v[32:47]
    ds_read_b128 v[160:163], v187 offset:16384
    ds_read_b128 v[164:167], v187 offset:17408
    ds_read_b64_tr_b16 v[180:181], v185 offset:2048
    v_mfma_f32_32x32x16_bf16 v[64:79], v[168:171], v[152:155], v[64:79]
    ds_read_b64_tr_b16 v[182:183], v185 offset:2560
    v_mfma_f32_32x32x16_bf16 v[16:31], v[172:175], v[144:147], v[16:31]
    s_waitcnt vmcnt(24)
    ds_write_b128 v193, v[194:197] offset:0
    ds_write_b128 v193, v[198:201] offset:1024
    v_mfma_f32_32x32x16_bf16 v[48:63], v[172:175], v[148:151], v[48:63]
    s_add_u32 s72, s74, 61440
    buffer_load_dwordx4 v[194:197], v189, s[20:23], s72 offen
    s_add_u32 s72, s74, 71680
    buffer_load_dwordx4 v[198:201], v189, s[20:23], s72 offen
    v_mfma_f32_32x32x16_bf16 v[80:95], v[172:175], v[152:155], v[80:95]
    s_waitcnt lgkmcnt(2)
    v_mfma_f32_32x32x16_bf16 v[0:15], v[176:179], v[156:159], v[0:15]
    ds_read_b64_tr_b16 v[168:169], v184 offset:0
    ds_read_b64_tr_b16 v[170:171], v184 offset:512
    ds_read_b128 v[144:147], v187 offset:18432
    v_mfma_f32_32x32x16_bf16 v[32:47], v[176:179], v[160:163], v[32:47]
    ds_read_b128 v[148:151], v187 offset:19456
    ds_read_b128 v[152:155], v187 offset:20480
    ds_read_b64_tr_b16 v[172:173], v185 offset:0
    v_mfma_f32_32x32x16_bf16 v[64:79], v[176:179], v[164:167], v[64:79]
    ds_read_b64_tr_b16 v[174:175], v185 offset:512
    v_mfma_f32_32x32x16_bf16 v[16:31], v[180:183], v[156:159], v[16:31]
    s_waitcnt vmcnt(24)
    ds_write_b128 v193, v[202:205] offset:2048
    ds_write_b128 v193, v[206:209] offset:3072
    v_mfma_f32_32x32x16_bf16 v[48:63], v[180:183], v[160:163], v[48:63]
    s_add_u32 s72, s74, 81920
    buffer_load_dwordx4 v[202:205], v189, s[20:23], s72 offen
    s_add_u32 s72, s74, 92160
    buffer_load_dwordx4 v[206:209], v189, s[20:23], s72 offen
    v_mfma_f32_32x32x16_bf16 v[80:95], v[180:183], v[164:167], v[80:95]
    s_waitcnt lgkmcnt(2)
    v_mfma_f32_32x32x16_bf16 v[0:15], v[168:171], v[144:147], v[0:15]
    ds_read_b64_tr_b16 v[176:177], v184 offset:2048
    ds_read_b64_tr_b16 v[178:179], v184 offset:2560
    ds_read_b128 v[156:159], v187 offset:21504
    v_mfma_f32_32x32x16_bf16 v[32:47], v[168:171], v[148:151], v[32:47]
    ds_read_b128 v[160:163], v187 offset:22528
    ds_read_b128 v[164:167], v187 offset:23552
    ds_read_b64_tr_b16 v[180:181], v185 offset:2048
    v_mfma_f32_32x32x16_bf16 v[64:79], v[168:171], v[152:155], v[64:79]
    ds_read_b64_tr_b16 v[182:183], v185 offset:2560
    v_mfma_f32_32x32x16_bf16 v[16:31], v[172:175], v[144:147], v[16:31]
    s_waitcnt vmcnt(24)
    ds_write_b128 v193, v[210:213] offset:0
    ds_write_b128 v193, v[214:217] offset:1024
    v_mfma_f32_32x32x16_bf16 v[48:63], v[172:175], v[148:151], v[48:63]
    s_add_u32 s72, s74, 102400
    buffer_load_dwordx4 v[210:213], v189, s[20:23], s72 offen
    s_add_u32 s72, s74, 112640
    buffer_load_dwordx4 v[214:217], v189, s[20:23], s72 offen
    v_mfma_f32_32x32x16_bf16 v[80:95], v[172:175], v[152:155], v[80:95]
    s_waitcnt lgkmcnt(2)
    v_mfma_f32_32x32x16_bf16 v[0:15], v[176:179], v[156:159], v[0:15]
    v_add_u32 v187, 98304, v188
    ds_read_b64_tr_b16 v[168:169], v184 offset:0
    ds_read_b64_tr_b16 v[170:171], v184 offset:512
    v_mfma_f32_32x32x16_bf16 v[32:47], v[176:179], v[160:163], v[32:47]
    ds_read_b128 v[144:147], v187 offset:0
    ds_read_b128 v[148:151], v187 offset:1024
    ds_read_b128 v[152:155], v187 offset:2048
    v_mfma_f32_32x32x16_bf16 v[64:79], v[176:179], v[164:167], v[64:79]
    ds_read_b64_tr_b16 v[172:173], v185 offset:0
    ds_read_b64_tr_b16 v[174:175], v185 offset:512
    v_mfma_f32_32x32x16_bf16 v[16:31], v[180:183], v[156:159], v[16:31]
    s_waitcnt vmcnt(24)
    ds_write_b128 v193, v[218:221] offset:2048
    ds_write_b128 v193, v[222:225] offset:3072
    v_mfma_f32_32x32x16_bf16 v[48:63], v[180:183], v[160:163], v[48:63]
    s_add_u32 s72, s74, 122880
    buffer_load_dwordx4 v[218:221], v189, s[20:23], s72 offen
    s_add_u32 s72, s74, 133120
    buffer_load_dwordx4 v[222:225], v189, s[20:23], s72 offen
    v_mfma_f32_32x32x16_bf16 v[80:95], v[180:183], v[164:167], v[80:95]
    s_waitcnt lgkmcnt(2)
    v_mfma_f32_32x32x16_bf16 v[0:15], v[168:171], v[144:147], v[0:15]
    ds_read_b64_tr_b16 v[176:177], v184 offset:2048
    ds_read_b64_tr_b16 v[178:179], v184 offset:2560
    ds_read_b128 v[156:159], v187 offset:3072
    v_mfma_f32_32x32x16_bf16 v[32:47], v[168:171], v[148:151], v[32:47]
    ds_read_b128 v[160:163], v187 offset:4096
    ds_read_b128 v[164:167], v187 offset:5120
    ds_read_b64_tr_b16 v[180:181], v185 offset:2048
    v_mfma_f32_32x32x16_bf16 v[64:79], v[168:171], v[152:155], v[64:79]
    ds_read_b64_tr_b16 v[182:183], v185 offset:2560
    v_mfma_f32_32x32x16_bf16 v[16:31], v[172:175], v[144:147], v[16:31]
    s_waitcnt vmcnt(24)
    ds_write_b128 v193, v[226:229] offset:0
    ds_write_b128 v193, v[230:233] offset:1024
    v_mfma_f32_32x32x16_bf16 v[48:63], v[172:175], v[148:151], v[48:63]
    s_add_u32 s72, s74, 143360
    buffer_load_dwordx4 v[226:229], v189, s[20:23], s72 offen
    s_add_u32 s72, s74, 153600
    buffer_load_dwordx4 v[230:233], v189, s[20:23], s72 offen
    v_mfma_f32_32x32x16_bf16 v[80:95], v[172:175], v[152:155], v[80:95]
    s_waitcnt lgkmcnt(2)
    v_mfma_f32_32x32x16_bf16 v[0:15], v[176:179], v[156:159], v[0:15]
    ds_read_b64_tr_b16 v[168:169], v184 offset:0
    ds_read_b64_tr_b16 v[170:171], v184 offset:512
    ds_read_b128 v[144:147], v187 offset:6144
    v_mfma_f32_32x32x16_bf16 v[32:47], v[176:179], v[160:163], v[32:47]
    ds_read_b128 v[148:151], v187 offset:7168
    ds_read_b128 v[152:155], v187 offset:8192
    ds_read_b64_tr_b16 v[172:173], v185 offset:0
    v_mfma_f32_32x32x16_bf16 v[64:79], v[176:179], v[164:167], v[64:79]
    ds_read_b64_tr_b16 v[174:175], v185 offset:512
    v_mfma_f32_32x32x16_bf16 v[16:31], v[180:183], v[156:159], v[16:31]
    s_waitcnt vmcnt(24)
    ds_write_b128 v193, v[234:237] offset:2048
    ds_write_b128 v193, v[238:241] offset:3072
    v_mfma_f32_32x32x16_bf16 v[48:63], v[180:183], v[160:163], v[48:63]
    s_add_u32 s72, s74, 491520
    buffer_load_dwordx4 v[234:237], v189, s[20:23], s72 offen
    s_add_u32 s72, s74, 501760
    buffer_load_dwordx4 v[238:241], v189, s[20:23], s72 offen
    v_mfma_f32_32x32x16_bf16 v[80:95], v[180:183], v[164:167], v[80:95]
    s_waitcnt lgkmcnt(2)
    v_mfma_f32_32x32x16_bf16 v[0:15], v[168:171], v[144:147], v[0:15]
    ds_read_b64_tr_b16 v[176:177], v184 offset:2048
    ds_read_b64_tr_b16 v[178:179], v184 offset:2560
    ds_read_b128 v[156:159], v187 offset:9216
    v_mfma_f32_32x32x16_bf16 v[32:47], v[168:171], v[148:151], v[32:47]
    ds_read_b128 v[160:163], v187 offset:10240
    ds_read_b128 v[164:167], v187 offset:11264
    ds_read_b64_tr_b16 v[180:181], v185 offset:2048
    v_mfma_f32_32x32x16_bf16 v[64:79], v[168:171], v[152:155], v[64:79]
    ds_read_b64_tr_b16 v[182:183], v185 offset:2560
    v_mfma_f32_32x32x16_bf16 v[16:31], v[172:175], v[144:147], v[16:31]
    s_waitcnt vmcnt(24)
    ds_write_b128 v193, v[242:245] offset:0
    ds_write_b128 v193, v[246:249] offset:1024
    v_mfma_f32_32x32x16_bf16 v[48:63], v[172:175], v[148:151], v[48:63]
    s_add_u32 s72, s74, 512000
    buffer_load_dwordx4 v[242:245], v189, s[20:23], s72 offen
    s_add_u32 s72, s74, 522240
    buffer_load_dwordx4 v[246:249], v189, s[20:23], s72 offen
    v_mfma_f32_32x32x16_bf16 v[80:95], v[172:175], v[152:155], v[80:95]
    s_waitcnt lgkmcnt(2)
    v_mfma_f32_32x32x16_bf16 v[0:15], v[176:179], v[156:159], v[0:15]
    ds_read_b64_tr_b16 v[168:169], v184 offset:0
    ds_read_b64_tr_b16 v[170:171], v184 offset:512
    ds_read_b128 v[144:147], v187 offset:12288
    v_mfma_f32_32x32x16_bf16 v[32:47], v[176:179], v[160:163], v[32:47]
    ds_read_b128 v[148:151], v187 offset:13312
    ds_read_b128 v[152:155], v187 offset:14336
    ds_read_b64_tr_b16 v[172:173], v185 offset:0
    v_mfma_f32_32x32x16_bf16 v[64:79], v[176:179], v[164:167], v[64:79]
    ds_read_b64_tr_b16 v[174:175], v185 offset:512
    v_mfma_f32_32x32x16_bf16 v[16:31], v[180:183], v[156:159], v[16:31]
    s_waitcnt vmcnt(24)
    ds_write_b128 v193, v[96:99] offset:2048
    ds_write_b128 v193, v[100:103] offset:3072
    v_mfma_f32_32x32x16_bf16 v[48:63], v[180:183], v[160:163], v[48:63]
    s_add_u32 s72, s74, 532480
    buffer_load_dwordx4 v[96:99], v189, s[20:23], s72 offen
    s_add_u32 s72, s74, 542720
    buffer_load_dwordx4 v[100:103], v189, s[20:23], s72 offen
    v_mfma_f32_32x32x16_bf16 v[80:95], v[180:183], v[164:167], v[80:95]
    s_waitcnt lgkmcnt(2)
    v_mfma_f32_32x32x16_bf16 v[0:15], v[168:171], v[144:147], v[0:15]
    ds_read_b64_tr_b16 v[176:177], v184 offset:2048
    ds_read_b64_tr_b16 v[178:179], v184 offset:2560
    ds_read_b128 v[156:159], v187 offset:15360
    v_mfma_f32_32x32x16_bf16 v[32:47], v[168:171], v[148:151], v[32:47]
    ds_read_b128 v[160:163], v187 offset:16384
    ds_read_b128 v[164:167], v187 offset:17408
    ds_read_b64_tr_b16 v[180:181], v185 offset:2048
    v_mfma_f32_32x32x16_bf16 v[64:79], v[168:171], v[152:155], v[64:79]
    ds_read_b64_tr_b16 v[182:183], v185 offset:2560
    v_mfma_f32_32x32x16_bf16 v[16:31], v[172:175], v[144:147], v[16:31]
    s_waitcnt vmcnt(24)
    ds_write_b128 v193, v[104:107] offset:0
    ds_write_b128 v193, v[108:111] offset:1024
    v_mfma_f32_32x32x16_bf16 v[48:63], v[172:175], v[148:151], v[48:63]
    s_add_u32 s72, s74, 552960
    buffer_load_dwordx4 v[104:107], v189, s[20:23], s72 offen
    s_add_u32 s72, s74, 563200
    buffer_load_dwordx4 v[108:111], v189, s[20:23], s72 offen
    v_mfma_f32_32x32x16_bf16 v[80:95], v[172:175], v[152:155], v[80:95]
    s_waitcnt lgkmcnt(2)
    v_mfma_f32_32x32x16_bf16 v[0:15], v[176:179], v[156:159], v[0:15]
    ds_read_b64_tr_b16 v[168:169], v184 offset:0
    ds_read_b64_tr_b16 v[170:171], v184 offset:512
    ds_read_b128 v[144:147], v187 offset:18432
    v_mfma_f32_32x32x16_bf16 v[32:47], v[176:179], v[160:163], v[32:47]
    ds_read_b128 v[148:151], v187 offset:19456
    ds_read_b128 v[152:155], v187 offset:20480
    ds_read_b64_tr_b16 v[172:173], v185 offset:0
    v_mfma_f32_32x32x16_bf16 v[64:79], v[176:179], v[164:167], v[64:79]
    ds_read_b64_tr_b16 v[174:175], v185 offset:512
    v_mfma_f32_32x32x16_bf16 v[16:31], v[180:183], v[156:159], v[16:31]
    s_waitcnt vmcnt(24)
    ds_write_b128 v193, v[112:115] offset:2048
    ds_write_b128 v193, v[116:119] offset:3072
    v_mfma_f32_32x32x16_bf16 v[48:63], v[180:183], v[160:163], v[48:63]
    s_add_u32 s72, s74, 573440
    buffer_load_dwordx4 v[112:115], v189, s[20:23], s72 offen
    s_add_u32 s72, s74, 583680
    buffer_load_dwordx4 v[116:119], v189, s[20:23], s72 offen
    v_mfma_f32_32x32x16_bf16 v[80:95], v[180:183], v[164:167], v[80:95]
    s_waitcnt lgkmcnt(2)
    v_mfma_f32_32x32x16_bf16 v[0:15], v[168:171], v[144:147], v[0:15]
    ds_read_b64_tr_b16 v[176:177], v184 offset:2048
    ds_read_b64_tr_b16 v[178:179], v184 offset:2560
    ds_read_b128 v[156:159], v187 offset:21504
    v_mfma_f32_32x32x16_bf16 v[32:47], v[168:171], v[148:151], v[32:47]
    ds_read_b128 v[160:163], v187 offset:22528
    ds_read_b128 v[164:167], v187 offset:23552
    ds_read_b64_tr_b16 v[180:181], v185 offset:2048
    v_mfma_f32_32x32x16_bf16 v[64:79], v[168:171], v[152:155], v[64:79]
    ds_read_b64_tr_b16 v[182:183], v185 offset:2560
    v_mfma_f32_32x32x16_bf16 v[16:31], v[172:175], v[144:147], v[16:31]
    s_waitcnt vmcnt(24)
    ds_write_b128 v193, v[120:123] offset:0
    ds_write_b128 v193, v[124:127] offset:1024
    v_mfma_f32_32x32x16_bf16 v[48:63], v[172:175], v[148:151], v[48:63]
    s_add_u32 s72, s74, 593920
    buffer_load_dwordx4 v[120:123], v189, s[20:23], s72 offen
    s_add_u32 s72, s74, 604160
    buffer_load_dwordx4 v[124:127], v189, s[20:23], s72 offen
    v_mfma_f32_32x32x16_bf16 v[80:95], v[172:175], v[152:155], v[80:95]
    s_waitcnt lgkmcnt(2)
    v_mfma_f32_32x32x16_bf16 v[0:15], v[176:179], v[156:159], v[0:15]
    v_add_u32 v187, 65536, v188
    ds_read_b64_tr_b16 v[168:169], v184 offset:0
    ds_read_b64_tr_b16 v[170:171], v184 offset:512
    v_mfma_f32_32x32x16_bf16 v[32:47], v[176:179], v[160:163], v[32:47]
    ds_read_b128 v[144:147], v187 offset:0
    ds_read_b128 v[148:151], v187 offset:1024
    ds_read_b128 v[152:155], v187 offset:2048
    v_mfma_f32_32x32x16_bf16 v[64:79], v[176:179], v[164:167], v[64:79]
    ds_read_b64_tr_b16 v[172:173], v185 offset:0
    ds_read_b64_tr_b16 v[174:175], v185 offset:512
    v_mfma_f32_32x32x16_bf16 v[16:31], v[180:183], v[156:159], v[16:31]
    s_waitcnt vmcnt(24)
    ds_write_b128 v193, v[128:131] offset:2048
    ds_write_b128 v193, v[132:135] offset:3072
    v_mfma_f32_32x32x16_bf16 v[48:63], v[180:183], v[160:163], v[48:63]
    s_add_u32 s72, s74, 614400
    buffer_load_dwordx4 v[128:131], v189, s[20:23], s72 offen
    s_add_u32 s72, s74, 624640
    buffer_load_dwordx4 v[132:135], v189, s[20:23], s72 offen
    v_mfma_f32_32x32x16_bf16 v[80:95], v[180:183], v[164:167], v[80:95]
    s_waitcnt lgkmcnt(2)
    v_mfma_f32_32x32x16_bf16 v[0:15], v[168:171], v[144:147], v[0:15]
    ds_read_b64_tr_b16 v[176:177], v184 offset:2048
    ds_read_b64_tr_b16 v[178:179], v184 offset:2560
    ds_read_b128 v[156:159], v187 offset:3072
    v_mfma_f32_32x32x16_bf16 v[32:47], v[168:171], v[148:151], v[32:47]
    ds_read_b128 v[160:163], v187 offset:4096
    ds_read_b128 v[164:167], v187 offset:5120
    ds_read_b64_tr_b16 v[180:181], v185 offset:2048
    v_mfma_f32_32x32x16_bf16 v[64:79], v[168:171], v[152:155], v[64:79]
    ds_read_b64_tr_b16 v[182:183], v185 offset:2560
    v_mfma_f32_32x32x16_bf16 v[16:31], v[172:175], v[144:147], v[16:31]
    s_waitcnt vmcnt(24)
    ds_write_b128 v193, v[136:139] offset:0
    ds_write_b128 v193, v[140:143] offset:1024
    v_mfma_f32_32x32x16_bf16 v[48:63], v[172:175], v[148:151], v[48:63]
    s_add_u32 s72, s74, 634880
    buffer_load_dwordx4 v[136:139], v189, s[20:23], s72 offen
    s_add_u32 s72, s74, 645120
    buffer_load_dwordx4 v[140:143], v189, s[20:23], s72 offen
    v_mfma_f32_32x32x16_bf16 v[80:95], v[172:175], v[152:155], v[80:95]
    s_waitcnt lgkmcnt(2)
    v_mfma_f32_32x32x16_bf16 v[0:15], v[176:179], v[156:159], v[0:15]
    ds_read_b64_tr_b16 v[168:169], v184 offset:0
    ds_read_b64_tr_b16 v[170:171], v184 offset:512
    ds_read_b128 v[144:147], v187 offset:6144
    v_mfma_f32_32x32x16_bf16 v[32:47], v[176:179], v[160:163], v[32:47]
    ds_read_b128 v[148:151], v187 offset:7168
    ds_read_b128 v[152:155], v187 offset:8192
    ds_read_b64_tr_b16 v[172:173], v185 offset:0
    v_mfma_f32_32x32x16_bf16 v[64:79], v[176:179], v[164:167], v[64:79]
    ds_read_b64_tr_b16 v[174:175], v185 offset:512
    v_mfma_f32_32x32x16_bf16 v[16:31], v[180:183], v[156:159], v[16:31]
    s_waitcnt vmcnt(24)
    ds_write_b128 v193, v[194:197] offset:2048
    ds_write_b128 v193, v[198:201] offset:3072
    v_mfma_f32_32x32x16_bf16 v[48:63], v[180:183], v[160:163], v[48:63]
    v_mfma_f32_32x32x16_bf16 v[80:95], v[180:183], v[164:167], v[80:95]
    s_waitcnt lgkmcnt(2)
    v_mfma_f32_32x32x16_bf16 v[0:15], v[168:171], v[144:147], v[0:15]
    ds_read_b64_tr_b16 v[176:177], v184 offset:2048
    ds_read_b64_tr_b16 v[178:179], v184 offset:2560
    ds_read_b128 v[156:159], v187 offset:9216
    v_mfma_f32_32x32x16_bf16 v[32:47], v[168:171], v[148:151], v[32:47]
    ds_read_b128 v[160:163], v187 offset:10240
    ds_read_b128 v[164:167], v187 offset:11264
    ds_read_b64_tr_b16 v[180:181], v185 offset:2048
    v_mfma_f32_32x32x16_bf16 v[64:79], v[168:171], v[152:155], v[64:79]
    ds_read_b64_tr_b16 v[182:183], v185 offset:2560
    v_mfma_f32_32x32x16_bf16 v[16:31], v[172:175], v[144:147], v[16:31]
    s_waitcnt vmcnt(22)
    ds_write_b128 v193, v[202:205] offset:0
    ds_write_b128 v193, v[206:209] offset:1024
    v_mfma_f32_32x32x16_bf16 v[48:63], v[172:175], v[148:151], v[48:63]
    v_mfma_f32_32x32x16_bf16 v[80:95], v[172:175], v[152:155], v[80:95]
    s_waitcnt lgkmcnt(2)
    v_mfma_f32_32x32x16_bf16 v[0:15], v[176:179], v[156:159], v[0:15]
    ds_read_b64_tr_b16 v[168:169], v184 offset:0
    ds_read_b64_tr_b16 v[170:171], v184 offset:512
    ds_read_b128 v[144:147], v187 offset:12288
    v_mfma_f32_32x32x16_bf16 v[32:47], v[176:179], v[160:163], v[32:47]
    ds_read_b128 v[148:151], v187 offset:13312
    ds_read_b128 v[152:155], v187 offset:14336
    ds_read_b64_tr_b16 v[172:173], v185 offset:0
    v_mfma_f32_32x32x16_bf16 v[64:79], v[176:179], v[164:167], v[64:79]
    ds_read_b64_tr_b16 v[174:175], v185 offset:512
    v_mfma_f32_32x32x16_bf16 v[16:31], v[180:183], v[156:159], v[16:31]
    s_waitcnt vmcnt(20)
    ds_write_b128 v193, v[210:213] offset:2048
    ds_write_b128 v193, v[214:217] offset:3072
    v_mfma_f32_32x32x16_bf16 v[48:63], v[180:183], v[160:163], v[48:63]
    v_mfma_f32_32x32x16_bf16 v[80:95], v[180:183], v[164:167], v[80:95]
    s_waitcnt lgkmcnt(2)
    v_mfma_f32_32x32x16_bf16 v[0:15], v[168:171], v[144:147], v[0:15]
    ds_read_b64_tr_b16 v[176:177], v184 offset:2048
    ds_read_b64_tr_b16 v[178:179], v184 offset:2560
    ds_read_b128 v[156:159], v187 offset:15360
    v_mfma_f32_32x32x16_bf16 v[32:47], v[168:171], v[148:151], v[32:47]
    ds_read_b128 v[160:163], v187 offset:16384
    ds_read_b128 v[164:167], v187 offset:17408
    ds_read_b64_tr_b16 v[180:181], v185 offset:2048
    v_mfma_f32_32x32x16_bf16 v[64:79], v[168:171], v[152:155], v[64:79]
    ds_read_b64_tr_b16 v[182:183], v185 offset:2560
    v_mfma_f32_32x32x16_bf16 v[16:31], v[172:175], v[144:147], v[16:31]
    s_waitcnt vmcnt(18)
    ds_write_b128 v193, v[218:221] offset:0
    ds_write_b128 v193, v[222:225] offset:1024
    v_mfma_f32_32x32x16_bf16 v[48:63], v[172:175], v[148:151], v[48:63]
    v_mfma_f32_32x32x16_bf16 v[80:95], v[172:175], v[152:155], v[80:95]
    s_waitcnt lgkmcnt(2)
    v_mfma_f32_32x32x16_bf16 v[0:15], v[176:179], v[156:159], v[0:15]
    ds_read_b64_tr_b16 v[168:169], v184 offset:0
    ds_read_b64_tr_b16 v[170:171], v184 offset:512
    ds_read_b128 v[144:147], v187 offset:18432
    v_mfma_f32_32x32x16_bf16 v[32:47], v[176:179], v[160:163], v[32:47]
    ds_read_b128 v[148:151], v187 offset:19456
    ds_read_b128 v[152:155], v187 offset:20480
    ds_read_b64_tr_b16 v[172:173], v185 offset:0
    v_mfma_f32_32x32x16_bf16 v[64:79], v[176:179], v[164:167], v[64:79]
    ds_read_b64_tr_b16 v[174:175], v185 offset:512
    v_mfma_f32_32x32x16_bf16 v[16:31], v[180:183], v[156:159], v[16:31]
    s_waitcnt vmcnt(16)
    ds_write_b128 v193, v[226:229] offset:2048
    ds_write_b128 v193, v[230:233] offset:3072
    v_mfma_f32_32x32x16_bf16 v[48:63], v[180:183], v[160:163], v[48:63]
    v_mfma_f32_32x32x16_bf16 v[80:95], v[180:183], v[164:167], v[80:95]
    s_waitcnt lgkmcnt(2)
    v_mfma_f32_32x32x16_bf16 v[0:15], v[168:171], v[144:147], v[0:15]
    ds_read_b64_tr_b16 v[176:177], v184 offset:2048
    ds_read_b64_tr_b16 v[178:179], v184 offset:2560
    ds_read_b128 v[156:159], v187 offset:21504
    v_mfma_f32_32x32x16_bf16 v[32:47], v[168:171], v[148:151], v[32:47]
    ds_read_b128 v[160:163], v187 offset:22528
    ds_read_b128 v[164:167], v187 offset:23552
    ds_read_b64_tr_b16 v[180:181], v185 offset:2048
    v_mfma_f32_32x32x16_bf16 v[64:79], v[168:171], v[152:155], v[64:79]
    ds_read_b64_tr_b16 v[182:183], v185 offset:2560
    v_mfma_f32_32x32x16_bf16 v[16:31], v[172:175], v[144:147], v[16:31]
    s_waitcnt vmcnt(14)
    ds_write_b128 v193, v[234:237] offset:0
    ds_write_b128 v193, v[238:241] offset:1024
    v_mfma_f32_32x32x16_bf16 v[48:63], v[172:175], v[148:151], v[48:63]
    v_mfma_f32_32x32x16_bf16 v[80:95], v[172:175], v[152:155], v[80:95]
    s_waitcnt lgkmcnt(2)
    v_mfma_f32_32x32x16_bf16 v[0:15], v[176:179], v[156:159], v[0:15]
    v_add_u32 v187, 32768, v188
    ds_read_b64_tr_b16 v[168:169], v184 offset:0
    ds_read_b64_tr_b16 v[170:171], v184 offset:512
    v_mfma_f32_32x32x16_bf16 v[32:47], v[176:179], v[160:163], v[32:47]
    ds_read_b128 v[144:147], v187 offset:0
    ds_read_b128 v[148:151], v187 offset:1024
    ds_read_b128 v[152:155], v187 offset:2048
    v_mfma_f32_32x32x16_bf16 v[64:79], v[176:179], v[164:167], v[64:79]
    ds_read_b64_tr_b16 v[172:173], v185 offset:0
    ds_read_b64_tr_b16 v[174:175], v185 offset:512
    v_mfma_f32_32x32x16_bf16 v[16:31], v[180:183], v[156:159], v[16:31]
    s_waitcnt vmcnt(12)
    ds_write_b128 v193, v[242:245] offset:2048
    ds_write_b128 v193, v[246:249] offset:3072
    v_mfma_f32_32x32x16_bf16 v[48:63], v[180:183], v[160:163], v[48:63]
    v_mfma_f32_32x32x16_bf16 v[80:95], v[180:183], v[164:167], v[80:95]
    s_waitcnt lgkmcnt(2)
    v_mfma_f32_32x32x16_bf16 v[0:15], v[168:171], v[144:147], v[0:15]
    ds_read_b64_tr_b16 v[176:177], v184 offset:2048
    ds_read_b64_tr_b16 v[178:179], v184 offset:2560
    ds_read_b128 v[156:159], v187 offset:3072
    v_mfma_f32_32x32x16_bf16 v[32:47], v[168:171], v[148:151], v[32:47]
    ds_read_b128 v[160:163], v187 offset:4096
    ds_read_b128 v[164:167], v187 offset:5120
    ds_read_b64_tr_b16 v[180:181], v185 offset:2048
    v_mfma_f32_32x32x16_bf16 v[64:79], v[168:171], v[152:155], v[64:79]
    ds_read_b64_tr_b16 v[182:183], v185 offset:2560
    v_mfma_f32_32x32x16_bf16 v[16:31], v[172:175], v[144:147], v[16:31]
    s_waitcnt vmcnt(10)
    ds_write_b128 v193, v[96:99] offset:0
    ds_write_b128 v193, v[100:103] offset:1024
    v_mfma_f32_32x32x16_bf16 v[48:63], v[172:175], v[148:151], v[48:63]
    v_mfma_f32_32x32x16_bf16 v[80:95], v[172:175], v[152:155], v[80:95]
    s_waitcnt lgkmcnt(2)
    v_mfma_f32_32x32x16_bf16 v[0:15], v[176:179], v[156:159], v[0:15]
    ds_read_b64_tr_b16 v[168:169], v184 offset:0
    ds_read_b64_tr_b16 v[170:171], v184 offset:512
    ds_read_b128 v[144:147], v187 offset:6144
    v_mfma_f32_32x32x16_bf16 v[32:47], v[176:179], v[160:163], v[32:47]
    ds_read_b128 v[148:151], v187 offset:7168
    ds_read_b128 v[152:155], v187 offset:8192
    ds_read_b64_tr_b16 v[172:173], v185 offset:0
    v_mfma_f32_32x32x16_bf16 v[64:79], v[176:179], v[164:167], v[64:79]
    ds_read_b64_tr_b16 v[174:175], v185 offset:512
    v_mfma_f32_32x32x16_bf16 v[16:31], v[180:183], v[156:159], v[16:31]
    s_waitcnt vmcnt(8)
    ds_write_b128 v193, v[104:107] offset:2048
    ds_write_b128 v193, v[108:111] offset:3072
    v_mfma_f32_32x32x16_bf16 v[48:63], v[180:183], v[160:163], v[48:63]
    v_mfma_f32_32x32x16_bf16 v[80:95], v[180:183], v[164:167], v[80:95]
    s_waitcnt lgkmcnt(2)
    v_mfma_f32_32x32x16_bf16 v[0:15], v[168:171], v[144:147], v[0:15]
    ds_read_b64_tr_b16 v[176:177], v184 offset:2048
    ds_read_b64_tr_b16 v[178:179], v184 offset:2560
    ds_read_b128 v[156:159], v187 offset:9216
    v_mfma_f32_32x32x16_bf16 v[32:47], v[168:171], v[148:151], v[32:47]
    ds_read_b128 v[160:163], v187 offset:10240
    ds_read_b128 v[164:167], v187 offset:11264
    ds_read_b64_tr_b16 v[180:181], v185 offset:2048
    v_mfma_f32_32x32x16_bf16 v[64:79], v[168:171], v[152:155], v[64:79]
    ds_read_b64_tr_b16 v[182:183], v185 offset:2560
    v_mfma_f32_32x32x16_bf16 v[16:31], v[172:175], v[144:147], v[16:31]
    s_waitcnt vmcnt(6)
    ds_write_b128 v193, v[112:115] offset:0
    ds_write_b128 v193, v[116:119] offset:1024
    v_mfma_f32_32x32x16_bf16 v[48:63], v[172:175], v[148:151], v[48:63]
    v_mfma_f32_32x32x16_bf16 v[80:95], v[172:175], v[152:155], v[80:95]
    s_waitcnt lgkmcnt(2)
    v_mfma_f32_32x32x16_bf16 v[0:15], v[176:179], v[156:159], v[0:15]
    ds_read_b64_tr_b16 v[168:169], v184 offset:0
    ds_read_b64_tr_b16 v[170:171], v184 offset:512
    ds_read_b128 v[144:147], v187 offset:12288
    v_mfma_f32_32x32x16_bf16 v[32:47], v[176:179], v[160:163], v[32:47]
    ds_read_b128 v[148:151], v187 offset:13312
    ds_read_b128 v[152:155], v187 offset:14336
    ds_read_b64_tr_b16 v[172:173], v185 offset:0
    v_mfma_f32_32x32x16_bf16 v[64:79], v[176:179], v[164:167], v[64:79]
    ds_read_b64_tr_b16 v[174:175], v185 offset:512
    v_mfma_f32_32x32x16_bf16 v[16:31], v[180:183], v[156:159], v[16:31]
    s_waitcnt vmcnt(4)
    ds_write_b128 v193, v[120:123] offset:2048
    ds_write_b128 v193, v[124:127] offset:3072
    v_mfma_f32_32x32x16_bf16 v[48:63], v[180:183], v[160:163], v[48:63]
    v_mfma_f32_32x32x16_bf16 v[80:95], v[180:183], v[164:167], v[80:95]
    s_waitcnt lgkmcnt(2)
    v_mfma_f32_32x32x16_bf16 v[0:15], v[168:171], v[144:147], v[0:15]
    ds_read_b64_tr_b16 v[176:177], v184 offset:2048
    ds_read_b64_tr_b16 v[178:179], v184 offset:2560
    ds_read_b128 v[156:159], v187 offset:15360
    v_mfma_f32_32x32x16_bf16 v[32:47], v[168:171], v[148:151], v[32:47]
    ds_read_b128 v[160:163], v187 offset:16384
    ds_read_b128 v[164:167], v187 offset:17408
    ds_read_b64_tr_b16 v[180:181], v185 offset:2048
    v_mfma_f32_32x32x16_bf16 v[64:79], v[168:171], v[152:155], v[64:79]
    ds_read_b64_tr_b16 v[182:183], v185 offset:2560
    v_mfma_f32_32x32x16_bf16 v[16:31], v[172:175], v[144:147], v[16:31]
    s_waitcnt vmcnt(2)
    ds_write_b128 v193, v[128:131] offset:0
    ds_write_b128 v193, v[132:135] offset:1024
    v_mfma_f32_32x32x16_bf16 v[48:63], v[172:175], v[148:151], v[48:63]
    v_mfma_f32_32x32x16_bf16 v[80:95], v[172:175], v[152:155], v[80:95]
    s_waitcnt lgkmcnt(2)
    v_mfma_f32_32x32x16_bf16 v[0:15], v[176:179], v[156:159], v[0:15]
    ds_read_b64_tr_b16 v[168:169], v184 offset:0
    ds_read_b64_tr_b16 v[170:171], v184 offset:512
    ds_read_b128 v[144:147], v187 offset:18432
    v_mfma_f32_32x32x16_bf16 v[32:47], v[176:179], v[160:163], v[32:47]
    ds_read_b128 v[148:151], v187 offset:19456
    ds_read_b128 v[152:155], v187 offset:20480
    ds_read_b64_tr_b16 v[172:173], v185 offset:0
    v_mfma_f32_32x32x16_bf16 v[64:79], v[176:179], v[164:167], v[64:79]
    ds_read_b64_tr_b16 v[174:175], v185 offset:512
    v_mfma_f32_32x32x16_bf16 v[16:31], v[180:183], v[156:159], v[16:31]
    s_waitcnt vmcnt(0)
    ds_write_b128 v193, v[136:139] offset:2048
    ds_write_b128 v193, v[140:143] offset:3072
    v_mfma_f32_32x32x16_bf16 v[48:63], v[180:183], v[160:163], v[48:63]
    v_mfma_f32_32x32x16_bf16 v[80:95], v[180:183], v[164:167], v[80:95]
    s_waitcnt lgkmcnt(2)
    v_mfma_f32_32x32x16_bf16 v[0:15], v[168:171], v[144:147], v[0:15]
    ds_read_b64_tr_b16 v[176:177], v184 offset:2048
    ds_read_b64_tr_b16 v[178:179], v184 offset:2560
    ds_read_b128 v[156:159], v187 offset:21504
    v_mfma_f32_32x32x16_bf16 v[32:47], v[168:171], v[148:151], v[32:47]
    ds_read_b128 v[160:163], v187 offset:22528
    ds_read_b128 v[164:167], v187 offset:23552
    ds_read_b64_tr_b16 v[180:181], v185 offset:2048
    v_mfma_f32_32x32x16_bf16 v[64:79], v[168:171], v[152:155], v[64:79]
    ds_read_b64_tr_b16 v[182:183], v185 offset:2560
    v_mfma_f32_32x32x16_bf16 v[16:31], v[172:175], v[144:147], v[16:31]
    v_mfma_f32_32x32x16_bf16 v[48:63], v[172:175], v[148:151], v[48:63]
    v_mfma_f32_32x32x16_bf16 v[80:95], v[172:175], v[152:155], v[80:95]
    s_waitcnt lgkmcnt(0)
    v_mfma_f32_32x32x16_bf16 v[0:15], v[176:179], v[156:159], v[0:15]
    v_mfma_f32_32x32x16_bf16 v[32:47], v[176:179], v[160:163], v[32:47]
    v_mfma_f32_32x32x16_bf16 v[64:79], v[176:179], v[164:167], v[64:79]
    v_mfma_f32_32x32x16_bf16 v[16:31], v[180:183], v[156:159], v[16:31]
    v_mfma_f32_32x32x16_bf16 v[48:63], v[180:183], v[160:163], v[48:63]
    v_mfma_f32_32x32x16_bf16 v[80:95], v[180:183], v[164:167], v[80:95]
    s_nop 6
    v_cvt_pk_bf16_f32 v0, v0, v1
    v_cvt_pk_bf16_f32 v1, v2, v3
    v_cvt_pk_bf16_f32 v2, v4, v5
    v_cvt_pk_bf16_f32 v3, v6, v7
    v_cvt_pk_bf16_f32 v4, v8, v9
    v_cvt_pk_bf16_f32 v5, v10, v11
    v_cvt_pk_bf16_f32 v6, v12, v13
    v_cvt_pk_bf16_f32 v7, v14, v15
    s_add_u32 s78, s69, 0
    buffer_store_dwordx4 v[0:3], v188, s[24:27], s78 offen offset:0 sc1
    buffer_store_dwordx4 v[4:7], v188, s[24:27], s78 offen offset:1024 sc1
    v_cvt_pk_bf16_f32 v32, v32, v33
    v_cvt_pk_bf16_f32 v33, v34, v35
    v_cvt_pk_bf16_f32 v34, v36, v37
    v_cvt_pk_bf16_f32 v35, v38, v39
    v_cvt_pk_bf16_f32 v36, v40, v41
    v_cvt_pk_bf16_f32 v37, v42, v43
    v_cvt_pk_bf16_f32 v38, v44, v45
    v_cvt_pk_bf16_f32 v39, v46, v47
    s_add_u32 s78, s69, 2048
    buffer_store_dwordx4 v[32:35], v188, s[24:27], s78 offen offset:0 sc1
    buffer_store_dwordx4 v[36:39], v188, s[24:27], s78 offen offset:1024 sc1
    v_cvt_pk_bf16_f32 v64, v64, v65
    v_cvt_pk_bf16_f32 v65, v66, v67
    v_cvt_pk_bf16_f32 v66, v68, v69
    v_cvt_pk_bf16_f32 v67, v70, v71
    v_cvt_pk_bf16_f32 v68, v72, v73
    v_cvt_pk_bf16_f32 v69, v74, v75
    v_cvt_pk_bf16_f32 v70, v76, v77
    v_cvt_pk_bf16_f32 v71, v78, v79
    s_add_u32 s78, s69, 4096
    buffer_store_dwordx4 v[64:67], v188, s[24:27], s78 offen offset:0 sc1
    buffer_store_dwordx4 v[68:71], v188, s[24:27], s78 offen offset:1024 sc1
    v_cvt_pk_bf16_f32 v16, v16, v17
    v_cvt_pk_bf16_f32 v17, v18, v19
    v_cvt_pk_bf16_f32 v18, v20, v21
    v_cvt_pk_bf16_f32 v19, v22, v23
    v_cvt_pk_bf16_f32 v20, v24, v25
    v_cvt_pk_bf16_f32 v21, v26, v27
    v_cvt_pk_bf16_f32 v22, v28, v29
    v_cvt_pk_bf16_f32 v23, v30, v31
    s_add_u32 s78, s69, 6144
    buffer_store_dwordx4 v[16:19], v188, s[24:27], s78 offen offset:0 sc1
    buffer_store_dwordx4 v[20:23], v188, s[24:27], s78 offen offset:1024 sc1
    v_cvt_pk_bf16_f32 v48, v48, v49
    v_cvt_pk_bf16_f32 v49, v50, v51
    v_cvt_pk_bf16_f32 v50, v52, v53
    v_cvt_pk_bf16_f32 v51, v54, v55
    v_cvt_pk_bf16_f32 v52, v56, v57
    v_cvt_pk_bf16_f32 v53, v58, v59
    v_cvt_pk_bf16_f32 v54, v60, v61
    v_cvt_pk_bf16_f32 v55, v62, v63
    s_add_u32 s78, s69, 8192
    buffer_store_dwordx4 v[48:51], v188, s[24:27], s78 offen offset:0 sc1
    buffer_store_dwordx4 v[52:55], v188, s[24:27], s78 offen offset:1024 sc1
    v_cvt_pk_bf16_f32 v80, v80, v81
    v_cvt_pk_bf16_f32 v81, v82, v83
    v_cvt_pk_bf16_f32 v82, v84, v85
    v_cvt_pk_bf16_f32 v83, v86, v87
    v_cvt_pk_bf16_f32 v84, v88, v89
    v_cvt_pk_bf16_f32 v85, v90, v91
    v_cvt_pk_bf16_f32 v86, v92, v93
    v_cvt_pk_bf16_f32 v87, v94, v95
    s_add_u32 s78, s69, 10240
    buffer_store_dwordx4 v[80:83], v188, s[24:27], s78 offen offset:0 sc1
    buffer_store_dwordx4 v[84:87], v188, s[24:27], s78 offen offset:1024 sc1
    v_lshrrev_b32 v247, 2, v188
    v_and_b32 v247, 0x7f, v247
    s_mul_i32 s73, s66, 983040
    s_lshl_b32 s72, s79, 11
    s_add_u32 s73, s73, s72
    s_mul_i32 s72, s65, 6144
    s_add_u32 s42, s73, s72
    s_lshr_b32 s78, s65, 1
    s_add_u32 s43, s42, 49152
    s_mul_i32 s72, s78, 6144
    s_add_u32 s44, s73, s72
    s_and_b32 s77, s65, 1
    s_lshl_b32 s72, s77, 10
    s_add_u32 s44, s44, s72
    s_add_u32 s44, s44, 98304
    s_lshl_b32 s45, s66, 9
    s_lshl_b32 s72, s78, 7
    s_add_u32 s45, s45, s72
    s_add_u32 s45, s45, 41943040
    s_mul_i32 s73, s62, 245760
    s_mul_i32 s72, s63, 1280
    s_add_u32 s73, s73, s72
    s_mul_i32 s72, s79, 81920
    s_add_u32 s73, s73, s72
    s_lshl_b32 s72, s65, 6
    s_add_u32 s36, s73, s72
    s_add_u32 s37, s36, 512
    s_lshl_b32 s72, s78, 6
    s_add_u32 s38, s73, s72
    s_lshl_b32 s72, s77, 5
    s_add_u32 s38, s38, s72
    s_add_u32 s38, s38, 1024
    s_mov_b32 s35, 0x40000
    v_lshrrev_b32 v230, 4, v188
    v_and_b32 v231, 31, v230
    v_lshrrev_b32 v232, 5, v230
    v_mul_u32_u24 v244, 2560, v231
    v_lshl_add_u32 v244, v232, 4, v244
    v_bfe_u32 v233, v231, 2, 1
    v_xor_b32 v233, v233, v232
    v_lshrrev_b32 v234, 4, v231
    v_or_b32 v233, v233, v234
    v_lshlrev_b32 v233, 3, v233
    v_bfe_u32 v234, v231, 3, 1
    v_bfe_u32 v230, v231, 1, 1
    v_lshl_or_b32 v234, v234, 1, v230
    v_or_b32 v233, v233, v234
    v_and_b32 v234, 1, v231
    v_lshlrev_b32 v234, 4, v234
    v_mov_b32 v230, 0x3f80
    v_lshlrev_b32 v234, v234, v230
    v_cmp_eq_u32 vcc, 0, v233
    s_nop 1
    v_cndmask_b32 v240, 0, v234, vcc
    v_cmp_eq_u32 vcc, 1, v233
    s_nop 1
    v_cndmask_b32 v241, 0, v234, vcc
    v_cmp_eq_u32 vcc, 2, v233
    s_nop 1
    v_cndmask_b32 v242, 0, v234, vcc
    v_cmp_eq_u32 vcc, 3, v233
    s_nop 1
    v_cndmask_b32 v243, 0, v234, vcc
    s_waitcnt vmcnt(0)
    s_mov_b64 exec, 1
    buffer_store_dword v191, v192, s[24:27], s70 offen sc1
    s_mov_b64 exec, -1
    s_cmp_eq_u32 s3, 3
    s_cbranch_scc1 L_end
L_red_p1:
    buffer_load_dword v246, v247, s[24:27], s45 offen sc1
    s_sub_u32 s35, s35, 1
    s_waitcnt vmcnt(0)
    v_cmp_eq_u32 vcc, 1, v246
    s_cmp_gt_i32 s35, 0
    s_cselect_b32 s78, 0, -1
    s_or_b32 s72, vcc_lo, s78
    s_bfe_u32 s72, s72, 0x80008
    s_cmp_lg_u32 s72, 0xff
    s_cbranch_scc1 L_red_p1
L_red_i1:
    s_add_u32 s72, s43, 0
    buffer_load_dwordx4 v[0:3], v188, s[24:27], s72 offen offset:0 sc1
    buffer_load_dwordx4 v[4:7], v188, s[24:27], s72 offen offset:1024 sc1
    s_add_u32 s72, s43, 122880
    buffer_load_dwordx4 v[8:11], v188, s[24:27], s72 offen offset:0 sc1
    buffer_load_dwordx4 v[12:15], v188, s[24:27], s72 offen offset:1024 sc1
    s_add_u32 s72, s43, 245760
    buffer_load_dwordx4 v[16:19], v188, s[24:27], s72 offen offset:0 sc1
    buffer_load_dwordx4 v[20:23], v188, s[24:27], s72 offen offset:1024 sc1
    s_add_u32 s72, s43, 368640
    buffer_load_dwordx4 v[24:27], v188, s[24:27], s72 offen offset:0 sc1
    buffer_load_dwordx4 v[28:31], v188, s[24:27], s72 offen offset:1024 sc1
    s_add_u32 s72, s43, 491520
    buffer_load_dwordx4 v[32:35], v188, s[24:27], s72 offen offset:0 sc1
    buffer_load_dwordx4 v[36:39], v188, s[24:27], s72 offen offset:1024 sc1
    s_add_u32 s72, s43, 614400
    buffer_load_dwordx4 v[40:43], v188, s[24:27], s72 offen offset:0 sc1
    buffer_load_dwordx4 v[44:47], v188, s[24:27], s72 offen offset:1024 sc1
    s_add_u32 s72, s43, 737280
    buffer_load_dwordx4 v[48:51], v188, s[24:27], s72 offen offset:0 sc1
    buffer_load_dwordx4 v[52:55], v188, s[24:27], s72 offen offset:1024 sc1
    s_add_u32 s72, s43, 860160
    buffer_load_dwordx4 v[56:59], v188, s[24:27], s72 offen offset:0 sc1
    buffer_load_dwordx4 v[60:63], v188, s[24:27], s72 offen offset:1024 sc1
L_red_p2:
    buffer_load_dword v246, v247, s[24:27], s45 offen sc1
    s_sub_u32 s35, s35, 1
    s_waitcnt vmcnt(0)
    v_cmp_eq_u32 vcc, 1, v246
    s_cmp_gt_i32 s35, 0
    s_cselect_b32 s78, 0, -1
    s_or_b32 s72, vcc_lo, s78
    s_bfe_u32 s72, s72, 0x80010
    s_cmp_lg_u32 s72, 0xff
    s_cbranch_scc1 L_red_p2
L_red_i2:
    s_add_u32 s72, s44, 0
    buffer_load_dwordx4 v[64:67], v188, s[24:27], s72 offen offset:0 sc1
    s_add_u32 s72, s44, 122880
    buffer_load_dwordx4 v[68:71], v188, s[24:27], s72 offen offset:0 sc1
    s_add_u32 s72, s44, 245760
    buffer_load_dwordx4 v[72:75], v188, s[24:27], s72 offen offset:0 sc1
    s_add_u32 s72, s44, 368640
    buffer_load_dwordx4 v[76:79], v188, s[24:27], s72 offen offset:0 sc1
    s_add_u32 s72, s44, 491520
    buffer_load_dwordx4 v[80:83], v188, s[24:27], s72 offen offset:0 sc1
    s_add_u32 s72, s44, 614400
    buffer_load_dwordx4 v[84:87], v188, s[24:27], s72 offen offset:0 sc1
    s_add_u32 s72, s44, 737280
    buffer_load_dwordx4 v[88:91], v188, s[24:27], s72 offen offset:0 sc1
    s_add_u32 s72, s44, 860160
    buffer_load_dwordx4 v[92:95], v188, s[24:27], s72 offen offset:0 sc1
    v_mfma_f32_32x32x16_bf16 v[96:111], v[240:243], v[0:3], 0
    v_mfma_f32_32x32x16_bf16 v[112:127], v[240:243], v[4:7], 0
    v_mfma_f32_32x32x16_bf16 v[96:111], v[240:243], v[8:11], v[96:111]
    v_mfma_f32_32x32x16_bf16 v[112:127], v[240:243], v[12:15], v[112:127]
    v_mfma_f32_32x32x16_bf16 v[96:111], v[240:243], v[16:19], v[96:111]
    v_mfma_f32_32x32x16_bf16 v[112:127], v[240:243], v[20:23], v[112:127]
    v_mfma_f32_32x32x16_bf16 v[96:111], v[240:243], v[24:27], v[96:111]
    v_mfma_f32_32x32x16_bf16 v[112:127], v[240:243], v[28:31], v[112:127]
    v_mfma_f32_32x32x16_bf16 v[96:111], v[240:243], v[32:35], v[96:111]
    v_mfma_f32_32x32x16_bf16 v[112:127], v[240:243], v[36:39], v[112:127]
    v_mfma_f32_32x32x16_bf16 v[96:111], v[240:243], v[40:43], v[96:111]
    v_mfma_f32_32x32x16_bf16 v[112:127], v[240:243], v[44:47], v[112:127]
    v_mfma_f32_32x32x16_bf16 v[96:111], v[240:243], v[48:51], v[96:111]
    v_mfma_f32_32x32x16_bf16 v[112:127], v[240:243], v[52:55], v[112:127]
    v_mfma_f32_32x32x16_bf16 v[96:111], v[240:243], v[56:59], v[96:111]
    v_mfma_f32_32x32x16_bf16 v[112:127], v[240:243], v[60:63], v[112:127]
    s_nop 10
    v_cvt_pk_bf16_f32 v96, v96, v97
    v_cvt_pk_bf16_f32 v97, v98, v99
    v_cvt_pk_bf16_f32 v98, v100, v101
    v_cvt_pk_bf16_f32 v99, v102, v103
    buffer_store_dwordx4 v[96:99], v244, s[28:31], s37 offen offset:0
    v_cvt_pk_bf16_f32 v112, v112, v113
    v_cvt_pk_bf16_f32 v113, v114, v115
    v_cvt_pk_bf16_f32 v114, v116, v117
    v_cvt_pk_bf16_f32 v115, v118, v119
    buffer_store_dwordx4 v[112:115], v244, s[28:31], s37 offen offset:32
    s_waitcnt vmcnt(2)
    v_mfma_f32_32x32x16_bf16 v[128:143], v[240:243], v[64:67], 0
    v_mfma_f32_32x32x16_bf16 v[128:143], v[240:243], v[68:71], v[128:143]
    v_mfma_f32_32x32x16_bf16 v[128:143], v[240:243], v[72:75], v[128:143]
    v_mfma_f32_32x32x16_bf16 v[128:143], v[240:243], v[76:79], v[128:143]
    v_mfma_f32_32x32x16_bf16 v[128:143], v[240:243], v[80:83], v[128:143]
    v_mfma_f32_32x32x16_bf16 v[128:143], v[240:243], v[84:87], v[128:143]
    v_mfma_f32_32x32x16_bf16 v[128:143], v[240:243], v[88:91], v[128:143]
    v_mfma_f32_32x32x16_bf16 v[128:143], v[240:243], v[92:95], v[128:143]
    s_nop 11
    v_cvt_pk_bf16_f32 v128, v128, v129
    v_cvt_pk_bf16_f32 v129, v130, v131
    v_cvt_pk_bf16_f32 v130, v132, v133
    v_cvt_pk_bf16_f32 v131, v134, v135
    buffer_store_dwordx4 v[128:131], v244, s[28:31], s38 offen offset:0
L_fin:
L_end:
    s_endpgm
L_slow_a0:
    s_nop 15
    v_mov_b32 v235, v234
    s_nop 1
    v_permlane32_swap_b32 v234, v235
    v_max3_f32 v234, v234, v235, 0
    v_exp_f32 v235, -v234
    v_sub_f32 v112, v112, v234
    v_sub_f32 v192, v192, v234
    v_sub_f32 v113, v113, v234
    v_sub_f32 v193, v193, v234
    v_sub_f32 v114, v114, v234
    v_sub_f32 v194, v194, v234
    v_sub_f32 v115, v115, v234
    v_sub_f32 v195, v195, v234
    v_sub_f32 v116, v116, v234
    v_sub_f32 v196, v196, v234
    v_sub_f32 v117, v117, v234
    v_sub_f32 v197, v197, v234
    v_sub_f32 v118, v118, v234
    v_sub_f32 v198, v198, v234
    v_sub_f32 v119, v119, v234
    v_sub_f32 v199, v199, v234
    v_sub_f32 v120, v120, v234
    v_sub_f32 v200, v200, v234
    v_sub_f32 v121, v121, v234
    v_sub_f32 v201, v201, v234
    v_sub_f32 v122, v122, v234
    v_sub_f32 v202, v202, v234
    v_sub_f32 v123, v123, v234
    v_sub_f32 v203, v203, v234
    v_sub_f32 v124, v124, v234
    v_sub_f32 v204, v204, v234
    v_sub_f32 v125, v125, v234
    v_sub_f32 v205, v205, v234
    v_sub_f32 v126, v126, v234
    v_sub_f32 v206, v206, v234
    v_sub_f32 v127, v127, v234
    v_sub_f32 v207, v207, v234
    v_mul_f32 v0, v235, v0
    v_mul_f32 v1, v235, v1
    v_mul_f32 v2, v235, v2
    v_mul_f32 v3, v235, v3
    v_mul_f32 v4, v235, v4
    v_mul_f32 v5, v235, v5
    v_mul_f32 v6, v235, v6
    v_mul_f32 v7, v235, v7
    v_mul_f32 v8, v235, v8
    v_mul_f32 v9, v235, v9
    v_mul_f32 v10, v235, v10
    v_mul_f32 v11, v235, v11
    v_mul_f32 v12, v235, v12
    v_mul_f32 v13, v235, v13
    v_mul_f32 v14, v235, v14
    v_mul_f32 v15, v235, v15
    v_mul_f32 v16, v235, v16
    v_mul_f32 v17, v235, v17
    v_mul_f32 v18, v235, v18
    v_mul_f32 v19, v235, v19
    v_mul_f32 v20, v235, v20
    v_mul_f32 v21, v235, v21
    v_mul_f32 v22, v235, v22
    v_mul_f32 v23, v235, v23
    v_mul_f32 v24, v235, v24
    v_mul_f32 v25, v235, v25
    v_mul_f32 v26, v235, v26
    v_mul_f32 v27, v235, v27
    v_mul_f32 v28, v235, v28
    v_mul_f32 v29, v235, v29
    v_mul_f32 v30, v235, v30
    v_mul_f32 v31, v235, v31
    v_mul_f32 v32, v235, v32
    v_mul_f32 v33, v235, v33
    v_mul_f32 v34, v235, v34
    v_mul_f32 v35, v235, v35
    v_mul_f32 v36, v235, v36
    v_mul_f32 v37, v235, v37
    v_mul_f32 v38, v235, v38
    v_mul_f32 v39, v235, v39
    v_mul_f32 v40, v235, v40
    v_mul_f32 v41, v235, v41
    v_mul_f32 v42, v235, v42
    v_mul_f32 v43, v235, v43
    v_mul_f32 v44, v235, v44
    v_mul_f32 v45, v235, v45
    v_mul_f32 v46, v235, v46
    v_mul_f32 v47, v235, v47
    v_mul_f32 v48, v235, v48
    v_mul_f32 v49, v235, v49
    v_mul_f32 v50, v235, v50
    v_mul_f32 v51, v235, v51
    v_mul_f32 v52, v235, v52
    v_mul_f32 v53, v235, v53
    v_mul_f32 v54, v235, v54
    v_mul_f32 v55, v235, v55
    v_mul_f32 v56, v235, v56
    v_mul_f32 v57, v235, v57
    v_mul_f32 v58, v235, v58
    v_mul_f32 v59, v235, v59
    v_mul_f32 v60, v235, v60
    v_mul_f32 v61, v235, v61
    v_mul_f32 v62, v235, v62
    v_mul_f32 v63, v235, v63
    v_mul_f32 v232, v235, v232
    v_mul_f32 v233, v235, v233
    s_nop 1
    s_branch L_back_a0
L_slow_ao1:
    s_nop 15
    v_mov_b32 v235, v234
    s_nop 1
    v_permlane32_swap_b32 v234, v235
    v_max3_f32 v234, v234, v235, 0
    v_exp_f32 v235, -v234
    v_sub_f32 v96, v96, v234
    v_sub_f32 v192, v192, v234
    v_sub_f32 v97, v97, v234
    v_sub_f32 v193, v193, v234
    v_sub_f32 v98, v98, v234
    v_sub_f32 v194, v194, v234
    v_sub_f32 v99, v99, v234
    v_sub_f32 v195, v195, v234
    v_sub_f32 v100, v100, v234
    v_sub_f32 v196, v196, v234
    v_sub_f32 v101, v101, v234
    v_sub_f32 v197, v197, v234
    v_sub_f32 v102, v102, v234
    v_sub_f32 v198, v198, v234
    v_sub_f32 v103, v103, v234
    v_sub_f32 v199, v199, v234
    v_sub_f32 v104, v104, v234
    v_sub_f32 v200, v200, v234
    v_sub_f32 v105, v105, v234
    v_sub_f32 v201, v201, v234
    v_sub_f32 v106, v106, v234
    v_sub_f32 v202, v202, v234
    v_sub_f32 v107, v107, v234
    v_sub_f32 v203, v203, v234
    v_sub_f32 v108, v108, v234
    v_sub_f32 v204, v204, v234
    v_sub_f32 v109, v109, v234
    v_sub_f32 v205, v205, v234
    v_sub_f32 v110, v110, v234
    v_sub_f32 v206, v206, v234
    v_sub_f32 v111, v111, v234
    v_sub_f32 v207, v207, v234
    v_mul_f32 v0, v235, v0
    v_mul_f32 v1, v235, v1
    v_mul_f32 v2, v235, v2
    v_mul_f32 v3, v235, v3
    v_mul_f32 v4, v235, v4
    v_mul_f32 v5, v235, v5
    v_mul_f32 v6, v235, v6
    v_mul_f32 v7, v235, v7
    v_mul_f32 v8, v235, v8
    v_mul_f32 v9, v235, v9
    v_mul_f32 v10, v235, v10
    v_mul_f32 v11, v235, v11
    v_mul_f32 v12, v235, v12
    v_mul_f32 v13, v235, v13
    v_mul_f32 v14, v235, v14
    v_mul_f32 v15, v235, v15
    v_mul_f32 v16, v235, v16
    v_mul_f32 v17, v235, v17
    v_mul_f32 v18, v235, v18
    v_mul_f32 v19, v235, v19
    v_mul_f32 v20, v235, v20
    v_mul_f32 v21, v235, v21
    v_mul_f32 v22, v235, v22
    v_mul_f32 v23, v235, v23
    v_mul_f32 v24, v235, v24
    v_mul_f32 v25, v235, v25
    v_mul_f32 v26, v235, v26
    v_mul_f32 v27, v235, v27
    v_mul_f32 v28, v235, v28
    v_mul_f32 v29, v235, v29
    v_mul_f32 v30, v235, v30
    v_mul_f32 v31, v235, v31
    v_mul_f32 v32, v235, v32
    v_mul_f32 v33, v235, v33
    v_mul_f32 v34, v235, v34
    v_mul_f32 v35, v235, v35
    v_mul_f32 v36, v235, v36
    v_mul_f32 v37, v235, v37
    v_mul_f32 v38, v235, v38
    v_mul_f32 v39, v235, v39
    v_mul_f32 v40, v235, v40
    v_mul_f32 v41, v235, v41
    v_mul_f32 v42, v235, v42
    v_mul_f32 v43, v235, v43
    v_mul_f32 v44, v235, v44
    v_mul_f32 v45, v235, v45
    v_mul_f32 v46, v235, v46
    v_mul_f32 v47, v235, v47
    v_mul_f32 v48, v235, v48
    v_mul_f32 v49, v235, v49
    v_mul_f32 v50, v235, v50
    v_mul_f32 v51, v235, v51
    v_mul_f32 v52, v235, v52
    v_mul_f32 v53, v235, v53
    v_mul_f32 v54, v235, v54
    v_mul_f32 v55, v235, v55
    v_mul_f32 v56, v235, v56
    v_mul_f32 v57, v235, v57
    v_mul_f32 v58, v235, v58
    v_mul_f32 v59, v235, v59
    v_mul_f32 v60, v235, v60
    v_mul_f32 v61, v235, v61
    v_mul_f32 v62, v235, v62
    v_mul_f32 v63, v235, v63
    v_mul_f32 v232, v235, v232
    v_mul_f32 v233, v235, v233
    s_nop 1
    s_branch L_back_ao1
L_slow_ao2:
    s_nop 15
    v_mov_b32 v235, v234
    s_nop 1
    v_permlane32_swap_b32 v234, v235
    v_max3_f32 v234, v234, v235, 0
    v_exp_f32 v235, -v234
    v_sub_f32 v112, v112, v234
    v_sub_f32 v192, v192, v234
    v_sub_f32 v113, v113, v234
    v_sub_f32 v193, v193, v234
    v_sub_f32 v114, v114, v234
    v_sub_f32 v194, v194, v234
    v_sub_f32 v115, v115, v234
    v_sub_f32 v195, v195, v234
    v_sub_f32 v116, v116, v234
    v_sub_f32 v196, v196, v234
    v_sub_f32 v117, v117, v234
    v_sub_f32 v197, v197, v234
    v_sub_f32 v118, v118, v234
    v_sub_f32 v198, v198, v234
    v_sub_f32 v119, v119, v234
    v_sub_f32 v199, v199, v234
    v_sub_f32 v120, v120, v234
    v_sub_f32 v200, v200, v234
    v_sub_f32 v121, v121, v234
    v_sub_f32 v201, v201, v234
    v_sub_f32 v122, v122, v234
    v_sub_f32 v202, v202, v234
    v_sub_f32 v123, v123, v234
    v_sub_f32 v203, v203, v234
    v_sub_f32 v124, v124, v234
    v_sub_f32 v204, v204, v234
    v_sub_f32 v125, v125, v234
    v_sub_f32 v205, v205, v234
    v_sub_f32 v126, v126, v234
    v_sub_f32 v206, v206, v234
    v_sub_f32 v127, v127, v234
    v_sub_f32 v207, v207, v234
    v_mul_f32 v0, v235, v0
    v_mul_f32 v1, v235, v1
    v_mul_f32 v2, v235, v2
    v_mul_f32 v3, v235, v3
    v_mul_f32 v4, v235, v4
    v_mul_f32 v5, v235, v5
    v_mul_f32 v6, v235, v6
    v_mul_f32 v7, v235, v7
    v_mul_f32 v8, v235, v8
    v_mul_f32 v9, v235, v9
    v_mul_f32 v10, v235, v10
    v_mul_f32 v11, v235, v11
    v_mul_f32 v12, v235, v12
    v_mul_f32 v13, v235, v13
    v_mul_f32 v14, v235, v14
    v_mul_f32 v15, v235, v15
    v_mul_f32 v16, v235, v16
    v_mul_f32 v17, v235, v17
    v_mul_f32 v18, v235, v18
    v_mul_f32 v19, v235, v19
    v_mul_f32 v20, v235, v20
    v_mul_f32 v21, v235, v21
    v_mul_f32 v22, v235, v22
    v_mul_f32 v23, v235, v23
    v_mul_f32 v24, v235, v24
    v_mul_f32 v25, v235, v25
    v_mul_f32 v26, v235, v26
    v_mul_f32 v27, v235, v27
    v_mul_f32 v28, v235, v28
    v_mul_f32 v29, v235, v29
    v_mul_f32 v30, v235, v30
    v_mul_f32 v31, v235, v31
    v_mul_f32 v32, v235, v32
    v_mul_f32 v33, v235, v33
    v_mul_f32 v34, v235, v34
    v_mul_f32 v35, v235, v35
    v_mul_f32 v36, v235, v36
    v_mul_f32 v37, v235, v37
    v_mul_f32 v38, v235, v38
    v_mul_f32 v39, v235, v39
    v_mul_f32 v40, v235, v40
    v_mul_f32 v41, v235, v41
    v_mul_f32 v42, v235, v42
    v_mul_f32 v43, v235, v43
    v_mul_f32 v44, v235, v44
    v_mul_f32 v45, v235, v45
    v_mul_f32 v46, v235, v46
    v_mul_f32 v47, v235, v47
    v_mul_f32 v48, v235, v48
    v_mul_f32 v49, v235, v49
    v_mul_f32 v50, v235, v50
    v_mul_f32 v51, v235, v51
    v_mul_f32 v52, v235, v52
    v_mul_f32 v53, v235, v53
    v_mul_f32 v54, v235, v54
    v_mul_f32 v55, v235, v55
    v_mul_f32 v56, v235, v56
    v_mul_f32 v57, v235, v57
    v_mul_f32 v58, v235, v58
    v_mul_f32 v59, v235, v59
    v_mul_f32 v60, v235, v60
    v_mul_f32 v61, v235, v61
    v_mul_f32 v62, v235, v62
    v_mul_f32 v63, v235, v63
    v_mul_f32 v232, v235, v232
    v_mul_f32 v233, v235, v233
    s_nop 1
    s_branch L_back_ao2
L_slow_ae1:
    s_nop 15
    v_mov_b32 v235, v234
    s_nop 1
    v_permlane32_swap_b32 v234, v235
    v_max3_f32 v234, v234, v235, 0
    v_exp_f32 v235, -v234
    v_sub_f32 v96, v96, v234
    v_sub_f32 v192, v192, v234
    v_sub_f32 v97, v97, v234
    v_sub_f32 v193, v193, v234
    v_sub_f32 v98, v98, v234
    v_sub_f32 v194, v194, v234
    v_sub_f32 v99, v99, v234
    v_sub_f32 v195, v195, v234
    v_sub_f32 v100, v100, v234
    v_sub_f32 v196, v196, v234
    v_sub_f32 v101, v101, v234
    v_sub_f32 v197, v197, v234
    v_sub_f32 v102, v102, v234
    v_sub_f32 v198, v198, v234
    v_sub_f32 v103, v103, v234
    v_sub_f32 v199, v199, v234
    v_sub_f32 v104, v104, v234
    v_sub_f32 v200, v200, v234
    v_sub_f32 v105, v105, v234
    v_sub_f32 v201, v201, v234
    v_sub_f32 v106, v106, v234
    v_sub_f32 v202, v202, v234
    v_sub_f32 v107, v107, v234
    v_sub_f32 v203, v203, v234
    v_sub_f32 v108, v108, v234
    v_sub_f32 v204, v204, v234
    v_sub_f32 v109, v109, v234
    v_sub_f32 v205, v205, v234
    v_sub_f32 v110, v110, v234
    v_sub_f32 v206, v206, v234
    v_sub_f32 v111, v111, v234
    v_sub_f32 v207, v207, v234
    v_mul_f32 v0, v235, v0
    v_mul_f32 v1, v235, v1
    v_mul_f32 v2, v235, v2
    v_mul_f32 v3, v235, v3
    v_mul_f32 v4, v235, v4
    v_mul_f32 v5, v235, v5
    v_mul_f32 v6, v235, v6
    v_mul_f32 v7, v235, v7
    v_mul_f32 v8, v235, v8
    v_mul_f32 v9, v235, v9
    v_mul_f32 v10, v235, v10
    v_mul_f32 v11, v235, v11
    v_mul_f32 v12, v235, v12
    v_mul_f32 v13, v235, v13
    v_mul_f32 v14, v235, v14
    v_mul_f32 v15, v235, v15
    v_mul_f32 v16, v235, v16
    v_mul_f32 v17, v235, v17
    v_mul_f32 v18, v235, v18
    v_mul_f32 v19, v235, v19
    v_mul_f32 v20, v235, v20
    v_mul_f32 v21, v235, v21
    v_mul_f32 v22, v235, v22
    v_mul_f32 v23, v235, v23
    v_mul_f32 v24, v235, v24
    v_mul_f32 v25, v235, v25
    v_mul_f32 v26, v235, v26
    v_mul_f32 v27, v235, v27
    v_mul_f32 v28, v235, v28
    v_mul_f32 v29, v235, v29
    v_mul_f32 v30, v235, v30
    v_mul_f32 v31, v235, v31
    v_mul_f32 v32, v235, v32
    v_mul_f32 v33, v235, v33
    v_mul_f32 v34, v235, v34
    v_mul_f32 v35, v235, v35
    v_mul_f32 v36, v235, v36
    v_mul_f32 v37, v235, v37
    v_mul_f32 v38, v235, v38
    v_mul_f32 v39, v235, v39
    v_mul_f32 v40, v235, v40
    v_mul_f32 v41, v235, v41
    v_mul_f32 v42, v235, v42
    v_mul_f32 v43, v235, v43
    v_mul_f32 v44, v235, v44
    v_mul_f32 v45, v235, v45
    v_mul_f32 v46, v235, v46
    v_mul_f32 v47, v235, v47
    v_mul_f32 v48, v235, v48
    v_mul_f32 v49, v235, v49
    v_mul_f32 v50, v235, v50
    v_mul_f32 v51, v235, v51
    v_mul_f32 v52, v235, v52
    v_mul_f32 v53, v235, v53
    v_mul_f32 v54, v235, v54
    v_mul_f32 v55, v235, v55
    v_mul_f32 v56, v235, v56
    v_mul_f32 v57, v235, v57
    v_mul_f32 v58, v235, v58
    v_mul_f32 v59, v235, v59
    v_mul_f32 v60, v235, v60
    v_mul_f32 v61, v235, v61
    v_mul_f32 v62, v235, v62
    v_mul_f32 v63, v235, v63
    v_mul_f32 v232, v235, v232
    v_mul_f32 v233, v235, v233
    s_nop 1
    s_branch L_back_ae1
L_slow_ae2:
    s_nop 15
    v_mov_b32 v235, v234
    s_nop 1
    v_permlane32_swap_b32 v234, v235
    v_max3_f32 v234, v234, v235, 0
    v_exp_f32 v235, -v234
    v_sub_f32 v112, v112, v234
    v_sub_f32 v192, v192, v234
    v_sub_f32 v113, v113, v234
    v_sub_f32 v193, v193, v234
    v_sub_f32 v114, v114, v234
    v_sub_f32 v194, v194, v234
    v_sub_f32 v115, v115, v234
    v_sub_f32 v195, v195, v234
    v_sub_f32 v116, v116, v234
    v_sub_f32 v196, v196, v234
    v_sub_f32 v117, v117, v234
    v_sub_f32 v197, v197, v234
    v_sub_f32 v118, v118, v234
    v_sub_f32 v198, v198, v234
    v_sub_f32 v119, v119, v234
    v_sub_f32 v199, v199, v234
    v_sub_f32 v120, v120, v234
    v_sub_f32 v200, v200, v234
    v_sub_f32 v121, v121, v234
    v_sub_f32 v201, v201, v234
    v_sub_f32 v122, v122, v234
    v_sub_f32 v202, v202, v234
    v_sub_f32 v123, v123, v234
    v_sub_f32 v203, v203, v234
    v_sub_f32 v124, v124, v234
    v_sub_f32 v204, v204, v234
    v_sub_f32 v125, v125, v234
    v_sub_f32 v205, v205, v234
    v_sub_f32 v126, v126, v234
    v_sub_f32 v206, v206, v234
    v_sub_f32 v127, v127, v234
    v_sub_f32 v207, v207, v234
    v_mul_f32 v0, v235, v0
    v_mul_f32 v1, v235, v1
    v_mul_f32 v2, v235, v2
    v_mul_f32 v3, v235, v3
    v_mul_f32 v4, v235, v4
    v_mul_f32 v5, v235, v5
    v_mul_f32 v6, v235, v6
    v_mul_f32 v7, v235, v7
    v_mul_f32 v8, v235, v8
    v_mul_f32 v9, v235, v9
    v_mul_f32 v10, v235, v10
    v_mul_f32 v11, v235, v11
    v_mul_f32 v12, v235, v12
    v_mul_f32 v13, v235, v13
    v_mul_f32 v14, v235, v14
    v_mul_f32 v15, v235, v15
    v_mul_f32 v16, v235, v16
    v_mul_f32 v17, v235, v17
    v_mul_f32 v18, v235, v18
    v_mul_f32 v19, v235, v19
    v_mul_f32 v20, v235, v20
    v_mul_f32 v21, v235, v21
    v_mul_f32 v22, v235, v22
    v_mul_f32 v23, v235, v23
    v_mul_f32 v24, v235, v24
    v_mul_f32 v25, v235, v25
    v_mul_f32 v26, v235, v26
    v_mul_f32 v27, v235, v27
    v_mul_f32 v28, v235, v28
    v_mul_f32 v29, v235, v29
    v_mul_f32 v30, v235, v30
    v_mul_f32 v31, v235, v31
    v_mul_f32 v32, v235, v32
    v_mul_f32 v33, v235, v33
    v_mul_f32 v34, v235, v34
    v_mul_f32 v35, v235, v35
    v_mul_f32 v36, v235, v36
    v_mul_f32 v37, v235, v37
    v_mul_f32 v38, v235, v38
    v_mul_f32 v39, v235, v39
    v_mul_f32 v40, v235, v40
    v_mul_f32 v41, v235, v41
    v_mul_f32 v42, v235, v42
    v_mul_f32 v43, v235, v43
    v_mul_f32 v44, v235, v44
    v_mul_f32 v45, v235, v45
    v_mul_f32 v46, v235, v46
    v_mul_f32 v47, v235, v47
    v_mul_f32 v48, v235, v48
    v_mul_f32 v49, v235, v49
    v_mul_f32 v50, v235, v50
    v_mul_f32 v51, v235, v51
    v_mul_f32 v52, v235, v52
    v_mul_f32 v53, v235, v53
    v_mul_f32 v54, v235, v54
    v_mul_f32 v55, v235, v55
    v_mul_f32 v56, v235, v56
    v_mul_f32 v57, v235, v57
    v_mul_f32 v58, v235, v58
    v_mul_f32 v59, v235, v59
    v_mul_f32 v60, v235, v60
    v_mul_f32 v61, v235, v61
    v_mul_f32 v62, v235, v62
    v_mul_f32 v63, v235, v63
    v_mul_f32 v232, v235, v232
    v_mul_f32 v233, v235, v233
    s_nop 1
    s_branch L_back_ae2
L_slow_ab:
    s_nop 15
    v_mov_b32 v235, v234
    s_nop 1
    v_permlane32_swap_b32 v234, v235
    v_max3_f32 v234, v234, v235, 0
    v_exp_f32 v235, -v234
    v_sub_f32 v112, v112, v234
    v_sub_f32 v192, v192, v234
    v_sub_f32 v113, v113, v234
    v_sub_f32 v193, v193, v234
    v_sub_f32 v114, v114, v234
    v_sub_f32 v194, v194, v234
    v_sub_f32 v115, v115, v234
    v_sub_f32 v195, v195, v234
    v_sub_f32 v116, v116, v234
    v_sub_f32 v196, v196, v234
    v_sub_f32 v117, v117, v234
    v_sub_f32 v197, v197, v234
    v_sub_f32 v118, v118, v234
    v_sub_f32 v198, v198, v234
    v_sub_f32 v119, v119, v234
    v_sub_f32 v199, v199, v234
    v_sub_f32 v120, v120, v234
    v_sub_f32 v200, v200, v234
    v_sub_f32 v121, v121, v234
    v_sub_f32 v201, v201, v234
    v_sub_f32 v122, v122, v234
    v_sub_f32 v202, v202, v234
    v_sub_f32 v123, v123, v234
    v_sub_f32 v203, v203, v234
    v_sub_f32 v124, v124, v234
    v_sub_f32 v204, v204, v234
    v_sub_f32 v125, v125, v234
    v_sub_f32 v205, v205, v234
    v_sub_f32 v126, v126, v234
    v_sub_f32 v206, v206, v234
    v_sub_f32 v127, v127, v234
    v_sub_f32 v207, v207, v234
    v_mul_f32 v0, v235, v0
    v_mul_f32 v1, v235, v1
    v_mul_f32 v2, v235, v2
    v_mul_f32 v3, v235, v3
    v_mul_f32 v4, v235, v4
    v_mul_f32 v5, v235, v5
    v_mul_f32 v6, v235, v6
    v_mul_f32 v7, v235, v7
    v_mul_f32 v8, v235, v8
    v_mul_f32 v9, v235, v9
    v_mul_f32 v10, v235, v10
    v_mul_f32 v11, v235, v11
    v_mul_f32 v12, v235, v12
    v_mul_f32 v13, v235, v13
    v_mul_f32 v14, v235, v14
    v_mul_f32 v15, v235, v15
    v_mul_f32 v16, v235, v16
    v_mul_f32 v17, v235, v17
    v_mul_f32 v18, v235, v18
    v_mul_f32 v19, v235, v19
    v_mul_f32 v20, v235, v20
    v_mul_f32 v21, v235, v21
    v_mul_f32 v22, v235, v22
    v_mul_f32 v23, v235, v23
    v_mul_f32 v24, v235, v24
    v_mul_f32 v25, v235, v25
    v_mul_f32 v26, v235, v26
    v_mul_f32 v27, v235, v27
    v_mul_f32 v28, v235, v28
    v_mul_f32 v29, v235, v29
    v_mul_f32 v30, v235, v30
    v_mul_f32 v31, v235, v31
    v_mul_f32 v32, v235, v32
    v_mul_f32 v33, v235, v33
    v_mul_f32 v34, v235, v34
    v_mul_f32 v35, v235, v35
    v_mul_f32 v36, v235, v36
    v_mul_f32 v37, v235, v37
    v_mul_f32 v38, v235, v38
    v_mul_f32 v39, v235, v39
    v_mul_f32 v40, v235, v40
    v_mul_f32 v41, v235, v41
    v_mul_f32 v42, v235, v42
    v_mul_f32 v43, v235, v43
    v_mul_f32 v44, v235, v44
    v_mul_f32 v45, v235, v45
    v_mul_f32 v46, v235, v46
    v_mul_f32 v47, v235, v47
    v_mul_f32 v48, v235, v48
    v_mul_f32 v49, v235, v49
    v_mul_f32 v50, v235, v50
    v_mul_f32 v51, v235, v51
    v_mul_f32 v52, v235, v52
    v_mul_f32 v53, v235, v53
    v_mul_f32 v54, v235, v54
    v_mul_f32 v55, v235, v55
    v_mul_f32 v56, v235, v56
    v_mul_f32 v57, v235, v57
    v_mul_f32 v58, v235, v58
    v_mul_f32 v59, v235, v59
    v_mul_f32 v60, v235, v60
    v_mul_f32 v61, v235, v61
    v_mul_f32 v62, v235, v62
    v_mul_f32 v63, v235, v63
    v_mul_f32 v232, v235, v232
    v_mul_f32 v233, v235, v233
    s_nop 1
    s_branch L_back_ab
.section .rodata,"a"
.p2align 6
.amdhsa_kernel concat_heads__gqa_block_cached__gqa_block_cached__near_ridge_kernel
  .amdhsa_next_free_vgpr 256
  .amdhsa_next_free_sgpr 102
  .amdhsa_accum_offset 256
  .amdhsa_group_segment_fixed_size 0
  .amdhsa_kernarg_size 104
  .amdhsa_user_sgpr_count 2
  .amdhsa_user_sgpr_kernarg_segment_ptr 1
  .amdhsa_system_sgpr_workgroup_id_x 1
.end_amdhsa_kernel
```
